```python
import torch

def _softmax(x, axis=-1):
    return torch.softmax(x, dim=axis)

def _gelu(x):
    return torch.nn.functional.gelu(x, approximate='tanh')

def _silu(x):
    return torch.nn.functional.silu(x)

def _sigmoid(x):
    return torch.sigmoid(x)

def _layernorm(x, axis=-1, eps=1e-05):
    m = x.mean(dim=axis, keepdim=True)
    v = x.var(dim=axis, keepdim=True, unbiased=False)
    return (x - m) / torch.sqrt(v + eps)

def _scatter_add(tgt, idx, src, axis=0):
    return tgt.clone().index_add_(axis, idx, src)

def _segment_sum(src, seg, n):
    out = torch.zeros((n,) + src.shape[1:], dtype=src.dtype)
    return out.index_add_(0, seg, src)

def _pad(x, pw):
    flat = tuple((v for pair in reversed(pw) for v in pair))
    return torch.nn.functional.pad(x, flat)
kernel_name = 'adaLN_cond__gqa_block_cached__dense_activation_relu__prompt'

def setup_inputs():

    _w = lambda a: (lambda t: t.to(torch.bfloat16) if t.is_floating_point() else t)(torch.as_tensor(a))

    def _A_setup():
        B, Sq, D = (1, 2048, 448)
        Hq, Hkv, Sk, Dh = (16, 8, 2048, 256)
        assert Hq % Hkv == 0, (Hq, Hkv)
        return {'x': _w((lambda *s: torch.randn(*s, dtype=torch.bfloat16) * 0.1)(B, Sq, D)), 'k_cache': _w((lambda *s: torch.randn(*s, dtype=torch.bfloat16) * 0.8)(B, Hkv, Sk, Dh)), 'v_cache': _w((lambda *s: torch.randn(*s, dtype=torch.bfloat16) * 1.6)(B, Hkv, Sk, Dh)), 'wq': _w((lambda *s: torch.randn(*s, dtype=torch.bfloat16) * 0.8)(D, Hq * Dh) * D ** (-0.5)), 'wo': _w((lambda *s: torch.randn(*s, dtype=torch.bfloat16) * 1.6)(Hq * Dh, D) * (Hq * Dh) ** (-0.5))}
    _A_in = _A_setup()

    def _B_setup():
        B, S, D, Dff = (1, 2048, 448, 1792)
        return {'x': _w((lambda *s: torch.randn(*s, dtype=torch.bfloat16) * 0.1)(B, S, D)), 'w1': _w((lambda *s: torch.randn(*s, dtype=torch.bfloat16) * 0.2)(D, Dff)), 'w2': _w((lambda *s: torch.randn(*s, dtype=torch.bfloat16) * 0.2)(Dff, D))}
    _B_in = _B_setup()
    return {'A_x': _A_in['x'], 'A_k_cache': _A_in['k_cache'], 'A_v_cache': _A_in['v_cache'], 'A_wq': _A_in['wq'], 'A_wo': _A_in['wo'], 'B_x': _B_in['x'], 'B_w1': _B_in['w1'], 'B_w2': _B_in['w2'], 'c': _w((lambda *s: torch.randn(*s, dtype=torch.bfloat16) * 0.8)(1, 448) * 8.0), 'w_mod': _w((lambda *s: torch.randn(*s, dtype=torch.bfloat16) * 0.8)(448, 6 * 448) * 448 ** (-0.5) * 8.0)}

def reference(A_x, A_k_cache, A_v_cache, A_wq, A_wo, B_x, B_w1, B_w2, c, w_mod):

    def _A_ref(x, k_cache, v_cache, wq, wo):
        B, Sq, D = x.shape
        Hq, Dh = (16, 256)
        Hkv = k_cache.shape[1]
        rep = Hq // Hkv
        q = (lambda x, *d: x.permute(*d))((x @ wq).reshape(B, Sq, Hq, Dh), 0, 2, 1, 3)
        k = (lambda x, n, axis: torch.repeat_interleave(x, n, dim=axis))(k_cache, rep, axis=1)
        v = (lambda x, n, axis: torch.repeat_interleave(x, n, dim=axis))(v_cache, rep, axis=1)
        scores = torch.einsum('bhqd,bhkd->bhqk', q, k) * Dh ** (-0.5)
        p = _softmax(scores, axis=-1)
        o = torch.einsum('bhqk,bhkd->bhqd', p, v)
        return (lambda x, *d: x.permute(*d))(o, 0, 2, 1, 3).reshape(B, Sq, Hq * Dh) @ wo

    def _B_ref(x, w1, w2):
        h = torch.einsum('bsd,df->bsf', x, w1)
        zero = torch.zeros_like(h)
        h = torch.maximum(h, zero)
        return torch.einsum('bsf,fd->bsd', h, w2)
    x = A_x
    mod = (_silu(c) @ w_mod).reshape(c.shape[0], 6, 1, -1)
    sa, ca, ga, sb, cb, gb = (mod[:, 0].clone(), mod[:, 1].clone(), mod[:, 2].clone(), mod[:, 3].clone(), mod[:, 4].clone(), mod[:, 5].clone())
    h = _layernorm(x, axis=-1) * (1 + ca) + sa
    x = x + ga * _A_ref(h, A_k_cache, A_v_cache, A_wq, A_wo)
    h = _layernorm(x, axis=-1) * (1 + cb) + sb
    x = x + gb * _B_ref(h, B_w1, B_w2)
    return x
```

```asm
; @launch kernel=k2_attn_kernel grid=(256,1,1) block=(256,1,1) lds=163840
; @launch kernel=k34_tail_kernel grid=(256,1,1) block=(512,1,1) lds=152576
.amdgcn_target "amdgcn-amd-amdhsa--gfx950"
.text
.p2align 8
code_begin:
.text
.globl k2_attn_kernel
.p2align 8
.type k2_attn_kernel,@function
k2_attn_kernel:
    s_cmp_ge_u32 s2, 256
    s_cbranch_scc1 K2_end
    s_load_dwordx4 s[4:7], s[0:1], 0
    s_load_dwordx4 s[8:11], s[0:1], 16
    s_load_dwordx2 s[12:13], s[0:1], 32
    s_load_dwordx2 s[14:15], s[0:1], 96
    s_load_dwordx4 s[96:99], s[0:1], 64
    s_load_dwordx2 s[100:101], s[0:1], 88
    s_load_dwordx4 s[88:91], s[0:1], 48
    v_and_b32 v1, 63, v0
    v_lshrrev_b32 v13, 6, v0
    v_and_b32 v2, 15, v0
    v_readfirstlane_b32 s48, v13
    v_lshrrev_b32 v3, 4, v1
    v_bfe_u32 v4, v0, 2, 2
    v_and_b32 v5, 3, v0
    s_nop 0
    s_cmp_lg_u32 s48, 3
    s_cbranch_scc1 K2_noecpf
    s_getpc_b64 s[70:71]
K2_pc0:
    s_sub_u32 s70, s70, K2_pc0-code_begin
    s_subb_u32 s71, s71, 0
    v_lshlrev_b32 v8, 7, v1
    global_load_dword v6, v8, s[70:71] offset:0
    v_add_u32 v8, 8192, v8
    global_load_dword v7, v8, s[70:71] offset:0
    v_add_u32 v8, 8192, v8
    s_waitcnt vmcnt(1)
    global_load_dword v6, v8, s[70:71] offset:0
K2_noecpf:
    s_and_b32 s51, s2, 7
    s_lshr_b32 s52, s2, 3
    s_mov_b32 s3, s2
    s_and_b32 s49, s48, 1
    s_lshr_b32 s50, s48, 1
    s_mov_b32 s65, 0xffff0000
    s_mov_b32 s64, 1904214016
    s_waitcnt lgkmcnt(0)
    s_mov_b32 s16, s4
    s_and_b32 s17, s5, 0xffff
    s_mov_b32 s18, 1835008
    s_mov_b32 s19, 0x00020000
    s_lshl_b32 s53, s51, 20
    s_add_u32 s6, s6, s53
    s_addc_u32 s7, s7, 0
    s_add_u32 s8, s8, s53
    s_addc_u32 s9, s9, 0
    s_mov_b32 s20, s6
    s_and_b32 s21, s7, 0xffff
    s_mov_b32 s22, 1048576
    s_mov_b32 s23, 0x00020000
    s_mov_b32 s24, s8
    s_and_b32 s25, s9, 0xffff
    s_mov_b32 s26, 1048576
    s_mov_b32 s27, 0x00020000
    s_mov_b32 s28, s10
    s_and_b32 s29, s11, 0xffff
    s_mov_b32 s30, 3670016
    s_mov_b32 s31, 0x00020000
    s_mul_i32 s53, s51, 458752
    s_add_u32 s12, s12, s53
    s_addc_u32 s13, s13, 0
    s_mov_b32 s32, s12
    s_and_b32 s33, s13, 0xffff
    s_mov_b32 s34, 458752
    s_mov_b32 s35, 0x00020000
    s_mov_b32 s36, s14
    s_and_b32 s37, s15, 0xffff
    s_mov_b32 s38, 65536
    s_mov_b32 s39, 0x00020000
    s_lshl_b32 s53, s52, 3
    s_add_u32 s53, s53, s51
    s_mul_i32 s53, s53, 57344
    s_add_u32 s53, s53, 1048576
    s_add_u32 s4, s14, s53
    s_addc_u32 s5, s15, 0
    s_mov_b32 s40, s4
    s_and_b32 s41, s5, 0xffff
    s_mov_b32 s42, 57344
    s_mov_b32 s43, 0x00020000
    s_mov_b32 s92, s100
    s_and_b32 s93, s101, 0xffff
    s_mov_b32 s94, 256
    s_mov_b32 s95, 0x00020000
    s_cmp_ge_u32 s3, 42
    s_cbranch_scc1 K2_noprod1
    s_mov_b32 s4, s96
    s_and_b32 s5, s97, 0xffff
    s_mov_b32 s6, 896
    s_mov_b32 s7, 0x00020000
    s_mov_b32 s8, s98
    s_and_b32 s9, s99, 0xffff
    s_mov_b32 s10, 2408448
    s_mov_b32 s11, 0x00020000
    v_lshrrev_b32 v8, 3, v0
    v_and_b32 v9, 7, v0
    v_mul_u32_u24 v10, 5376, v8
    v_lshl_add_u32 v10, v9, 4, v10
    v_lshlrev_b32 v11, 1, v8
    s_lshl_b32 s53, s3, 7
    s_memrealtime s[70:71]
    buffer_load_ushort v240, v11, s[4:7], 0 offen offset:0
    buffer_load_ushort v241, v11, s[4:7], 0 offen offset:64
    buffer_load_ushort v242, v11, s[4:7], 0 offen offset:128
    buffer_load_ushort v243, v11, s[4:7], 0 offen offset:192
    buffer_load_ushort v244, v11, s[4:7], 0 offen offset:256
    buffer_load_ushort v245, v11, s[4:7], 0 offen offset:320
    buffer_load_ushort v246, v11, s[4:7], 0 offen offset:384
    buffer_load_ushort v247, v11, s[4:7], 0 offen offset:448
    buffer_load_ushort v248, v11, s[4:7], 0 offen offset:512
    buffer_load_ushort v249, v11, s[4:7], 0 offen offset:576
    buffer_load_ushort v250, v11, s[4:7], 0 offen offset:640
    buffer_load_ushort v251, v11, s[4:7], 0 offen offset:704
    buffer_load_ushort v252, v11, s[4:7], 0 offen offset:768
    buffer_load_ushort v253, v11, s[4:7], 0 offen offset:832
    buffer_load_dwordx4 v[184:187], v10, s[8:11], s53 offen
    s_add_u32 s53, s53, 172032
    buffer_load_dwordx4 v[188:191], v10, s[8:11], s53 offen
    s_add_u32 s53, s53, 172032
    buffer_load_dwordx4 v[192:195], v10, s[8:11], s53 offen
    s_add_u32 s53, s53, 172032
    buffer_load_dwordx4 v[196:199], v10, s[8:11], s53 offen
    s_add_u32 s53, s53, 172032
    buffer_load_dwordx4 v[200:203], v10, s[8:11], s53 offen
    s_add_u32 s53, s53, 172032
    buffer_load_dwordx4 v[204:207], v10, s[8:11], s53 offen
    s_add_u32 s53, s53, 172032
    buffer_load_dwordx4 v[208:211], v10, s[8:11], s53 offen
    s_add_u32 s53, s53, 172032
    buffer_load_dwordx4 v[212:215], v10, s[8:11], s53 offen
    s_add_u32 s53, s53, 172032
    buffer_load_dwordx4 v[216:219], v10, s[8:11], s53 offen
    s_add_u32 s53, s53, 172032
    buffer_load_dwordx4 v[220:223], v10, s[8:11], s53 offen
    s_add_u32 s53, s53, 172032
    buffer_load_dwordx4 v[224:227], v10, s[8:11], s53 offen
    s_add_u32 s53, s53, 172032
    buffer_load_dwordx4 v[228:231], v10, s[8:11], s53 offen
    s_add_u32 s53, s53, 172032
    buffer_load_dwordx4 v[232:235], v10, s[8:11], s53 offen
    s_add_u32 s53, s53, 172032
    buffer_load_dwordx4 v[236:239], v10, s[8:11], s53 offen
    s_waitcnt lgkmcnt(0)
    s_or_b32 s69, s70, 1
    s_cmp_ge_u32 s3, 14
    s_cbranch_scc1 K2_noprod1
    s_cmp_lg_u32 s48, 0
    s_cbranch_scc1 K2_noprod1
    s_lshl_b32 s53, s3, 2
    v_mov_b32 v8, s53
    v_mov_b32 v9, s69
    buffer_store_dword v9, v8, s[92:95], 0 offen sc0 sc1
    s_cmp_lg_u32 s3, 0
    s_cbranch_scc1 K2_noprod1
    v_mov_b32 v8, 49152
    buffer_store_dword v9, v8, s[36:39], 0 offen sc0 sc1
K2_noprod1:
    s_lshl_b32 s53, s52, 6
    s_lshl_b32 s54, s48, 4
    s_add_u32 s53, s53, s54
    v_add_u32 v13, s53, v2
    v_mul_u32_u24 v13, 896, v13
    v_lshl_add_u32 v13, v3, 4, v13
    buffer_load_dwordx4 v[128:131], v13, s[16:19], 0 offen offset:0
    buffer_load_dwordx4 v[132:135], v13, s[16:19], 0 offen offset:64
    buffer_load_dwordx4 v[136:139], v13, s[16:19], 0 offen offset:128
    buffer_load_dwordx4 v[140:143], v13, s[16:19], 0 offen offset:192
    buffer_load_dwordx4 v[144:147], v13, s[16:19], 0 offen offset:256
    buffer_load_dwordx4 v[148:151], v13, s[16:19], 0 offen offset:320
    buffer_load_dwordx4 v[152:155], v13, s[16:19], 0 offen offset:384
    buffer_load_dwordx4 v[156:159], v13, s[16:19], 0 offen offset:448
    buffer_load_dwordx4 v[160:163], v13, s[16:19], 0 offen offset:512
    buffer_load_dwordx4 v[164:167], v13, s[16:19], 0 offen offset:576
    buffer_load_dwordx4 v[168:171], v13, s[16:19], 0 offen offset:640
    buffer_load_dwordx4 v[172:175], v13, s[16:19], 0 offen offset:704
    buffer_load_dwordx4 v[176:179], v13, s[16:19], 0 offen offset:768
    buffer_load_dwordx4 v[180:183], v13, s[16:19], 0 offen offset:832
    s_cmp_ge_u32 s3, 42
    s_cbranch_scc1 K2_noprod2
    s_mov_b32 s53, 1069066811
    s_waitcnt vmcnt(28)
    v_lshlrev_b32 v240, 16, v240
    v_lshlrev_b32 v241, 16, v241
    v_lshlrev_b32 v242, 16, v242
    v_lshlrev_b32 v243, 16, v243
    v_lshlrev_b32 v244, 16, v244
    v_lshlrev_b32 v245, 16, v245
    v_lshlrev_b32 v246, 16, v246
    v_lshlrev_b32 v247, 16, v247
    v_lshlrev_b32 v248, 16, v248
    v_lshlrev_b32 v249, 16, v249
    v_lshlrev_b32 v250, 16, v250
    v_lshlrev_b32 v251, 16, v251
    v_lshlrev_b32 v252, 16, v252
    v_lshlrev_b32 v253, 16, v253
    v_mul_f32 v100, s53, v240
    v_mul_f32 v101, s53, v241
    v_mul_f32 v102, s53, v242
    v_mul_f32 v103, s53, v243
    v_mul_f32 v104, s53, v244
    v_mul_f32 v105, s53, v245
    v_mul_f32 v106, s53, v246
    v_mul_f32 v107, s53, v247
    v_mul_f32 v108, s53, v248
    v_mul_f32 v109, s53, v249
    v_mul_f32 v110, s53, v250
    v_mul_f32 v111, s53, v251
    v_mul_f32 v112, s53, v252
    v_mul_f32 v113, s53, v253
    v_exp_f32 v100, -v100
    v_exp_f32 v101, -v101
    v_exp_f32 v102, -v102
    v_exp_f32 v103, -v103
    v_exp_f32 v104, -v104
    v_exp_f32 v105, -v105
    v_exp_f32 v106, -v106
    v_exp_f32 v107, -v107
    v_exp_f32 v108, -v108
    v_exp_f32 v109, -v109
    v_exp_f32 v110, -v110
    v_exp_f32 v111, -v111
    v_exp_f32 v112, -v112
    v_exp_f32 v113, -v113
    v_add_f32 v100, 1.0, v100
    v_add_f32 v101, 1.0, v101
    v_add_f32 v102, 1.0, v102
    v_add_f32 v103, 1.0, v103
    v_add_f32 v104, 1.0, v104
    v_add_f32 v105, 1.0, v105
    v_add_f32 v106, 1.0, v106
    v_add_f32 v107, 1.0, v107
    v_add_f32 v108, 1.0, v108
    v_add_f32 v109, 1.0, v109
    v_add_f32 v110, 1.0, v110
    v_add_f32 v111, 1.0, v111
    v_add_f32 v112, 1.0, v112
    v_add_f32 v113, 1.0, v113
    v_rcp_f32 v100, v100
    v_rcp_f32 v101, v101
    v_rcp_f32 v102, v102
    v_rcp_f32 v103, v103
    v_rcp_f32 v104, v104
    v_rcp_f32 v105, v105
    v_rcp_f32 v106, v106
    v_rcp_f32 v107, v107
    v_rcp_f32 v108, v108
    v_rcp_f32 v109, v109
    v_rcp_f32 v110, v110
    v_rcp_f32 v111, v111
    v_rcp_f32 v112, v112
    v_rcp_f32 v113, v113
    v_mul_f32 v100, v240, v100
    v_mul_f32 v101, v241, v101
    v_mul_f32 v102, v242, v102
    v_mul_f32 v103, v243, v103
    v_mul_f32 v104, v244, v104
    v_mul_f32 v105, v245, v105
    v_mul_f32 v106, v246, v106
    v_mul_f32 v107, v247, v107
    v_mul_f32 v108, v248, v108
    v_mul_f32 v109, v249, v109
    v_mul_f32 v110, v250, v110
    v_mul_f32 v111, v251, v111
    v_mul_f32 v112, v252, v112
    v_mul_f32 v113, v253, v113
    v_cvt_pk_bf16_f32 v100, 0, v100
    v_cvt_pk_bf16_f32 v101, 0, v101
    v_cvt_pk_bf16_f32 v102, 0, v102
    v_cvt_pk_bf16_f32 v103, 0, v103
    v_cvt_pk_bf16_f32 v104, 0, v104
    v_cvt_pk_bf16_f32 v105, 0, v105
    v_cvt_pk_bf16_f32 v106, 0, v106
    v_cvt_pk_bf16_f32 v107, 0, v107
    v_cvt_pk_bf16_f32 v108, 0, v108
    v_cvt_pk_bf16_f32 v109, 0, v109
    v_cvt_pk_bf16_f32 v110, 0, v110
    v_cvt_pk_bf16_f32 v111, 0, v111
    v_cvt_pk_bf16_f32 v112, 0, v112
    v_cvt_pk_bf16_f32 v113, 0, v113
    v_mov_b32 v16, 0
    v_mov_b32 v17, 0
    v_mov_b32 v18, 0
    v_mov_b32 v19, 0
    v_mov_b32 v20, 0
    v_mov_b32 v21, 0
    v_mov_b32 v22, 0
    v_mov_b32 v23, 0
    s_waitcnt vmcnt(27)
    v_lshlrev_b32 v12, 16, v184
    v_and_b32 v13, s65, v184
    v_fmac_f32 v16, v100, v12
    v_fmac_f32 v17, v100, v13
    v_lshlrev_b32 v12, 16, v185
    v_and_b32 v13, s65, v185
    v_fmac_f32 v18, v100, v12
    v_fmac_f32 v19, v100, v13
    v_lshlrev_b32 v12, 16, v186
    v_and_b32 v13, s65, v186
    v_fmac_f32 v20, v100, v12
    v_fmac_f32 v21, v100, v13
    v_lshlrev_b32 v12, 16, v187
    v_and_b32 v13, s65, v187
    v_fmac_f32 v22, v100, v12
    v_fmac_f32 v23, v100, v13
    s_waitcnt vmcnt(26)
    v_lshlrev_b32 v12, 16, v188
    v_and_b32 v13, s65, v188
    v_fmac_f32 v16, v101, v12
    v_fmac_f32 v17, v101, v13
    v_lshlrev_b32 v12, 16, v189
    v_and_b32 v13, s65, v189
    v_fmac_f32 v18, v101, v12
    v_fmac_f32 v19, v101, v13
    v_lshlrev_b32 v12, 16, v190
    v_and_b32 v13, s65, v190
    v_fmac_f32 v20, v101, v12
    v_fmac_f32 v21, v101, v13
    v_lshlrev_b32 v12, 16, v191
    v_and_b32 v13, s65, v191
    v_fmac_f32 v22, v101, v12
    v_fmac_f32 v23, v101, v13
    s_waitcnt vmcnt(25)
    v_lshlrev_b32 v12, 16, v192
    v_and_b32 v13, s65, v192
    v_fmac_f32 v16, v102, v12
    v_fmac_f32 v17, v102, v13
    v_lshlrev_b32 v12, 16, v193
    v_and_b32 v13, s65, v193
    v_fmac_f32 v18, v102, v12
    v_fmac_f32 v19, v102, v13
    v_lshlrev_b32 v12, 16, v194
    v_and_b32 v13, s65, v194
    v_fmac_f32 v20, v102, v12
    v_fmac_f32 v21, v102, v13
    v_lshlrev_b32 v12, 16, v195
    v_and_b32 v13, s65, v195
    v_fmac_f32 v22, v102, v12
    v_fmac_f32 v23, v102, v13
    s_waitcnt vmcnt(24)
    v_lshlrev_b32 v12, 16, v196
    v_and_b32 v13, s65, v196
    v_fmac_f32 v16, v103, v12
    v_fmac_f32 v17, v103, v13
    v_lshlrev_b32 v12, 16, v197
    v_and_b32 v13, s65, v197
    v_fmac_f32 v18, v103, v12
    v_fmac_f32 v19, v103, v13
    v_lshlrev_b32 v12, 16, v198
    v_and_b32 v13, s65, v198
    v_fmac_f32 v20, v103, v12
    v_fmac_f32 v21, v103, v13
    v_lshlrev_b32 v12, 16, v199
    v_and_b32 v13, s65, v199
    v_fmac_f32 v22, v103, v12
    v_fmac_f32 v23, v103, v13
    s_waitcnt vmcnt(23)
    v_lshlrev_b32 v12, 16, v200
    v_and_b32 v13, s65, v200
    v_fmac_f32 v16, v104, v12
    v_fmac_f32 v17, v104, v13
    v_lshlrev_b32 v12, 16, v201
    v_and_b32 v13, s65, v201
    v_fmac_f32 v18, v104, v12
    v_fmac_f32 v19, v104, v13
    v_lshlrev_b32 v12, 16, v202
    v_and_b32 v13, s65, v202
    v_fmac_f32 v20, v104, v12
    v_fmac_f32 v21, v104, v13
    v_lshlrev_b32 v12, 16, v203
    v_and_b32 v13, s65, v203
    v_fmac_f32 v22, v104, v12
    v_fmac_f32 v23, v104, v13
    s_waitcnt vmcnt(22)
    v_lshlrev_b32 v12, 16, v204
    v_and_b32 v13, s65, v204
    v_fmac_f32 v16, v105, v12
    v_fmac_f32 v17, v105, v13
    v_lshlrev_b32 v12, 16, v205
    v_and_b32 v13, s65, v205
    v_fmac_f32 v18, v105, v12
    v_fmac_f32 v19, v105, v13
    v_lshlrev_b32 v12, 16, v206
    v_and_b32 v13, s65, v206
    v_fmac_f32 v20, v105, v12
    v_fmac_f32 v21, v105, v13
    v_lshlrev_b32 v12, 16, v207
    v_and_b32 v13, s65, v207
    v_fmac_f32 v22, v105, v12
    v_fmac_f32 v23, v105, v13
    s_waitcnt vmcnt(21)
    v_lshlrev_b32 v12, 16, v208
    v_and_b32 v13, s65, v208
    v_fmac_f32 v16, v106, v12
    v_fmac_f32 v17, v106, v13
    v_lshlrev_b32 v12, 16, v209
    v_and_b32 v13, s65, v209
    v_fmac_f32 v18, v106, v12
    v_fmac_f32 v19, v106, v13
    v_lshlrev_b32 v12, 16, v210
    v_and_b32 v13, s65, v210
    v_fmac_f32 v20, v106, v12
    v_fmac_f32 v21, v106, v13
    v_lshlrev_b32 v12, 16, v211
    v_and_b32 v13, s65, v211
    v_fmac_f32 v22, v106, v12
    v_fmac_f32 v23, v106, v13
    s_waitcnt vmcnt(20)
    v_lshlrev_b32 v12, 16, v212
    v_and_b32 v13, s65, v212
    v_fmac_f32 v16, v107, v12
    v_fmac_f32 v17, v107, v13
    v_lshlrev_b32 v12, 16, v213
    v_and_b32 v13, s65, v213
    v_fmac_f32 v18, v107, v12
    v_fmac_f32 v19, v107, v13
    v_lshlrev_b32 v12, 16, v214
    v_and_b32 v13, s65, v214
    v_fmac_f32 v20, v107, v12
    v_fmac_f32 v21, v107, v13
    v_lshlrev_b32 v12, 16, v215
    v_and_b32 v13, s65, v215
    v_fmac_f32 v22, v107, v12
    v_fmac_f32 v23, v107, v13
    s_waitcnt vmcnt(19)
    v_lshlrev_b32 v12, 16, v216
    v_and_b32 v13, s65, v216
    v_fmac_f32 v16, v108, v12
    v_fmac_f32 v17, v108, v13
    v_lshlrev_b32 v12, 16, v217
    v_and_b32 v13, s65, v217
    v_fmac_f32 v18, v108, v12
    v_fmac_f32 v19, v108, v13
    v_lshlrev_b32 v12, 16, v218
    v_and_b32 v13, s65, v218
    v_fmac_f32 v20, v108, v12
    v_fmac_f32 v21, v108, v13
    v_lshlrev_b32 v12, 16, v219
    v_and_b32 v13, s65, v219
    v_fmac_f32 v22, v108, v12
    v_fmac_f32 v23, v108, v13
    s_waitcnt vmcnt(18)
    v_lshlrev_b32 v12, 16, v220
    v_and_b32 v13, s65, v220
    v_fmac_f32 v16, v109, v12
    v_fmac_f32 v17, v109, v13
    v_lshlrev_b32 v12, 16, v221
    v_and_b32 v13, s65, v221
    v_fmac_f32 v18, v109, v12
    v_fmac_f32 v19, v109, v13
    v_lshlrev_b32 v12, 16, v222
    v_and_b32 v13, s65, v222
    v_fmac_f32 v20, v109, v12
    v_fmac_f32 v21, v109, v13
    v_lshlrev_b32 v12, 16, v223
    v_and_b32 v13, s65, v223
    v_fmac_f32 v22, v109, v12
    v_fmac_f32 v23, v109, v13
    s_waitcnt vmcnt(17)
    v_lshlrev_b32 v12, 16, v224
    v_and_b32 v13, s65, v224
    v_fmac_f32 v16, v110, v12
    v_fmac_f32 v17, v110, v13
    v_lshlrev_b32 v12, 16, v225
    v_and_b32 v13, s65, v225
    v_fmac_f32 v18, v110, v12
    v_fmac_f32 v19, v110, v13
    v_lshlrev_b32 v12, 16, v226
    v_and_b32 v13, s65, v226
    v_fmac_f32 v20, v110, v12
    v_fmac_f32 v21, v110, v13
    v_lshlrev_b32 v12, 16, v227
    v_and_b32 v13, s65, v227
    v_fmac_f32 v22, v110, v12
    v_fmac_f32 v23, v110, v13
    s_waitcnt vmcnt(16)
    v_lshlrev_b32 v12, 16, v228
    v_and_b32 v13, s65, v228
    v_fmac_f32 v16, v111, v12
    v_fmac_f32 v17, v111, v13
    v_lshlrev_b32 v12, 16, v229
    v_and_b32 v13, s65, v229
    v_fmac_f32 v18, v111, v12
    v_fmac_f32 v19, v111, v13
    v_lshlrev_b32 v12, 16, v230
    v_and_b32 v13, s65, v230
    v_fmac_f32 v20, v111, v12
    v_fmac_f32 v21, v111, v13
    v_lshlrev_b32 v12, 16, v231
    v_and_b32 v13, s65, v231
    v_fmac_f32 v22, v111, v12
    v_fmac_f32 v23, v111, v13
    s_waitcnt vmcnt(15)
    v_lshlrev_b32 v12, 16, v232
    v_and_b32 v13, s65, v232
    v_fmac_f32 v16, v112, v12
    v_fmac_f32 v17, v112, v13
    v_lshlrev_b32 v12, 16, v233
    v_and_b32 v13, s65, v233
    v_fmac_f32 v18, v112, v12
    v_fmac_f32 v19, v112, v13
    v_lshlrev_b32 v12, 16, v234
    v_and_b32 v13, s65, v234
    v_fmac_f32 v20, v112, v12
    v_fmac_f32 v21, v112, v13
    v_lshlrev_b32 v12, 16, v235
    v_and_b32 v13, s65, v235
    v_fmac_f32 v22, v112, v12
    v_fmac_f32 v23, v112, v13
    s_waitcnt vmcnt(14)
    v_lshlrev_b32 v12, 16, v236
    v_and_b32 v13, s65, v236
    v_fmac_f32 v16, v113, v12
    v_fmac_f32 v17, v113, v13
    v_lshlrev_b32 v12, 16, v237
    v_and_b32 v13, s65, v237
    v_fmac_f32 v18, v113, v12
    v_fmac_f32 v19, v113, v13
    v_lshlrev_b32 v12, 16, v238
    v_and_b32 v13, s65, v238
    v_fmac_f32 v20, v113, v12
    v_fmac_f32 v21, v113, v13
    v_lshlrev_b32 v12, 16, v239
    v_and_b32 v13, s65, v239
    v_fmac_f32 v22, v113, v12
    v_fmac_f32 v23, v113, v13
    v_lshrrev_b32 v8, 3, v0
    v_and_b32 v9, 7, v0
    v_lshlrev_b32 v12, 8, v8
    v_lshl_add_u32 v12, v9, 5, v12
    v_add_u32 v12, 101376, v12
    ds_write_b128 v12, v[16:19]
    ds_write_b128 v12, v[20:23] offset:16
    s_waitcnt lgkmcnt(0)
    s_barrier
    s_cmp_lg_u32 s48, 0
    s_cbranch_scc1 K2_noprod2
    v_lshlrev_b32 v12, 2, v1
    v_add_u32 v12, 101376, v12
    ds_read_b32 v16, v12 offset:0
    ds_read_b32 v17, v12 offset:256
    ds_read_b32 v18, v12 offset:512
    ds_read_b32 v19, v12 offset:768
    ds_read_b32 v20, v12 offset:1024
    ds_read_b32 v21, v12 offset:1280
    ds_read_b32 v22, v12 offset:1536
    ds_read_b32 v23, v12 offset:1792
    ds_read_b32 v24, v12 offset:2048
    ds_read_b32 v25, v12 offset:2304
    ds_read_b32 v26, v12 offset:2560
    ds_read_b32 v27, v12 offset:2816
    ds_read_b32 v28, v12 offset:3072
    ds_read_b32 v29, v12 offset:3328
    ds_read_b32 v30, v12 offset:3584
    ds_read_b32 v31, v12 offset:3840
    ds_read_b32 v32, v12 offset:4096
    ds_read_b32 v33, v12 offset:4352
    ds_read_b32 v34, v12 offset:4608
    ds_read_b32 v35, v12 offset:4864
    ds_read_b32 v36, v12 offset:5120
    ds_read_b32 v37, v12 offset:5376
    ds_read_b32 v38, v12 offset:5632
    ds_read_b32 v39, v12 offset:5888
    ds_read_b32 v40, v12 offset:6144
    ds_read_b32 v41, v12 offset:6400
    ds_read_b32 v42, v12 offset:6656
    ds_read_b32 v43, v12 offset:6912
    ds_read_b32 v44, v12 offset:7168
    ds_read_b32 v45, v12 offset:7424
    ds_read_b32 v46, v12 offset:7680
    ds_read_b32 v47, v12 offset:7936
    s_waitcnt lgkmcnt(0)
    v_add_f32 v16, v16, v32
    v_add_f32 v17, v17, v33
    v_add_f32 v18, v18, v34
    v_add_f32 v19, v19, v35
    v_add_f32 v20, v20, v36
    v_add_f32 v21, v21, v37
    v_add_f32 v22, v22, v38
    v_add_f32 v23, v23, v39
    v_add_f32 v24, v24, v40
    v_add_f32 v25, v25, v41
    v_add_f32 v26, v26, v42
    v_add_f32 v27, v27, v43
    v_add_f32 v28, v28, v44
    v_add_f32 v29, v29, v45
    v_add_f32 v30, v30, v46
    v_add_f32 v31, v31, v47
    v_add_f32 v16, v16, v24
    v_add_f32 v17, v17, v25
    v_add_f32 v18, v18, v26
    v_add_f32 v19, v19, v27
    v_add_f32 v20, v20, v28
    v_add_f32 v21, v21, v29
    v_add_f32 v22, v22, v30
    v_add_f32 v23, v23, v31
    v_add_f32 v16, v16, v20
    v_add_f32 v17, v17, v21
    v_add_f32 v18, v18, v22
    v_add_f32 v19, v19, v23
    v_add_f32 v16, v16, v18
    v_add_f32 v17, v17, v19
    v_add_f32 v16, v16, v17
    v_cvt_pk_bf16_f32 v16, 0, v16
    s_lshl_b32 s53, s3, 6
    v_add_u32 v12, s53, v1
    v_add_f32 v17, 1.0, v16
    v_cvt_pk_bf16_f32 v17, 0, v17
    v_subrev_u32 v18, 448, v12
    v_subrev_u32 v19, 1792, v12
    v_min_u32 v18, v18, v19
    v_cmp_gt_u32 vcc, 448, v18
    v_lshlrev_b32 v12, 2, v12
    s_nop 0
    v_cndmask_b32 v16, v16, v17, vcc
    s_mov_b32 s53, 1.0
    s_cmp_lt_u32 s3, 14
    s_cmov_b32 s53, 0x3db8aa3b
    v_mul_f32 v16, s53, v16
    s_cmp_ge_u32 s3, 14
    s_cbranch_scc1 K2_prodplain
    v_mov_b32 v17, s69
    v_lshlrev_b32 v12, 1, v12
    s_mov_b32 s53, 32768
    buffer_store_dwordx2 v[16:17], v12, s[36:39], s53 offen sc0 sc1
    s_branch K2_noprod2
K2_prodplain:
    buffer_store_dword v16, v12, s[36:39], 0 offen sc0 sc1
K2_noprod2:
    v_lshlrev_b32 v120, 4, v1
    v_add_u32 v121, 8192, v120
    v_add_u32 v122, 16384, v120
    v_add_u32 v123, 24576, v120
    v_add_u32 v124, 32768, v120
    v_add_u32 v125, 40960, v120
    v_add_u32 v126, 49152, v120
    v_add_u32 v127, 57344, v120
    s_lshl_b32 s67, s48, 16
    s_lshl_b32 s53, s51, 10
    s_add_u32 s67, s67, s53
    s_mul_i32 s56, s48, 8448
    s_add_u32 m0, s56, 33792
    s_nop 0
    buffer_load_dwordx4 v120, s[28:31], s67 offen lds
    s_add_u32 m0, s56, 34848
    s_nop 0
    buffer_load_dwordx4 v121, s[28:31], s67 offen lds
    s_add_u32 m0, s56, 35904
    s_nop 0
    buffer_load_dwordx4 v122, s[28:31], s67 offen lds
    s_add_u32 m0, s56, 36960
    s_nop 0
    buffer_load_dwordx4 v123, s[28:31], s67 offen lds
    s_add_u32 m0, s56, 38016
    s_nop 0
    buffer_load_dwordx4 v124, s[28:31], s67 offen lds
    s_add_u32 m0, s56, 39072
    s_nop 0
    buffer_load_dwordx4 v125, s[28:31], s67 offen lds
    s_add_u32 m0, s56, 40128
    s_nop 0
    buffer_load_dwordx4 v126, s[28:31], s67 offen lds
    s_add_u32 m0, s56, 41184
    s_nop 0
    buffer_load_dwordx4 v127, s[28:31], s67 offen lds
    s_add_u32 m0, s56, 67584
    s_add_u32 s67, s67, 262144
    buffer_load_dwordx4 v120, s[28:31], s67 offen lds
    s_add_u32 m0, s56, 68640
    s_nop 0
    buffer_load_dwordx4 v121, s[28:31], s67 offen lds
    s_add_u32 m0, s56, 69696
    s_nop 0
    buffer_load_dwordx4 v122, s[28:31], s67 offen lds
    s_add_u32 m0, s56, 70752
    s_nop 0
    buffer_load_dwordx4 v123, s[28:31], s67 offen lds
    s_add_u32 m0, s56, 71808
    s_nop 0
    buffer_load_dwordx4 v124, s[28:31], s67 offen lds
    s_add_u32 m0, s56, 72864
    s_nop 0
    buffer_load_dwordx4 v125, s[28:31], s67 offen lds
    s_add_u32 m0, s56, 73920
    s_nop 0
    buffer_load_dwordx4 v126, s[28:31], s67 offen lds
    s_add_u32 m0, s56, 74976
    s_nop 0
    buffer_load_dwordx4 v127, s[28:31], s67 offen lds
    s_add_u32 m0, s56, 0
    s_add_u32 s67, s67, 262144
    buffer_load_dwordx4 v120, s[28:31], s67 offen lds
    s_add_u32 m0, s56, 1056
    s_nop 0
    buffer_load_dwordx4 v121, s[28:31], s67 offen lds
    s_add_u32 m0, s56, 2112
    s_nop 0
    buffer_load_dwordx4 v122, s[28:31], s67 offen lds
    s_add_u32 m0, s56, 3168
    s_nop 0
    buffer_load_dwordx4 v123, s[28:31], s67 offen lds
    s_add_u32 m0, s56, 4224
    s_nop 0
    buffer_load_dwordx4 v124, s[28:31], s67 offen lds
    s_add_u32 m0, s56, 5280
    s_nop 0
    buffer_load_dwordx4 v125, s[28:31], s67 offen lds
    s_add_u32 m0, s56, 6336
    s_nop 0
    buffer_load_dwordx4 v126, s[28:31], s67 offen lds
    s_add_u32 m0, s56, 7392
    s_nop 0
    buffer_load_dwordx4 v127, s[28:31], s67 offen lds
    s_sub_u32 s53, s2, 42
    s_lshl_b32 s57, s53, 2
    s_add_u32 s57, s57, s48
    s_cmp_lt_u32 s2, 42
    s_cbranch_scc1 K2_wt_none
    s_cmp_lt_u32 s57, 784
    s_cbranch_scc1 K2_wt_go
K2_wt_none:
    s_mov_b32 s57, -1
    s_branch K2_wt_skip1
K2_wt_go:
    s_cmp_lt_u32 s57, 392
    s_cselect_b32 s4, s88, s90
    s_cselect_b32 s5, s89, s91
    s_mov_b32 s58, 896
    s_cmov_b32 s58, 3584
    s_cselect_b32 s55, 28, 7
    s_mov_b32 s54, 9363
    s_cmov_b32 s54, 2341
    s_cselect_b32 s53, 0, 392
    s_mov_b32 s62, 1024
    s_cmov_b32 s62, 14336
    s_mov_b32 s61, 29360128
    s_cmov_b32 s61, 27262976
    s_cselect_b32 s59, 10, 12
    s_sub_u32 s53, s57, s53
    s_mul_i32 s54, s53, s54
    s_lshr_b32 s54, s54, 16
    s_mul_i32 s55, s54, s55
    s_sub_u32 s55, s53, s55
    s_and_b32 s5, s5, 0xffff
    s_mov_b32 s6, 1605632
    s_mov_b32 s7, 0x00020000
    s_mul_i32 s53, s54, s58
    s_lshl_b32 s53, s53, 5
    s_lshl_b32 s60, s55, 7
    s_add_u32 s60, s60, s53
    s_mul_i32 s53, s55, 56
    s_add_u32 s53, s53, s54
    s_lshl_b32 s53, s53, s59
    s_add_u32 s61, s61, s53
    v_lshrrev_b32 v8, 3, v1
    v_mul_lo_u32 v8, v8, s58
    v_bfe_u32 v9, v1, 1, 2
    v_xor_b32 v9, v9, v3
    v_lshl_add_u32 v8, v9, 5, v8
    v_and_b32 v9, 1, v1
    v_lshl_add_u32 v8, v9, 4, v8
    s_lshl_b32 s54, s48, 12
    s_add_u32 s54, s54, 117760
    s_lshl_b32 s55, s58, 3
    s_add_u32 m0, s54, 0
    s_nop 0
    buffer_load_dwordx4 v8, s[4:7], s60 offen lds
    s_add_u32 s60, s60, s55
    s_add_u32 m0, s54, 1024
    s_nop 0
    buffer_load_dwordx4 v8, s[4:7], s60 offen lds
    s_add_u32 s60, s60, s55
    s_add_u32 m0, s54, 2048
    s_nop 0
    buffer_load_dwordx4 v8, s[4:7], s60 offen lds
    s_add_u32 s60, s60, s55
    s_add_u32 m0, s54, 3072
    s_nop 0
    buffer_load_dwordx4 v8, s[4:7], s60 offen lds
K2_wt_skip1:
    s_cmp_eq_u32 s48, 3
    s_cbranch_scc0 K2_pfend
    v_add_u32 v9, 0, v1
    v_min_u32 v9, 111, v9
    v_lshrrev_b32 v10, 3, v9
    v_lshlrev_b32 v10, 13, v10
    v_and_b32 v11, 7, v9
    v_lshl_add_u32 v10, v11, 7, v10
    s_mul_i32 s53, s52, 114688
    s_lshl_b32 s54, s51, 10
    s_add_u32 s53, s53, s54
    buffer_load_dword v6, v10, s[28:31], s53 offen
    v_add_u32 v9, 64, v1
    v_min_u32 v9, 111, v9
    v_lshrrev_b32 v10, 3, v9
    v_lshlrev_b32 v10, 13, v10
    v_and_b32 v11, 7, v9
    v_lshl_add_u32 v10, v11, 7, v10
    s_mul_i32 s53, s52, 114688
    s_lshl_b32 s54, s51, 10
    s_add_u32 s53, s53, s54
    buffer_load_dword v7, v10, s[28:31], s53 offen
K2_pfend:
    s_cmp_eq_u32 s48, 2
    s_cbranch_scc0 K2_pfend2
    s_getpc_b64 s[70:71]
K2_pc:
    s_sub_u32 s70, s70, K2_pc-code_begin
    s_subb_u32 s71, s71, 0
    v_and_b32 v9, 15, v1
    v_lshlrev_b32 v9, 7, v9
    s_lshl_b32 s53, s52, 11
    v_add_u32 v9, s53, v9
    v_min_u32 v9, code_end-code_begin-4, v9
    global_load_dword v6, v9, s[70:71]
K2_pfend2:
    s_waitcnt vmcnt(37)
    v_lshlrev_b32 v16, 16, v128
    v_and_b32 v17, s65, v128
    v_lshlrev_b32 v18, 16, v129
    v_and_b32 v19, s65, v129
    v_lshlrev_b32 v20, 16, v130
    v_and_b32 v21, s65, v130
    v_lshlrev_b32 v22, 16, v131
    v_and_b32 v23, s65, v131
    s_waitcnt vmcnt(36)
    v_lshlrev_b32 v24, 16, v132
    v_and_b32 v25, s65, v132
    v_lshlrev_b32 v26, 16, v133
    v_and_b32 v27, s65, v133
    v_lshlrev_b32 v28, 16, v134
    v_and_b32 v29, s65, v134
    v_lshlrev_b32 v30, 16, v135
    v_and_b32 v31, s65, v135
    s_waitcnt vmcnt(35)
    v_lshlrev_b32 v32, 16, v136
    v_and_b32 v33, s65, v136
    v_lshlrev_b32 v34, 16, v137
    v_and_b32 v35, s65, v137
    v_lshlrev_b32 v36, 16, v138
    v_and_b32 v37, s65, v138
    v_lshlrev_b32 v38, 16, v139
    v_and_b32 v39, s65, v139
    s_waitcnt vmcnt(34)
    v_lshlrev_b32 v40, 16, v140
    v_and_b32 v41, s65, v140
    v_lshlrev_b32 v42, 16, v141
    v_and_b32 v43, s65, v141
    v_lshlrev_b32 v44, 16, v142
    v_and_b32 v45, s65, v142
    v_lshlrev_b32 v46, 16, v143
    v_and_b32 v47, s65, v143
    s_waitcnt vmcnt(33)
    v_lshlrev_b32 v48, 16, v144
    v_and_b32 v49, s65, v144
    v_lshlrev_b32 v50, 16, v145
    v_and_b32 v51, s65, v145
    v_lshlrev_b32 v52, 16, v146
    v_and_b32 v53, s65, v146
    v_lshlrev_b32 v54, 16, v147
    v_and_b32 v55, s65, v147
    s_waitcnt vmcnt(32)
    v_lshlrev_b32 v56, 16, v148
    v_and_b32 v57, s65, v148
    v_lshlrev_b32 v58, 16, v149
    v_and_b32 v59, s65, v149
    v_lshlrev_b32 v60, 16, v150
    v_and_b32 v61, s65, v150
    v_lshlrev_b32 v62, 16, v151
    v_and_b32 v63, s65, v151
    s_waitcnt vmcnt(31)
    v_lshlrev_b32 v64, 16, v152
    v_and_b32 v65, s65, v152
    v_lshlrev_b32 v66, 16, v153
    v_and_b32 v67, s65, v153
    v_lshlrev_b32 v68, 16, v154
    v_and_b32 v69, s65, v154
    v_lshlrev_b32 v70, 16, v155
    v_and_b32 v71, s65, v155
    s_waitcnt vmcnt(30)
    v_lshlrev_b32 v72, 16, v156
    v_and_b32 v73, s65, v156
    v_lshlrev_b32 v74, 16, v157
    v_and_b32 v75, s65, v157
    v_lshlrev_b32 v76, 16, v158
    v_and_b32 v77, s65, v158
    v_lshlrev_b32 v78, 16, v159
    v_and_b32 v79, s65, v159
    s_waitcnt vmcnt(29)
    v_lshlrev_b32 v80, 16, v160
    v_and_b32 v81, s65, v160
    v_lshlrev_b32 v82, 16, v161
    v_and_b32 v83, s65, v161
    v_lshlrev_b32 v84, 16, v162
    v_and_b32 v85, s65, v162
    v_lshlrev_b32 v86, 16, v163
    v_and_b32 v87, s65, v163
    s_waitcnt vmcnt(28)
    v_lshlrev_b32 v88, 16, v164
    v_and_b32 v89, s65, v164
    v_lshlrev_b32 v90, 16, v165
    v_and_b32 v91, s65, v165
    v_lshlrev_b32 v92, 16, v166
    v_and_b32 v93, s65, v166
    v_lshlrev_b32 v94, 16, v167
    v_and_b32 v95, s65, v167
    s_waitcnt vmcnt(27)
    v_lshlrev_b32 v96, 16, v168
    v_and_b32 v97, s65, v168
    v_lshlrev_b32 v98, 16, v169
    v_and_b32 v99, s65, v169
    v_lshlrev_b32 v100, 16, v170
    v_and_b32 v101, s65, v170
    v_lshlrev_b32 v102, 16, v171
    v_and_b32 v103, s65, v171
    s_waitcnt vmcnt(26)
    v_lshlrev_b32 v104, 16, v172
    v_and_b32 v105, s65, v172
    v_lshlrev_b32 v106, 16, v173
    v_and_b32 v107, s65, v173
    v_lshlrev_b32 v108, 16, v174
    v_and_b32 v109, s65, v174
    v_lshlrev_b32 v110, 16, v175
    v_and_b32 v111, s65, v175
    s_waitcnt vmcnt(25)
    v_lshlrev_b32 v112, 16, v176
    v_and_b32 v113, s65, v176
    v_lshlrev_b32 v114, 16, v177
    v_and_b32 v115, s65, v177
    v_lshlrev_b32 v116, 16, v178
    v_and_b32 v117, s65, v178
    v_lshlrev_b32 v118, 16, v179
    v_and_b32 v119, s65, v179
    s_waitcnt vmcnt(24)
    v_lshlrev_b32 v120, 16, v180
    v_and_b32 v121, s65, v180
    v_lshlrev_b32 v122, 16, v181
    v_and_b32 v123, s65, v181
    v_lshlrev_b32 v124, 16, v182
    v_and_b32 v125, s65, v182
    v_lshlrev_b32 v126, 16, v183
    v_and_b32 v127, s65, v183
    v_pk_add_f32 v[8:9], v[16:17], v[18:19]
    v_pk_add_f32 v[10:11], v[20:21], v[22:23]
    v_pk_add_f32 v[8:9], v[8:9], v[24:25]
    v_pk_add_f32 v[10:11], v[10:11], v[26:27]
    v_pk_add_f32 v[8:9], v[8:9], v[28:29]
    v_pk_add_f32 v[10:11], v[10:11], v[30:31]
    v_pk_add_f32 v[8:9], v[8:9], v[32:33]
    v_pk_add_f32 v[10:11], v[10:11], v[34:35]
    v_pk_add_f32 v[8:9], v[8:9], v[36:37]
    v_pk_add_f32 v[10:11], v[10:11], v[38:39]
    v_pk_add_f32 v[8:9], v[8:9], v[40:41]
    v_pk_add_f32 v[10:11], v[10:11], v[42:43]
    v_pk_add_f32 v[8:9], v[8:9], v[44:45]
    v_pk_add_f32 v[10:11], v[10:11], v[46:47]
    v_pk_add_f32 v[8:9], v[8:9], v[48:49]
    v_pk_add_f32 v[10:11], v[10:11], v[50:51]
    v_pk_add_f32 v[8:9], v[8:9], v[52:53]
    v_pk_add_f32 v[10:11], v[10:11], v[54:55]
    v_pk_add_f32 v[8:9], v[8:9], v[56:57]
    v_pk_add_f32 v[10:11], v[10:11], v[58:59]
    v_pk_add_f32 v[8:9], v[8:9], v[60:61]
    v_pk_add_f32 v[10:11], v[10:11], v[62:63]
    v_pk_add_f32 v[8:9], v[8:9], v[64:65]
    v_pk_add_f32 v[10:11], v[10:11], v[66:67]
    v_pk_add_f32 v[8:9], v[8:9], v[68:69]
    v_pk_add_f32 v[10:11], v[10:11], v[70:71]
    v_pk_add_f32 v[8:9], v[8:9], v[72:73]
    v_pk_add_f32 v[10:11], v[10:11], v[74:75]
    v_pk_add_f32 v[8:9], v[8:9], v[76:77]
    v_pk_add_f32 v[10:11], v[10:11], v[78:79]
    v_pk_add_f32 v[8:9], v[8:9], v[80:81]
    v_pk_add_f32 v[10:11], v[10:11], v[82:83]
    v_pk_add_f32 v[8:9], v[8:9], v[84:85]
    v_pk_add_f32 v[10:11], v[10:11], v[86:87]
    v_pk_add_f32 v[8:9], v[8:9], v[88:89]
    v_pk_add_f32 v[10:11], v[10:11], v[90:91]
    v_pk_add_f32 v[8:9], v[8:9], v[92:93]
    v_pk_add_f32 v[10:11], v[10:11], v[94:95]
    v_pk_add_f32 v[8:9], v[8:9], v[96:97]
    v_pk_add_f32 v[10:11], v[10:11], v[98:99]
    v_pk_add_f32 v[8:9], v[8:9], v[100:101]
    v_pk_add_f32 v[10:11], v[10:11], v[102:103]
    v_pk_add_f32 v[8:9], v[8:9], v[104:105]
    v_pk_add_f32 v[10:11], v[10:11], v[106:107]
    v_pk_add_f32 v[8:9], v[8:9], v[108:109]
    v_pk_add_f32 v[10:11], v[10:11], v[110:111]
    v_pk_add_f32 v[8:9], v[8:9], v[112:113]
    v_pk_add_f32 v[10:11], v[10:11], v[114:115]
    v_pk_add_f32 v[8:9], v[8:9], v[116:117]
    v_pk_add_f32 v[10:11], v[10:11], v[118:119]
    v_pk_add_f32 v[8:9], v[8:9], v[120:121]
    v_pk_add_f32 v[10:11], v[10:11], v[122:123]
    v_pk_add_f32 v[8:9], v[8:9], v[124:125]
    v_pk_add_f32 v[10:11], v[10:11], v[126:127]
    v_pk_add_f32 v[8:9], v[8:9], v[10:11]
    v_add_f32 v8, v8, v9
    v_mov_b32 v9, v8
    s_nop 1
    v_permlane16_swap_b32 v8, v9
    s_nop 1
    v_add_f32 v8, v8, v9
    v_mov_b32 v9, v8
    s_nop 1
    v_permlane32_swap_b32 v8, v9
    s_nop 1
    v_add_f32 v8, v8, v9
    v_mul_f32 v8, 0x3b124925, v8
    v_pk_add_f32 v[16:17], v[16:17], v[8:9] op_sel_hi:[1,0] neg_lo:[0,1] neg_hi:[0,1]
    v_pk_add_f32 v[18:19], v[18:19], v[8:9] op_sel_hi:[1,0] neg_lo:[0,1] neg_hi:[0,1]
    v_pk_add_f32 v[20:21], v[20:21], v[8:9] op_sel_hi:[1,0] neg_lo:[0,1] neg_hi:[0,1]
    v_pk_add_f32 v[22:23], v[22:23], v[8:9] op_sel_hi:[1,0] neg_lo:[0,1] neg_hi:[0,1]
    v_pk_add_f32 v[24:25], v[24:25], v[8:9] op_sel_hi:[1,0] neg_lo:[0,1] neg_hi:[0,1]
    v_pk_add_f32 v[26:27], v[26:27], v[8:9] op_sel_hi:[1,0] neg_lo:[0,1] neg_hi:[0,1]
    v_pk_add_f32 v[28:29], v[28:29], v[8:9] op_sel_hi:[1,0] neg_lo:[0,1] neg_hi:[0,1]
    v_pk_add_f32 v[30:31], v[30:31], v[8:9] op_sel_hi:[1,0] neg_lo:[0,1] neg_hi:[0,1]
    v_pk_add_f32 v[32:33], v[32:33], v[8:9] op_sel_hi:[1,0] neg_lo:[0,1] neg_hi:[0,1]
    v_pk_add_f32 v[34:35], v[34:35], v[8:9] op_sel_hi:[1,0] neg_lo:[0,1] neg_hi:[0,1]
    v_pk_add_f32 v[36:37], v[36:37], v[8:9] op_sel_hi:[1,0] neg_lo:[0,1] neg_hi:[0,1]
    v_pk_add_f32 v[38:39], v[38:39], v[8:9] op_sel_hi:[1,0] neg_lo:[0,1] neg_hi:[0,1]
    v_pk_add_f32 v[40:41], v[40:41], v[8:9] op_sel_hi:[1,0] neg_lo:[0,1] neg_hi:[0,1]
    v_pk_add_f32 v[42:43], v[42:43], v[8:9] op_sel_hi:[1,0] neg_lo:[0,1] neg_hi:[0,1]
    v_pk_add_f32 v[44:45], v[44:45], v[8:9] op_sel_hi:[1,0] neg_lo:[0,1] neg_hi:[0,1]
    v_pk_add_f32 v[46:47], v[46:47], v[8:9] op_sel_hi:[1,0] neg_lo:[0,1] neg_hi:[0,1]
    v_pk_add_f32 v[48:49], v[48:49], v[8:9] op_sel_hi:[1,0] neg_lo:[0,1] neg_hi:[0,1]
    v_pk_add_f32 v[50:51], v[50:51], v[8:9] op_sel_hi:[1,0] neg_lo:[0,1] neg_hi:[0,1]
    v_pk_add_f32 v[52:53], v[52:53], v[8:9] op_sel_hi:[1,0] neg_lo:[0,1] neg_hi:[0,1]
    v_pk_add_f32 v[54:55], v[54:55], v[8:9] op_sel_hi:[1,0] neg_lo:[0,1] neg_hi:[0,1]
    v_pk_add_f32 v[56:57], v[56:57], v[8:9] op_sel_hi:[1,0] neg_lo:[0,1] neg_hi:[0,1]
    v_pk_add_f32 v[58:59], v[58:59], v[8:9] op_sel_hi:[1,0] neg_lo:[0,1] neg_hi:[0,1]
    v_pk_add_f32 v[60:61], v[60:61], v[8:9] op_sel_hi:[1,0] neg_lo:[0,1] neg_hi:[0,1]
    v_pk_add_f32 v[62:63], v[62:63], v[8:9] op_sel_hi:[1,0] neg_lo:[0,1] neg_hi:[0,1]
    v_pk_add_f32 v[64:65], v[64:65], v[8:9] op_sel_hi:[1,0] neg_lo:[0,1] neg_hi:[0,1]
    v_pk_add_f32 v[66:67], v[66:67], v[8:9] op_sel_hi:[1,0] neg_lo:[0,1] neg_hi:[0,1]
    v_pk_add_f32 v[68:69], v[68:69], v[8:9] op_sel_hi:[1,0] neg_lo:[0,1] neg_hi:[0,1]
    v_pk_add_f32 v[70:71], v[70:71], v[8:9] op_sel_hi:[1,0] neg_lo:[0,1] neg_hi:[0,1]
    v_pk_add_f32 v[72:73], v[72:73], v[8:9] op_sel_hi:[1,0] neg_lo:[0,1] neg_hi:[0,1]
    v_pk_add_f32 v[74:75], v[74:75], v[8:9] op_sel_hi:[1,0] neg_lo:[0,1] neg_hi:[0,1]
    v_pk_add_f32 v[76:77], v[76:77], v[8:9] op_sel_hi:[1,0] neg_lo:[0,1] neg_hi:[0,1]
    v_pk_add_f32 v[78:79], v[78:79], v[8:9] op_sel_hi:[1,0] neg_lo:[0,1] neg_hi:[0,1]
    v_pk_add_f32 v[80:81], v[80:81], v[8:9] op_sel_hi:[1,0] neg_lo:[0,1] neg_hi:[0,1]
    v_pk_add_f32 v[82:83], v[82:83], v[8:9] op_sel_hi:[1,0] neg_lo:[0,1] neg_hi:[0,1]
    v_pk_add_f32 v[84:85], v[84:85], v[8:9] op_sel_hi:[1,0] neg_lo:[0,1] neg_hi:[0,1]
    v_pk_add_f32 v[86:87], v[86:87], v[8:9] op_sel_hi:[1,0] neg_lo:[0,1] neg_hi:[0,1]
    v_pk_add_f32 v[88:89], v[88:89], v[8:9] op_sel_hi:[1,0] neg_lo:[0,1] neg_hi:[0,1]
    v_pk_add_f32 v[90:91], v[90:91], v[8:9] op_sel_hi:[1,0] neg_lo:[0,1] neg_hi:[0,1]
    v_pk_add_f32 v[92:93], v[92:93], v[8:9] op_sel_hi:[1,0] neg_lo:[0,1] neg_hi:[0,1]
    v_pk_add_f32 v[94:95], v[94:95], v[8:9] op_sel_hi:[1,0] neg_lo:[0,1] neg_hi:[0,1]
    v_pk_add_f32 v[96:97], v[96:97], v[8:9] op_sel_hi:[1,0] neg_lo:[0,1] neg_hi:[0,1]
    v_pk_add_f32 v[98:99], v[98:99], v[8:9] op_sel_hi:[1,0] neg_lo:[0,1] neg_hi:[0,1]
    v_pk_add_f32 v[100:101], v[100:101], v[8:9] op_sel_hi:[1,0] neg_lo:[0,1] neg_hi:[0,1]
    v_pk_add_f32 v[102:103], v[102:103], v[8:9] op_sel_hi:[1,0] neg_lo:[0,1] neg_hi:[0,1]
    v_pk_add_f32 v[104:105], v[104:105], v[8:9] op_sel_hi:[1,0] neg_lo:[0,1] neg_hi:[0,1]
    v_pk_add_f32 v[106:107], v[106:107], v[8:9] op_sel_hi:[1,0] neg_lo:[0,1] neg_hi:[0,1]
    v_pk_add_f32 v[108:109], v[108:109], v[8:9] op_sel_hi:[1,0] neg_lo:[0,1] neg_hi:[0,1]
    v_pk_add_f32 v[110:111], v[110:111], v[8:9] op_sel_hi:[1,0] neg_lo:[0,1] neg_hi:[0,1]
    v_pk_add_f32 v[112:113], v[112:113], v[8:9] op_sel_hi:[1,0] neg_lo:[0,1] neg_hi:[0,1]
    v_pk_add_f32 v[114:115], v[114:115], v[8:9] op_sel_hi:[1,0] neg_lo:[0,1] neg_hi:[0,1]
    v_pk_add_f32 v[116:117], v[116:117], v[8:9] op_sel_hi:[1,0] neg_lo:[0,1] neg_hi:[0,1]
    v_pk_add_f32 v[118:119], v[118:119], v[8:9] op_sel_hi:[1,0] neg_lo:[0,1] neg_hi:[0,1]
    v_pk_add_f32 v[120:121], v[120:121], v[8:9] op_sel_hi:[1,0] neg_lo:[0,1] neg_hi:[0,1]
    v_pk_add_f32 v[122:123], v[122:123], v[8:9] op_sel_hi:[1,0] neg_lo:[0,1] neg_hi:[0,1]
    v_pk_add_f32 v[124:125], v[124:125], v[8:9] op_sel_hi:[1,0] neg_lo:[0,1] neg_hi:[0,1]
    v_pk_add_f32 v[126:127], v[126:127], v[8:9] op_sel_hi:[1,0] neg_lo:[0,1] neg_hi:[0,1]
    v_pk_mul_f32 v[10:11], v[16:17], v[16:17]
    v_pk_mul_f32 v[12:13], v[18:19], v[18:19]
    v_pk_fma_f32 v[10:11], v[20:21], v[20:21], v[10:11]
    v_pk_fma_f32 v[12:13], v[22:23], v[22:23], v[12:13]
    v_pk_fma_f32 v[10:11], v[24:25], v[24:25], v[10:11]
    v_pk_fma_f32 v[12:13], v[26:27], v[26:27], v[12:13]
    v_pk_fma_f32 v[10:11], v[28:29], v[28:29], v[10:11]
    v_pk_fma_f32 v[12:13], v[30:31], v[30:31], v[12:13]
    v_pk_fma_f32 v[10:11], v[32:33], v[32:33], v[10:11]
    v_pk_fma_f32 v[12:13], v[34:35], v[34:35], v[12:13]
    v_pk_fma_f32 v[10:11], v[36:37], v[36:37], v[10:11]
    v_pk_fma_f32 v[12:13], v[38:39], v[38:39], v[12:13]
    v_pk_fma_f32 v[10:11], v[40:41], v[40:41], v[10:11]
    v_pk_fma_f32 v[12:13], v[42:43], v[42:43], v[12:13]
    v_pk_fma_f32 v[10:11], v[44:45], v[44:45], v[10:11]
    v_pk_fma_f32 v[12:13], v[46:47], v[46:47], v[12:13]
    v_pk_fma_f32 v[10:11], v[48:49], v[48:49], v[10:11]
    v_pk_fma_f32 v[12:13], v[50:51], v[50:51], v[12:13]
    v_pk_fma_f32 v[10:11], v[52:53], v[52:53], v[10:11]
    v_pk_fma_f32 v[12:13], v[54:55], v[54:55], v[12:13]
    v_pk_fma_f32 v[10:11], v[56:57], v[56:57], v[10:11]
    v_pk_fma_f32 v[12:13], v[58:59], v[58:59], v[12:13]
    v_pk_fma_f32 v[10:11], v[60:61], v[60:61], v[10:11]
    v_pk_fma_f32 v[12:13], v[62:63], v[62:63], v[12:13]
    v_pk_fma_f32 v[10:11], v[64:65], v[64:65], v[10:11]
    v_pk_fma_f32 v[12:13], v[66:67], v[66:67], v[12:13]
    v_pk_fma_f32 v[10:11], v[68:69], v[68:69], v[10:11]
    v_pk_fma_f32 v[12:13], v[70:71], v[70:71], v[12:13]
    v_pk_fma_f32 v[10:11], v[72:73], v[72:73], v[10:11]
    v_pk_fma_f32 v[12:13], v[74:75], v[74:75], v[12:13]
    v_pk_fma_f32 v[10:11], v[76:77], v[76:77], v[10:11]
    v_pk_fma_f32 v[12:13], v[78:79], v[78:79], v[12:13]
    v_pk_fma_f32 v[10:11], v[80:81], v[80:81], v[10:11]
    v_pk_fma_f32 v[12:13], v[82:83], v[82:83], v[12:13]
    v_pk_fma_f32 v[10:11], v[84:85], v[84:85], v[10:11]
    v_pk_fma_f32 v[12:13], v[86:87], v[86:87], v[12:13]
    v_pk_fma_f32 v[10:11], v[88:89], v[88:89], v[10:11]
    v_pk_fma_f32 v[12:13], v[90:91], v[90:91], v[12:13]
    v_pk_fma_f32 v[10:11], v[92:93], v[92:93], v[10:11]
    v_pk_fma_f32 v[12:13], v[94:95], v[94:95], v[12:13]
    v_pk_fma_f32 v[10:11], v[96:97], v[96:97], v[10:11]
    v_pk_fma_f32 v[12:13], v[98:99], v[98:99], v[12:13]
    v_pk_fma_f32 v[10:11], v[100:101], v[100:101], v[10:11]
    v_pk_fma_f32 v[12:13], v[102:103], v[102:103], v[12:13]
    v_pk_fma_f32 v[10:11], v[104:105], v[104:105], v[10:11]
    v_pk_fma_f32 v[12:13], v[106:107], v[106:107], v[12:13]
    v_pk_fma_f32 v[10:11], v[108:109], v[108:109], v[10:11]
    v_pk_fma_f32 v[12:13], v[110:111], v[110:111], v[12:13]
    v_pk_fma_f32 v[10:11], v[112:113], v[112:113], v[10:11]
    v_pk_fma_f32 v[12:13], v[114:115], v[114:115], v[12:13]
    v_pk_fma_f32 v[10:11], v[116:117], v[116:117], v[10:11]
    v_pk_fma_f32 v[12:13], v[118:119], v[118:119], v[12:13]
    v_pk_fma_f32 v[10:11], v[120:121], v[120:121], v[10:11]
    v_pk_fma_f32 v[12:13], v[122:123], v[122:123], v[12:13]
    v_pk_fma_f32 v[10:11], v[124:125], v[124:125], v[10:11]
    v_pk_fma_f32 v[12:13], v[126:127], v[126:127], v[12:13]
    v_pk_add_f32 v[10:11], v[10:11], v[12:13]
    v_add_f32 v10, v10, v11
    v_mov_b32 v11, v10
    s_nop 1
    v_permlane16_swap_b32 v10, v11
    s_nop 1
    v_add_f32 v10, v10, v11
    v_mov_b32 v11, v10
    s_nop 1
    v_permlane32_swap_b32 v10, v11
    s_nop 1
    v_add_f32 v10, v10, v11
    v_mov_b32 v11, 0x3727c5ac
    v_fmac_f32 v11, 0x3b124925, v10
    v_rsq_f32 v10, v11
    s_nop 0
    v_pk_mul_f32 v[16:17], v[16:17], v[10:11] op_sel_hi:[1,0]
    v_pk_mul_f32 v[18:19], v[18:19], v[10:11] op_sel_hi:[1,0]
    v_pk_mul_f32 v[20:21], v[20:21], v[10:11] op_sel_hi:[1,0]
    v_pk_mul_f32 v[22:23], v[22:23], v[10:11] op_sel_hi:[1,0]
    v_pk_mul_f32 v[24:25], v[24:25], v[10:11] op_sel_hi:[1,0]
    v_pk_mul_f32 v[26:27], v[26:27], v[10:11] op_sel_hi:[1,0]
    v_pk_mul_f32 v[28:29], v[28:29], v[10:11] op_sel_hi:[1,0]
    v_pk_mul_f32 v[30:31], v[30:31], v[10:11] op_sel_hi:[1,0]
    v_pk_mul_f32 v[32:33], v[32:33], v[10:11] op_sel_hi:[1,0]
    v_pk_mul_f32 v[34:35], v[34:35], v[10:11] op_sel_hi:[1,0]
    v_pk_mul_f32 v[36:37], v[36:37], v[10:11] op_sel_hi:[1,0]
    v_pk_mul_f32 v[38:39], v[38:39], v[10:11] op_sel_hi:[1,0]
    v_pk_mul_f32 v[40:41], v[40:41], v[10:11] op_sel_hi:[1,0]
    v_pk_mul_f32 v[42:43], v[42:43], v[10:11] op_sel_hi:[1,0]
    v_pk_mul_f32 v[44:45], v[44:45], v[10:11] op_sel_hi:[1,0]
    v_pk_mul_f32 v[46:47], v[46:47], v[10:11] op_sel_hi:[1,0]
    v_pk_mul_f32 v[48:49], v[48:49], v[10:11] op_sel_hi:[1,0]
    v_pk_mul_f32 v[50:51], v[50:51], v[10:11] op_sel_hi:[1,0]
    v_pk_mul_f32 v[52:53], v[52:53], v[10:11] op_sel_hi:[1,0]
    v_pk_mul_f32 v[54:55], v[54:55], v[10:11] op_sel_hi:[1,0]
    v_pk_mul_f32 v[56:57], v[56:57], v[10:11] op_sel_hi:[1,0]
    v_pk_mul_f32 v[58:59], v[58:59], v[10:11] op_sel_hi:[1,0]
    v_pk_mul_f32 v[60:61], v[60:61], v[10:11] op_sel_hi:[1,0]
    v_pk_mul_f32 v[62:63], v[62:63], v[10:11] op_sel_hi:[1,0]
    v_pk_mul_f32 v[64:65], v[64:65], v[10:11] op_sel_hi:[1,0]
    v_pk_mul_f32 v[66:67], v[66:67], v[10:11] op_sel_hi:[1,0]
    v_pk_mul_f32 v[68:69], v[68:69], v[10:11] op_sel_hi:[1,0]
    v_pk_mul_f32 v[70:71], v[70:71], v[10:11] op_sel_hi:[1,0]
    v_pk_mul_f32 v[72:73], v[72:73], v[10:11] op_sel_hi:[1,0]
    v_pk_mul_f32 v[74:75], v[74:75], v[10:11] op_sel_hi:[1,0]
    v_pk_mul_f32 v[76:77], v[76:77], v[10:11] op_sel_hi:[1,0]
    v_pk_mul_f32 v[78:79], v[78:79], v[10:11] op_sel_hi:[1,0]
    v_pk_mul_f32 v[80:81], v[80:81], v[10:11] op_sel_hi:[1,0]
    v_pk_mul_f32 v[82:83], v[82:83], v[10:11] op_sel_hi:[1,0]
    v_pk_mul_f32 v[84:85], v[84:85], v[10:11] op_sel_hi:[1,0]
    v_pk_mul_f32 v[86:87], v[86:87], v[10:11] op_sel_hi:[1,0]
    v_pk_mul_f32 v[88:89], v[88:89], v[10:11] op_sel_hi:[1,0]
    v_pk_mul_f32 v[90:91], v[90:91], v[10:11] op_sel_hi:[1,0]
    v_pk_mul_f32 v[92:93], v[92:93], v[10:11] op_sel_hi:[1,0]
    v_pk_mul_f32 v[94:95], v[94:95], v[10:11] op_sel_hi:[1,0]
    v_pk_mul_f32 v[96:97], v[96:97], v[10:11] op_sel_hi:[1,0]
    v_pk_mul_f32 v[98:99], v[98:99], v[10:11] op_sel_hi:[1,0]
    v_pk_mul_f32 v[100:101], v[100:101], v[10:11] op_sel_hi:[1,0]
    v_pk_mul_f32 v[102:103], v[102:103], v[10:11] op_sel_hi:[1,0]
    v_pk_mul_f32 v[104:105], v[104:105], v[10:11] op_sel_hi:[1,0]
    v_pk_mul_f32 v[106:107], v[106:107], v[10:11] op_sel_hi:[1,0]
    v_pk_mul_f32 v[108:109], v[108:109], v[10:11] op_sel_hi:[1,0]
    v_pk_mul_f32 v[110:111], v[110:111], v[10:11] op_sel_hi:[1,0]
    v_pk_mul_f32 v[112:113], v[112:113], v[10:11] op_sel_hi:[1,0]
    v_pk_mul_f32 v[114:115], v[114:115], v[10:11] op_sel_hi:[1,0]
    v_pk_mul_f32 v[116:117], v[116:117], v[10:11] op_sel_hi:[1,0]
    v_pk_mul_f32 v[118:119], v[118:119], v[10:11] op_sel_hi:[1,0]
    v_pk_mul_f32 v[120:121], v[120:121], v[10:11] op_sel_hi:[1,0]
    v_pk_mul_f32 v[122:123], v[122:123], v[10:11] op_sel_hi:[1,0]
    v_pk_mul_f32 v[124:125], v[124:125], v[10:11] op_sel_hi:[1,0]
    v_pk_mul_f32 v[126:127], v[126:127], v[10:11] op_sel_hi:[1,0]
    s_cmp_eq_u32 s57, -1
    s_cbranch_scc1 K2_wt_skip2
    s_waitcnt vmcnt(0)
    v_and_b32 v8, 1, v3
    v_lshl_add_u32 v8, v8, 2, v4
    v_lshrrev_b32 v9, 1, v3
    v_lshlrev_b32 v9, 10, v9
    v_lshl_add_u32 v9, v8, 7, v9
    v_lshl_add_u32 v9, v5, 3, v9
    s_lshl_b32 s54, s48, 12
    s_add_u32 s54, s54, 117760
    v_add_u32 v9, s54, v9
    v_lshrrev_b32 v8, 1, v8
    v_xor_b32 v10, 0, v8
    v_lshl_add_u32 v10, v10, 5, v9
    ds_read_b64_tr_b16 v[128:129], v10
    ds_read_b64_tr_b16 v[130:131], v10 offset:2048
    v_xor_b32 v10, 1, v8
    v_lshl_add_u32 v10, v10, 5, v9
    ds_read_b64_tr_b16 v[132:133], v10
    ds_read_b64_tr_b16 v[134:135], v10 offset:2048
    v_xor_b32 v10, 2, v8
    v_lshl_add_u32 v10, v10, 5, v9
    ds_read_b64_tr_b16 v[136:137], v10
    ds_read_b64_tr_b16 v[138:139], v10 offset:2048
    v_xor_b32 v10, 3, v8
    v_lshl_add_u32 v10, v10, 5, v9
    ds_read_b64_tr_b16 v[140:141], v10
    ds_read_b64_tr_b16 v[142:143], v10 offset:2048
    s_add_u32 s4, s14, 0
    s_addc_u32 s5, s15, 0
    s_and_b32 s5, s5, 0xffff
    s_mov_b32 s6, 30965760
    s_mov_b32 s7, 0x00020000
    v_lshlrev_b32 v10, 4, v1
    s_waitcnt lgkmcnt(0)
    buffer_store_dwordx4 v[128:131], v10, s[4:7], s61 offen sc0 sc1
    s_add_u32 s61, s61, s62
    buffer_store_dwordx4 v[132:135], v10, s[4:7], s61 offen sc0 sc1
    s_add_u32 s61, s61, s62
    buffer_store_dwordx4 v[136:139], v10, s[4:7], s61 offen sc0 sc1
    s_add_u32 s61, s61, s62
    buffer_store_dwordx4 v[140:143], v10, s[4:7], s61 offen sc0 sc1
K2_wt_skip2:
    s_cmp_lg_u32 s48, 0
    s_cbranch_scc1 K2_gotpar
    v_min_u32 v12, 55, v1
    v_lshrrev_b32 v13, 2, v12
    v_lshlrev_b32 v13, 2, v13
    v_lshlrev_b32 v10, 7, v12
    v_lshlrev_b32 v11, 6, v12
    v_add_u32 v11, 158720, v11
    s_mov_b32 s54, 32768
    s_mov_b32 s55, 0x100000
K2_poll:
    buffer_load_dword v9, v13, s[92:95], 0 offen sc0 sc1
    buffer_load_dwordx4 v[128:131], v10, s[36:39], s54 offen offset:0 sc0 sc1
    buffer_load_dwordx4 v[132:135], v10, s[36:39], s54 offen offset:16 sc0 sc1
    buffer_load_dwordx4 v[136:139], v10, s[36:39], s54 offen offset:32 sc0 sc1
    buffer_load_dwordx4 v[140:143], v10, s[36:39], s54 offen offset:48 sc0 sc1
    buffer_load_dwordx4 v[144:147], v10, s[36:39], s54 offen offset:64 sc0 sc1
    buffer_load_dwordx4 v[148:151], v10, s[36:39], s54 offen offset:80 sc0 sc1
    buffer_load_dwordx4 v[152:155], v10, s[36:39], s54 offen offset:96 sc0 sc1
    buffer_load_dwordx4 v[156:159], v10, s[36:39], s54 offen offset:112 sc0 sc1
    s_waitcnt vmcnt(0)
    v_xor_b32 v129, v129, v9
    v_xor_b32 v131, v131, v9
    v_xor_b32 v133, v133, v9
    v_xor_b32 v135, v135, v9
    v_xor_b32 v137, v137, v9
    v_xor_b32 v139, v139, v9
    v_xor_b32 v141, v141, v9
    v_xor_b32 v143, v143, v9
    v_xor_b32 v145, v145, v9
    v_xor_b32 v147, v147, v9
    v_xor_b32 v149, v149, v9
    v_xor_b32 v151, v151, v9
    v_xor_b32 v153, v153, v9
    v_xor_b32 v155, v155, v9
    v_xor_b32 v157, v157, v9
    v_xor_b32 v159, v159, v9
    v_or3_b32 v8, v129, v131, v133
    v_or3_b32 v8, v8, v135, v137
    v_or3_b32 v8, v8, v139, v141
    v_or3_b32 v8, v8, v143, v145
    v_or3_b32 v8, v8, v147, v149
    v_or3_b32 v8, v8, v151, v153
    v_or3_b32 v8, v8, v155, v157
    v_or_b32 v8, v8, v159
    v_cmp_ne_u32 vcc, 0, v8
    v_cmp_eq_u32 s[4:5], 0, v9
    s_nop 1
    s_or_b64 s[4:5], s[4:5], vcc
    s_cbranch_scc0 K2_polled
    s_sleep 1
    s_sub_u32 s55, s55, 1
    s_cmp_lg_u32 s55, 0
    s_cbranch_scc1 K2_poll
K2_polled:
    ds_write2_b32 v11, v128, v130 offset0:0 offset1:1
    ds_write2_b32 v11, v132, v134 offset0:2 offset1:3
    ds_write2_b32 v11, v136, v138 offset0:4 offset1:5
    ds_write2_b32 v11, v140, v142 offset0:6 offset1:7
    ds_write2_b32 v11, v144, v146 offset0:8 offset1:9
    ds_write2_b32 v11, v148, v150 offset0:10 offset1:11
    ds_write2_b32 v11, v152, v154 offset0:12 offset1:13
    ds_write2_b32 v11, v156, v158 offset0:14 offset1:15
    s_waitcnt lgkmcnt(0)
K2_gotpar:
    s_barrier
    s_mul_i32 s53, s48, 14336
    s_add_u32 s53, s53, 101376
    v_and_b32 v12, 1, v3
    v_lshlrev_b32 v12, 9, v12
    v_lshl_add_u32 v12, v2, 4, v12
    v_lshrrev_b32 v13, 1, v3
    v_lshl_add_u32 v12, v13, 3, v12
    v_add_u32 v12, s53, v12
    v_lshlrev_b32 v13, 5, v3
    v_add_u32 v13, 158720, v13
    ds_read_b128 v[128:131], v13 offset:1792
    ds_read_b128 v[132:135], v13 offset:1808
    ds_read_b128 v[136:139], v13 offset:0
    ds_read_b128 v[140:143], v13 offset:16
    ds_read_b128 v[144:147], v13 offset:1920
    ds_read_b128 v[148:151], v13 offset:1936
    ds_read_b128 v[152:155], v13 offset:128
    ds_read_b128 v[156:159], v13 offset:144
    ds_read_b128 v[160:163], v13 offset:2048
    ds_read_b128 v[164:167], v13 offset:2064
    ds_read_b128 v[168:171], v13 offset:256
    ds_read_b128 v[172:175], v13 offset:272
    ds_read_b128 v[176:179], v13 offset:2176
    ds_read_b128 v[180:183], v13 offset:2192
    ds_read_b128 v[184:187], v13 offset:384
    ds_read_b128 v[188:191], v13 offset:400
    s_waitcnt lgkmcnt(13)
    v_pk_fma_f32 v[16:17], v[16:17], v[128:129], v[136:137]
    v_pk_fma_f32 v[18:19], v[18:19], v[130:131], v[138:139]
    s_waitcnt lgkmcnt(12)
    v_pk_fma_f32 v[20:21], v[20:21], v[132:133], v[140:141]
    v_pk_fma_f32 v[22:23], v[22:23], v[134:135], v[142:143]
    v_cvt_pk_bf16_f32 v16, v16, v17
    v_cvt_pk_bf16_f32 v17, v18, v19
    v_cvt_pk_bf16_f32 v18, v20, v21
    v_cvt_pk_bf16_f32 v19, v22, v23
    ds_write_b64 v12, v[16:17] offset:0
    ds_write_b64 v12, v[18:19] offset:256
    ds_read_b128 v[128:131], v13 offset:2304
    ds_read_b128 v[132:135], v13 offset:2320
    ds_read_b128 v[136:139], v13 offset:512
    ds_read_b128 v[140:143], v13 offset:528
    s_waitcnt lgkmcnt(15)
    v_pk_fma_f32 v[24:25], v[24:25], v[144:145], v[152:153]
    v_pk_fma_f32 v[26:27], v[26:27], v[146:147], v[154:155]
    s_waitcnt lgkmcnt(14)
    v_pk_fma_f32 v[28:29], v[28:29], v[148:149], v[156:157]
    v_pk_fma_f32 v[30:31], v[30:31], v[150:151], v[158:159]
    v_cvt_pk_bf16_f32 v24, v24, v25
    v_cvt_pk_bf16_f32 v25, v26, v27
    v_cvt_pk_bf16_f32 v26, v28, v29
    v_cvt_pk_bf16_f32 v27, v30, v31
    ds_write_b64 v12, v[24:25] offset:1024
    ds_write_b64 v12, v[26:27] offset:1280
    ds_read_b128 v[144:147], v13 offset:2432
    ds_read_b128 v[148:151], v13 offset:2448
    ds_read_b128 v[152:155], v13 offset:640
    ds_read_b128 v[156:159], v13 offset:656
    s_waitcnt lgkmcnt(15)
    v_pk_fma_f32 v[32:33], v[32:33], v[160:161], v[168:169]
    v_pk_fma_f32 v[34:35], v[34:35], v[162:163], v[170:171]
    v_pk_fma_f32 v[36:37], v[36:37], v[164:165], v[172:173]
    v_pk_fma_f32 v[38:39], v[38:39], v[166:167], v[174:175]
    v_cvt_pk_bf16_f32 v32, v32, v33
    v_cvt_pk_bf16_f32 v33, v34, v35
    v_cvt_pk_bf16_f32 v34, v36, v37
    v_cvt_pk_bf16_f32 v35, v38, v39
    ds_write_b64 v12, v[32:33] offset:2048
    ds_write_b64 v12, v[34:35] offset:2304
    ds_read_b128 v[160:163], v13 offset:2560
    ds_read_b128 v[164:167], v13 offset:2576
    ds_read_b128 v[168:171], v13 offset:768
    ds_read_b128 v[172:175], v13 offset:784
    s_waitcnt lgkmcnt(15)
    v_pk_fma_f32 v[40:41], v[40:41], v[176:177], v[184:185]
    v_pk_fma_f32 v[42:43], v[42:43], v[178:179], v[186:187]
    v_pk_fma_f32 v[44:45], v[44:45], v[180:181], v[188:189]
    v_pk_fma_f32 v[46:47], v[46:47], v[182:183], v[190:191]
    v_cvt_pk_bf16_f32 v40, v40, v41
    v_cvt_pk_bf16_f32 v41, v42, v43
    v_cvt_pk_bf16_f32 v42, v44, v45
    v_cvt_pk_bf16_f32 v43, v46, v47
    ds_write_b64 v12, v[40:41] offset:3072
    ds_write_b64 v12, v[42:43] offset:3328
    ds_read_b128 v[176:179], v13 offset:2688
    ds_read_b128 v[180:183], v13 offset:2704
    ds_read_b128 v[184:187], v13 offset:896
    ds_read_b128 v[188:191], v13 offset:912
    s_waitcnt lgkmcnt(15)
    v_pk_fma_f32 v[48:49], v[48:49], v[128:129], v[136:137]
    v_pk_fma_f32 v[50:51], v[50:51], v[130:131], v[138:139]
    v_pk_fma_f32 v[52:53], v[52:53], v[132:133], v[140:141]
    v_pk_fma_f32 v[54:55], v[54:55], v[134:135], v[142:143]
    v_cvt_pk_bf16_f32 v48, v48, v49
    v_cvt_pk_bf16_f32 v49, v50, v51
    v_cvt_pk_bf16_f32 v50, v52, v53
    v_cvt_pk_bf16_f32 v51, v54, v55
    ds_write_b64 v12, v[48:49] offset:4096
    ds_write_b64 v12, v[50:51] offset:4352
    ds_read_b128 v[128:131], v13 offset:2816
    ds_read_b128 v[132:135], v13 offset:2832
    ds_read_b128 v[136:139], v13 offset:1024
    ds_read_b128 v[140:143], v13 offset:1040
    s_waitcnt lgkmcnt(15)
    v_pk_fma_f32 v[56:57], v[56:57], v[144:145], v[152:153]
    v_pk_fma_f32 v[58:59], v[58:59], v[146:147], v[154:155]
    v_pk_fma_f32 v[60:61], v[60:61], v[148:149], v[156:157]
    v_pk_fma_f32 v[62:63], v[62:63], v[150:151], v[158:159]
    v_cvt_pk_bf16_f32 v56, v56, v57
    v_cvt_pk_bf16_f32 v57, v58, v59
    v_cvt_pk_bf16_f32 v58, v60, v61
    v_cvt_pk_bf16_f32 v59, v62, v63
    ds_write_b64 v12, v[56:57] offset:5120
    ds_write_b64 v12, v[58:59] offset:5376
    ds_read_b128 v[144:147], v13 offset:2944
    ds_read_b128 v[148:151], v13 offset:2960
    ds_read_b128 v[152:155], v13 offset:1152
    ds_read_b128 v[156:159], v13 offset:1168
    s_waitcnt lgkmcnt(15)
    v_pk_fma_f32 v[64:65], v[64:65], v[160:161], v[168:169]
    v_pk_fma_f32 v[66:67], v[66:67], v[162:163], v[170:171]
    v_pk_fma_f32 v[68:69], v[68:69], v[164:165], v[172:173]
    v_pk_fma_f32 v[70:71], v[70:71], v[166:167], v[174:175]
    v_cvt_pk_bf16_f32 v64, v64, v65
    v_cvt_pk_bf16_f32 v65, v66, v67
    v_cvt_pk_bf16_f32 v66, v68, v69
    v_cvt_pk_bf16_f32 v67, v70, v71
    ds_write_b64 v12, v[64:65] offset:6144
    ds_write_b64 v12, v[66:67] offset:6400
    ds_read_b128 v[160:163], v13 offset:3072
    ds_read_b128 v[164:167], v13 offset:3088
    ds_read_b128 v[168:171], v13 offset:1280
    ds_read_b128 v[172:175], v13 offset:1296
    s_waitcnt lgkmcnt(15)
    v_pk_fma_f32 v[72:73], v[72:73], v[176:177], v[184:185]
    v_pk_fma_f32 v[74:75], v[74:75], v[178:179], v[186:187]
    v_pk_fma_f32 v[76:77], v[76:77], v[180:181], v[188:189]
    v_pk_fma_f32 v[78:79], v[78:79], v[182:183], v[190:191]
    v_cvt_pk_bf16_f32 v72, v72, v73
    v_cvt_pk_bf16_f32 v73, v74, v75
    v_cvt_pk_bf16_f32 v74, v76, v77
    v_cvt_pk_bf16_f32 v75, v78, v79
    ds_write_b64 v12, v[72:73] offset:7168
    ds_write_b64 v12, v[74:75] offset:7424
    ds_read_b128 v[176:179], v13 offset:3200
    ds_read_b128 v[180:183], v13 offset:3216
    ds_read_b128 v[184:187], v13 offset:1408
    ds_read_b128 v[188:191], v13 offset:1424
    s_waitcnt lgkmcnt(15)
    v_pk_fma_f32 v[80:81], v[80:81], v[128:129], v[136:137]
    v_pk_fma_f32 v[82:83], v[82:83], v[130:131], v[138:139]
    v_pk_fma_f32 v[84:85], v[84:85], v[132:133], v[140:141]
    v_pk_fma_f32 v[86:87], v[86:87], v[134:135], v[142:143]
    v_cvt_pk_bf16_f32 v80, v80, v81
    v_cvt_pk_bf16_f32 v81, v82, v83
    v_cvt_pk_bf16_f32 v82, v84, v85
    v_cvt_pk_bf16_f32 v83, v86, v87
    ds_write_b64 v12, v[80:81] offset:8192
    ds_write_b64 v12, v[82:83] offset:8448
    ds_read_b128 v[128:131], v13 offset:3328
    ds_read_b128 v[132:135], v13 offset:3344
    ds_read_b128 v[136:139], v13 offset:1536
    ds_read_b128 v[140:143], v13 offset:1552
    s_waitcnt lgkmcnt(15)
    v_pk_fma_f32 v[88:89], v[88:89], v[144:145], v[152:153]
    v_pk_fma_f32 v[90:91], v[90:91], v[146:147], v[154:155]
    v_pk_fma_f32 v[92:93], v[92:93], v[148:149], v[156:157]
    v_pk_fma_f32 v[94:95], v[94:95], v[150:151], v[158:159]
    v_cvt_pk_bf16_f32 v88, v88, v89
    v_cvt_pk_bf16_f32 v89, v90, v91
    v_cvt_pk_bf16_f32 v90, v92, v93
    v_cvt_pk_bf16_f32 v91, v94, v95
    ds_write_b64 v12, v[88:89] offset:9216
    ds_write_b64 v12, v[90:91] offset:9472
    ds_read_b128 v[144:147], v13 offset:3456
    ds_read_b128 v[148:151], v13 offset:3472
    ds_read_b128 v[152:155], v13 offset:1664
    ds_read_b128 v[156:159], v13 offset:1680
    s_waitcnt lgkmcnt(15)
    v_pk_fma_f32 v[96:97], v[96:97], v[160:161], v[168:169]
    v_pk_fma_f32 v[98:99], v[98:99], v[162:163], v[170:171]
    v_pk_fma_f32 v[100:101], v[100:101], v[164:165], v[172:173]
    v_pk_fma_f32 v[102:103], v[102:103], v[166:167], v[174:175]
    v_cvt_pk_bf16_f32 v96, v96, v97
    v_cvt_pk_bf16_f32 v97, v98, v99
    v_cvt_pk_bf16_f32 v98, v100, v101
    v_cvt_pk_bf16_f32 v99, v102, v103
    ds_write_b64 v12, v[96:97] offset:10240
    ds_write_b64 v12, v[98:99] offset:10496
    s_waitcnt lgkmcnt(15)
    v_pk_fma_f32 v[104:105], v[104:105], v[176:177], v[184:185]
    v_pk_fma_f32 v[106:107], v[106:107], v[178:179], v[186:187]
    s_waitcnt lgkmcnt(14)
    v_pk_fma_f32 v[108:109], v[108:109], v[180:181], v[188:189]
    v_pk_fma_f32 v[110:111], v[110:111], v[182:183], v[190:191]
    v_cvt_pk_bf16_f32 v104, v104, v105
    v_cvt_pk_bf16_f32 v105, v106, v107
    v_cvt_pk_bf16_f32 v106, v108, v109
    v_cvt_pk_bf16_f32 v107, v110, v111
    ds_write_b64 v12, v[104:105] offset:11264
    ds_write_b64 v12, v[106:107] offset:11520
    s_waitcnt lgkmcnt(11)
    v_pk_fma_f32 v[112:113], v[112:113], v[128:129], v[136:137]
    v_pk_fma_f32 v[114:115], v[114:115], v[130:131], v[138:139]
    s_waitcnt lgkmcnt(10)
    v_pk_fma_f32 v[116:117], v[116:117], v[132:133], v[140:141]
    v_pk_fma_f32 v[118:119], v[118:119], v[134:135], v[142:143]
    v_cvt_pk_bf16_f32 v112, v112, v113
    v_cvt_pk_bf16_f32 v113, v114, v115
    v_cvt_pk_bf16_f32 v114, v116, v117
    v_cvt_pk_bf16_f32 v115, v118, v119
    ds_write_b64 v12, v[112:113] offset:12288
    ds_write_b64 v12, v[114:115] offset:12544
    s_waitcnt lgkmcnt(7)
    v_pk_fma_f32 v[120:121], v[120:121], v[144:145], v[152:153]
    v_pk_fma_f32 v[122:123], v[122:123], v[146:147], v[154:155]
    s_waitcnt lgkmcnt(6)
    v_pk_fma_f32 v[124:125], v[124:125], v[148:149], v[156:157]
    v_pk_fma_f32 v[126:127], v[126:127], v[150:151], v[158:159]
    v_cvt_pk_bf16_f32 v120, v120, v121
    v_cvt_pk_bf16_f32 v121, v122, v123
    v_cvt_pk_bf16_f32 v122, v124, v125
    v_cvt_pk_bf16_f32 v123, v126, v127
    ds_write_b64 v12, v[120:121] offset:13312
    ds_write_b64 v12, v[122:123] offset:13568
    v_lshl_add_u32 v13, v3, 2, v4
    v_mul_u32_u24 v13, 1056, v13
    v_lshl_add_u32 v13, v5, 3, v13
    s_lshl_b32 s53, s49, 9
    s_lshl_b32 s54, s50, 8
    s_add_u32 s53, s53, s54
    v_add_u32 v13, s53, v13
    v_add_u32 v8, 33792, v13
    v_add_u32 v9, 67584, v13
    v_add_u32 v10, 0, v13
    v_lshlrev_b32 v11, 4, v1
    v_add_u32 v96, 0, v11
    v_add_u32 v97, 8192, v11
    v_add_u32 v98, 16384, v11
    v_add_u32 v99, 24576, v11
    v_add_u32 v100, 32768, v11
    v_add_u32 v101, 40960, v11
    v_add_u32 v102, 49152, v11
    v_add_u32 v103, 57344, v11
    v_add_u32 v11, 101376, v11
    v_lshrrev_b32 v15, 5, v1
    v_and_b32 v14, 31, v1
    v_xor_b32 v14, v14, v15
    v_lshlrev_b32 v14, 4, v14
    v_lshl_add_u32 v14, v15, 9, v14
    s_lshl_b32 s57, s48, 13
    s_add_u32 s58, s57, 4096
    s_mul_i32 s61, s48, 8448
    s_mul_i32 s62, s48, 8704
    s_waitcnt lgkmcnt(0)
    s_waitcnt vmcnt(16)
    s_barrier
    ds_read_b64_tr_b16 v[32:33], v8 offset:0
    ds_read_b64_tr_b16 v[34:35], v8 offset:16896
    ds_read_b64_tr_b16 v[36:37], v8 offset:32
    ds_read_b64_tr_b16 v[38:39], v8 offset:16928
    ds_read_b64_tr_b16 v[40:41], v8 offset:64
    ds_read_b64_tr_b16 v[42:43], v8 offset:16960
    ds_read_b128 v[64:67], v11 offset:0
    ds_read_b128 v[68:71], v11 offset:14336
    ds_read_b128 v[72:75], v11 offset:28672
    ds_read_b128 v[76:79], v11 offset:43008
    ds_read_b64_tr_b16 v[44:45], v8 offset:96
    ds_read_b64_tr_b16 v[46:47], v8 offset:16992
    s_waitcnt lgkmcnt(5)
    v_mfma_f32_16x16x32_bf16 v[128:131], v[32:35], v[64:67], 0
    s_waitcnt lgkmcnt(4)
    v_mfma_f32_16x16x32_bf16 v[132:135], v[32:35], v[68:71], 0
    s_waitcnt lgkmcnt(3)
    v_mfma_f32_16x16x32_bf16 v[136:139], v[32:35], v[72:75], 0
    ds_read_b128 v[80:83], v11 offset:1024
    s_waitcnt lgkmcnt(3)
    v_mfma_f32_16x16x32_bf16 v[140:143], v[32:35], v[76:79], 0
    v_mfma_f32_16x16x32_bf16 v[144:147], v[36:39], v[64:67], 0
    ds_read_b64_tr_b16 v[32:33], v8 offset:128
    ds_read_b64_tr_b16 v[34:35], v8 offset:17024
    v_mfma_f32_16x16x32_bf16 v[148:151], v[36:39], v[68:71], 0
    v_mfma_f32_16x16x32_bf16 v[152:155], v[36:39], v[72:75], 0
    ds_read_b128 v[84:87], v11 offset:15360
    v_mfma_f32_16x16x32_bf16 v[156:159], v[36:39], v[76:79], 0
    v_mfma_f32_16x16x32_bf16 v[160:163], v[40:43], v[64:67], 0
    ds_read_b64_tr_b16 v[36:37], v8 offset:160
    ds_read_b64_tr_b16 v[38:39], v8 offset:17056
    v_mfma_f32_16x16x32_bf16 v[164:167], v[40:43], v[68:71], 0
    v_mfma_f32_16x16x32_bf16 v[168:171], v[40:43], v[72:75], 0
    ds_read_b128 v[88:91], v11 offset:29696
    v_mfma_f32_16x16x32_bf16 v[172:175], v[40:43], v[76:79], 0
    s_waitcnt lgkmcnt(7)
    v_mfma_f32_16x16x32_bf16 v[176:179], v[44:47], v[64:67], 0
    ds_read_b64_tr_b16 v[40:41], v8 offset:192
    ds_read_b64_tr_b16 v[42:43], v8 offset:17088
    v_mfma_f32_16x16x32_bf16 v[180:183], v[44:47], v[68:71], 0
    v_mfma_f32_16x16x32_bf16 v[184:187], v[44:47], v[72:75], 0
    ds_read_b128 v[92:95], v11 offset:44032
    v_mfma_f32_16x16x32_bf16 v[188:191], v[44:47], v[76:79], 0
    s_waitcnt lgkmcnt(7)
    v_mfma_f32_16x16x32_bf16 v[192:195], v[32:35], v[64:67], 0
    ds_read_b64_tr_b16 v[44:45], v8 offset:224
    ds_read_b64_tr_b16 v[46:47], v8 offset:17120
    v_mfma_f32_16x16x32_bf16 v[196:199], v[32:35], v[68:71], 0
    v_mfma_f32_16x16x32_bf16 v[200:203], v[32:35], v[72:75], 0
    v_mfma_f32_16x16x32_bf16 v[204:207], v[32:35], v[76:79], 0
    s_waitcnt lgkmcnt(6)
    v_mfma_f32_16x16x32_bf16 v[208:211], v[36:39], v[64:67], 0
    v_mfma_f32_16x16x32_bf16 v[212:215], v[36:39], v[68:71], 0
    v_mfma_f32_16x16x32_bf16 v[216:219], v[36:39], v[72:75], 0
    v_mfma_f32_16x16x32_bf16 v[220:223], v[36:39], v[76:79], 0
    s_waitcnt lgkmcnt(0)
    s_waitcnt vmcnt(8)
    s_barrier
    ds_read_b64_tr_b16 v[32:33], v9 offset:0
    ds_read_b64_tr_b16 v[34:35], v9 offset:16896
    ds_read_b64_tr_b16 v[36:37], v9 offset:32
    ds_read_b64_tr_b16 v[38:39], v9 offset:16928
    v_mfma_f32_16x16x32_bf16 v[224:227], v[40:43], v[64:67], 0
    v_mfma_f32_16x16x32_bf16 v[228:231], v[40:43], v[68:71], 0
    s_add_u32 m0, s56, 33792
    s_add_u32 s67, s67, 262144
    buffer_load_dwordx4 v96, s[28:31], s67 offen lds
    v_mfma_f32_16x16x32_bf16 v[232:235], v[40:43], v[72:75], 0
    v_mfma_f32_16x16x32_bf16 v[236:239], v[40:43], v[76:79], 0
    ds_read_b64_tr_b16 v[40:41], v9 offset:64
    ds_read_b64_tr_b16 v[42:43], v9 offset:16960
    v_mfma_f32_16x16x32_bf16 v[240:243], v[44:47], v[64:67], 0
    v_mfma_f32_16x16x32_bf16 v[244:247], v[44:47], v[68:71], 0
    s_add_u32 m0, s56, 34848
    s_nop 0
    buffer_load_dwordx4 v97, s[28:31], s67 offen lds
    v_mfma_f32_16x16x32_bf16 v[248:251], v[44:47], v[72:75], 0
    v_mfma_f32_16x16x32_bf16 v[252:255], v[44:47], v[76:79], 0
    ds_read_b64_tr_b16 v[44:45], v9 offset:96
    ds_read_b64_tr_b16 v[46:47], v9 offset:16992
    s_waitcnt lgkmcnt(6)
    v_mfma_f32_16x16x32_bf16 v[128:131], v[32:35], v[80:83], v[128:131]
    v_mfma_f32_16x16x32_bf16 v[132:135], v[32:35], v[84:87], v[132:135]
    s_add_u32 m0, s56, 35904
    s_nop 0
    buffer_load_dwordx4 v98, s[28:31], s67 offen lds
    v_mfma_f32_16x16x32_bf16 v[136:139], v[32:35], v[88:91], v[136:139]
    ds_read_b128 v[64:67], v11 offset:2048
    v_mfma_f32_16x16x32_bf16 v[140:143], v[32:35], v[92:95], v[140:143]
    s_waitcnt lgkmcnt(5)
    v_mfma_f32_16x16x32_bf16 v[144:147], v[36:39], v[80:83], v[144:147]
    ds_read_b64_tr_b16 v[32:33], v9 offset:128
    ds_read_b64_tr_b16 v[34:35], v9 offset:17024
    v_mfma_f32_16x16x32_bf16 v[148:151], v[36:39], v[84:87], v[148:151]
    s_add_u32 m0, s56, 36960
    s_nop 0
    buffer_load_dwordx4 v99, s[28:31], s67 offen lds
    v_mfma_f32_16x16x32_bf16 v[152:155], v[36:39], v[88:91], v[152:155]
    ds_read_b128 v[68:71], v11 offset:16384
    v_mfma_f32_16x16x32_bf16 v[156:159], v[36:39], v[92:95], v[156:159]
    s_waitcnt lgkmcnt(6)
    v_mfma_f32_16x16x32_bf16 v[160:163], v[40:43], v[80:83], v[160:163]
    ds_read_b64_tr_b16 v[36:37], v9 offset:160
    ds_read_b64_tr_b16 v[38:39], v9 offset:17056
    v_mfma_f32_16x16x32_bf16 v[164:167], v[40:43], v[84:87], v[164:167]
    s_add_u32 m0, s56, 38016
    s_nop 0
    buffer_load_dwordx4 v100, s[28:31], s67 offen lds
    v_mfma_f32_16x16x32_bf16 v[168:171], v[40:43], v[88:91], v[168:171]
    ds_read_b128 v[72:75], v11 offset:30720
    v_accvgpr_write_b32 a0, 0
    v_mfma_f32_16x16x32_bf16 v[172:175], v[40:43], v[92:95], v[172:175]
    v_accvgpr_write_b32 a1, 0
    s_waitcnt lgkmcnt(7)
    v_mfma_f32_16x16x32_bf16 v[176:179], v[44:47], v[80:83], v[176:179]
    ds_read_b64_tr_b16 v[40:41], v9 offset:192
    ds_read_b64_tr_b16 v[42:43], v9 offset:17088
    v_mfma_f32_16x16x32_bf16 v[180:183], v[44:47], v[84:87], v[180:183]
    s_add_u32 m0, s56, 39072
    s_nop 0
    buffer_load_dwordx4 v101, s[28:31], s67 offen lds
    v_mfma_f32_16x16x32_bf16 v[184:187], v[44:47], v[88:91], v[184:187]
    ds_read_b128 v[76:79], v11 offset:45056
    v_accvgpr_write_b32 a2, 0
    v_mfma_f32_16x16x32_bf16 v[188:191], v[44:47], v[92:95], v[188:191]
    v_accvgpr_write_b32 a3, 0
    s_waitcnt lgkmcnt(7)
    v_mfma_f32_16x16x32_bf16 v[192:195], v[32:35], v[80:83], v[192:195]
    ds_read_b64_tr_b16 v[44:45], v9 offset:224
    ds_read_b64_tr_b16 v[46:47], v9 offset:17120
    v_mfma_f32_16x16x32_bf16 v[196:199], v[32:35], v[84:87], v[196:199]
    s_add_u32 m0, s56, 40128
    s_nop 0
    buffer_load_dwordx4 v102, s[28:31], s67 offen lds
    v_mfma_f32_16x16x32_bf16 v[200:203], v[32:35], v[88:91], v[200:203]
    v_accvgpr_write_b32 a4, 0
    v_mfma_f32_16x16x32_bf16 v[204:207], v[32:35], v[92:95], v[204:207]
    v_accvgpr_write_b32 a5, 0
    s_waitcnt lgkmcnt(6)
    v_mfma_f32_16x16x32_bf16 v[208:211], v[36:39], v[80:83], v[208:211]
    v_accvgpr_write_b32 a6, 0
    v_mfma_f32_16x16x32_bf16 v[212:215], v[36:39], v[84:87], v[212:215]
    s_add_u32 m0, s56, 41184
    s_nop 0
    buffer_load_dwordx4 v103, s[28:31], s67 offen lds
    v_mfma_f32_16x16x32_bf16 v[216:219], v[36:39], v[88:91], v[216:219]
    v_accvgpr_write_b32 a7, 0
    v_mfma_f32_16x16x32_bf16 v[220:223], v[36:39], v[92:95], v[220:223]
    s_waitcnt lgkmcnt(0)
    s_waitcnt vmcnt(8)
    s_barrier
    ds_read_b64_tr_b16 v[32:33], v10 offset:0
    ds_read_b64_tr_b16 v[34:35], v10 offset:16896
    ds_read_b64_tr_b16 v[36:37], v10 offset:32
    ds_read_b64_tr_b16 v[38:39], v10 offset:16928
    v_accvgpr_write_b32 a8, 0
    v_mfma_f32_16x16x32_bf16 v[224:227], v[40:43], v[80:83], v[224:227]
    v_accvgpr_write_b32 a9, 0
    v_mfma_f32_16x16x32_bf16 v[228:231], v[40:43], v[84:87], v[228:231]
    s_add_u32 m0, s56, 67584
    s_add_u32 s67, s67, 262144
    buffer_load_dwordx4 v96, s[28:31], s67 offen lds
    v_mfma_f32_16x16x32_bf16 v[232:235], v[40:43], v[88:91], v[232:235]
    v_accvgpr_write_b32 a10, 0
    v_mfma_f32_16x16x32_bf16 v[236:239], v[40:43], v[92:95], v[236:239]
    ds_read_b64_tr_b16 v[40:41], v10 offset:64
    ds_read_b64_tr_b16 v[42:43], v10 offset:16960
    v_mfma_f32_16x16x32_bf16 v[240:243], v[44:47], v[80:83], v[240:243]
    v_accvgpr_write_b32 a11, 0
    v_mfma_f32_16x16x32_bf16 v[244:247], v[44:47], v[84:87], v[244:247]
    s_add_u32 m0, s56, 68640
    s_nop 0
    buffer_load_dwordx4 v97, s[28:31], s67 offen lds
    v_mfma_f32_16x16x32_bf16 v[248:251], v[44:47], v[88:91], v[248:251]
    v_accvgpr_write_b32 a12, 0
    v_mfma_f32_16x16x32_bf16 v[252:255], v[44:47], v[92:95], v[252:255]
    ds_read_b64_tr_b16 v[44:45], v10 offset:96
    ds_read_b64_tr_b16 v[46:47], v10 offset:16992
    s_waitcnt lgkmcnt(6)
    v_mfma_f32_16x16x32_bf16 v[128:131], v[32:35], v[64:67], v[128:131]
    v_accvgpr_write_b32 a13, 0
    v_mfma_f32_16x16x32_bf16 v[132:135], v[32:35], v[68:71], v[132:135]
    s_add_u32 m0, s56, 69696
    s_nop 0
    buffer_load_dwordx4 v98, s[28:31], s67 offen lds
    v_mfma_f32_16x16x32_bf16 v[136:139], v[32:35], v[72:75], v[136:139]
    ds_read_b128 v[80:83], v11 offset:3072
    v_accvgpr_write_b32 a14, 0
    v_mfma_f32_16x16x32_bf16 v[140:143], v[32:35], v[76:79], v[140:143]
    v_accvgpr_write_b32 a15, 0
    s_waitcnt lgkmcnt(5)
    v_mfma_f32_16x16x32_bf16 v[144:147], v[36:39], v[64:67], v[144:147]
    ds_read_b64_tr_b16 v[32:33], v10 offset:128
    ds_read_b64_tr_b16 v[34:35], v10 offset:17024
    v_mfma_f32_16x16x32_bf16 v[148:151], v[36:39], v[68:71], v[148:151]
    s_add_u32 m0, s56, 70752
    s_nop 0
    buffer_load_dwordx4 v99, s[28:31], s67 offen lds
    v_mfma_f32_16x16x32_bf16 v[152:155], v[36:39], v[72:75], v[152:155]
    ds_read_b128 v[84:87], v11 offset:17408
    v_accvgpr_write_b32 a16, 0
    v_mfma_f32_16x16x32_bf16 v[156:159], v[36:39], v[76:79], v[156:159]
    v_accvgpr_write_b32 a17, 0
    s_waitcnt lgkmcnt(6)
    v_mfma_f32_16x16x32_bf16 v[160:163], v[40:43], v[64:67], v[160:163]
    ds_read_b64_tr_b16 v[36:37], v10 offset:160
    ds_read_b64_tr_b16 v[38:39], v10 offset:17056
    v_mfma_f32_16x16x32_bf16 v[164:167], v[40:43], v[68:71], v[164:167]
    s_add_u32 m0, s56, 71808
    s_nop 0
    buffer_load_dwordx4 v100, s[28:31], s67 offen lds
    v_mfma_f32_16x16x32_bf16 v[168:171], v[40:43], v[72:75], v[168:171]
    ds_read_b128 v[88:91], v11 offset:31744
    v_accvgpr_write_b32 a18, 0
    v_mfma_f32_16x16x32_bf16 v[172:175], v[40:43], v[76:79], v[172:175]
    v_accvgpr_write_b32 a19, 0
    s_waitcnt lgkmcnt(7)
    v_mfma_f32_16x16x32_bf16 v[176:179], v[44:47], v[64:67], v[176:179]
    ds_read_b64_tr_b16 v[40:41], v10 offset:192
    ds_read_b64_tr_b16 v[42:43], v10 offset:17088
    v_mfma_f32_16x16x32_bf16 v[180:183], v[44:47], v[68:71], v[180:183]
    s_add_u32 m0, s56, 72864
    s_nop 0
    buffer_load_dwordx4 v101, s[28:31], s67 offen lds
    v_mfma_f32_16x16x32_bf16 v[184:187], v[44:47], v[72:75], v[184:187]
    ds_read_b128 v[92:95], v11 offset:46080
    v_accvgpr_write_b32 a20, 0
    v_mfma_f32_16x16x32_bf16 v[188:191], v[44:47], v[76:79], v[188:191]
    v_accvgpr_write_b32 a21, 0
    s_waitcnt lgkmcnt(7)
    v_mfma_f32_16x16x32_bf16 v[192:195], v[32:35], v[64:67], v[192:195]
    ds_read_b64_tr_b16 v[44:45], v10 offset:224
    ds_read_b64_tr_b16 v[46:47], v10 offset:17120
    v_mfma_f32_16x16x32_bf16 v[196:199], v[32:35], v[68:71], v[196:199]
    s_add_u32 m0, s56, 73920
    s_nop 0
    buffer_load_dwordx4 v102, s[28:31], s67 offen lds
    v_mfma_f32_16x16x32_bf16 v[200:203], v[32:35], v[72:75], v[200:203]
    v_accvgpr_write_b32 a22, 0
    v_mfma_f32_16x16x32_bf16 v[204:207], v[32:35], v[76:79], v[204:207]
    v_accvgpr_write_b32 a23, 0
    s_waitcnt lgkmcnt(6)
    v_mfma_f32_16x16x32_bf16 v[208:211], v[36:39], v[64:67], v[208:211]
    v_accvgpr_write_b32 a24, 0
    v_mfma_f32_16x16x32_bf16 v[212:215], v[36:39], v[68:71], v[212:215]
    s_add_u32 m0, s56, 74976
    s_nop 0
    buffer_load_dwordx4 v103, s[28:31], s67 offen lds
    v_mfma_f32_16x16x32_bf16 v[216:219], v[36:39], v[72:75], v[216:219]
    v_accvgpr_write_b32 a25, 0
    v_mfma_f32_16x16x32_bf16 v[220:223], v[36:39], v[76:79], v[220:223]
    s_waitcnt lgkmcnt(0)
    s_waitcnt vmcnt(8)
    s_barrier
    ds_read_b64_tr_b16 v[32:33], v8 offset:0
    ds_read_b64_tr_b16 v[34:35], v8 offset:16896
    ds_read_b64_tr_b16 v[36:37], v8 offset:32
    ds_read_b64_tr_b16 v[38:39], v8 offset:16928
    v_accvgpr_write_b32 a26, 0
    v_mfma_f32_16x16x32_bf16 v[224:227], v[40:43], v[64:67], v[224:227]
    v_accvgpr_write_b32 a27, 0
    v_mfma_f32_16x16x32_bf16 v[228:231], v[40:43], v[68:71], v[228:231]
    s_add_u32 m0, s56, 0
    s_add_u32 s67, s67, 262144
    buffer_load_dwordx4 v96, s[28:31], s67 offen lds
    v_mfma_f32_16x16x32_bf16 v[232:235], v[40:43], v[72:75], v[232:235]
    v_accvgpr_write_b32 a28, 0
    v_mfma_f32_16x16x32_bf16 v[236:239], v[40:43], v[76:79], v[236:239]
    ds_read_b64_tr_b16 v[40:41], v8 offset:64
    ds_read_b64_tr_b16 v[42:43], v8 offset:16960
    v_mfma_f32_16x16x32_bf16 v[240:243], v[44:47], v[64:67], v[240:243]
    v_accvgpr_write_b32 a29, 0
    v_mfma_f32_16x16x32_bf16 v[244:247], v[44:47], v[68:71], v[244:247]
    s_add_u32 m0, s56, 1056
    s_nop 0
    buffer_load_dwordx4 v97, s[28:31], s67 offen lds
    v_mfma_f32_16x16x32_bf16 v[248:251], v[44:47], v[72:75], v[248:251]
    v_accvgpr_write_b32 a30, 0
    v_mfma_f32_16x16x32_bf16 v[252:255], v[44:47], v[76:79], v[252:255]
    ds_read_b64_tr_b16 v[44:45], v8 offset:96
    ds_read_b64_tr_b16 v[46:47], v8 offset:16992
    s_waitcnt lgkmcnt(6)
    v_mfma_f32_16x16x32_bf16 v[128:131], v[32:35], v[80:83], v[128:131]
    v_accvgpr_write_b32 a31, 0
    v_mfma_f32_16x16x32_bf16 v[132:135], v[32:35], v[84:87], v[132:135]
    s_add_u32 m0, s56, 2112
    s_nop 0
    buffer_load_dwordx4 v98, s[28:31], s67 offen lds
    v_mfma_f32_16x16x32_bf16 v[136:139], v[32:35], v[88:91], v[136:139]
    ds_read_b128 v[64:67], v11 offset:4096
    v_accvgpr_write_b32 a32, 0
    v_mfma_f32_16x16x32_bf16 v[140:143], v[32:35], v[92:95], v[140:143]
    v_accvgpr_write_b32 a33, 0
    s_waitcnt lgkmcnt(5)
    v_mfma_f32_16x16x32_bf16 v[144:147], v[36:39], v[80:83], v[144:147]
    ds_read_b64_tr_b16 v[32:33], v8 offset:128
    ds_read_b64_tr_b16 v[34:35], v8 offset:17024
    v_mfma_f32_16x16x32_bf16 v[148:151], v[36:39], v[84:87], v[148:151]
    s_add_u32 m0, s56, 3168
    s_nop 0
    buffer_load_dwordx4 v99, s[28:31], s67 offen lds
    v_mfma_f32_16x16x32_bf16 v[152:155], v[36:39], v[88:91], v[152:155]
    ds_read_b128 v[68:71], v11 offset:18432
    v_accvgpr_write_b32 a34, 0
    v_mfma_f32_16x16x32_bf16 v[156:159], v[36:39], v[92:95], v[156:159]
    v_accvgpr_write_b32 a35, 0
    s_waitcnt lgkmcnt(6)
    v_mfma_f32_16x16x32_bf16 v[160:163], v[40:43], v[80:83], v[160:163]
    ds_read_b64_tr_b16 v[36:37], v8 offset:160
    ds_read_b64_tr_b16 v[38:39], v8 offset:17056
    v_mfma_f32_16x16x32_bf16 v[164:167], v[40:43], v[84:87], v[164:167]
    s_add_u32 m0, s56, 4224
    s_nop 0
    buffer_load_dwordx4 v100, s[28:31], s67 offen lds
    v_mfma_f32_16x16x32_bf16 v[168:171], v[40:43], v[88:91], v[168:171]
    ds_read_b128 v[72:75], v11 offset:32768
    v_accvgpr_write_b32 a36, 0
    v_mfma_f32_16x16x32_bf16 v[172:175], v[40:43], v[92:95], v[172:175]
    v_accvgpr_write_b32 a37, 0
    s_waitcnt lgkmcnt(7)
    v_mfma_f32_16x16x32_bf16 v[176:179], v[44:47], v[80:83], v[176:179]
    ds_read_b64_tr_b16 v[40:41], v8 offset:192
    ds_read_b64_tr_b16 v[42:43], v8 offset:17088
    v_mfma_f32_16x16x32_bf16 v[180:183], v[44:47], v[84:87], v[180:183]
    s_add_u32 m0, s56, 5280
    s_nop 0
    buffer_load_dwordx4 v101, s[28:31], s67 offen lds
    v_mfma_f32_16x16x32_bf16 v[184:187], v[44:47], v[88:91], v[184:187]
    ds_read_b128 v[76:79], v11 offset:47104
    v_accvgpr_write_b32 a38, 0
    v_mfma_f32_16x16x32_bf16 v[188:191], v[44:47], v[92:95], v[188:191]
    v_accvgpr_write_b32 a39, 0
    s_waitcnt lgkmcnt(7)
    v_mfma_f32_16x16x32_bf16 v[192:195], v[32:35], v[80:83], v[192:195]
    ds_read_b64_tr_b16 v[44:45], v8 offset:224
    ds_read_b64_tr_b16 v[46:47], v8 offset:17120
    v_mfma_f32_16x16x32_bf16 v[196:199], v[32:35], v[84:87], v[196:199]
    s_add_u32 m0, s56, 6336
    s_nop 0
    buffer_load_dwordx4 v102, s[28:31], s67 offen lds
    v_mfma_f32_16x16x32_bf16 v[200:203], v[32:35], v[88:91], v[200:203]
    v_accvgpr_write_b32 a40, 0
    v_mfma_f32_16x16x32_bf16 v[204:207], v[32:35], v[92:95], v[204:207]
    v_accvgpr_write_b32 a41, 0
    s_waitcnt lgkmcnt(6)
    v_mfma_f32_16x16x32_bf16 v[208:211], v[36:39], v[80:83], v[208:211]
    v_accvgpr_write_b32 a42, 0
    v_mfma_f32_16x16x32_bf16 v[212:215], v[36:39], v[84:87], v[212:215]
    s_add_u32 m0, s56, 7392
    s_nop 0
    buffer_load_dwordx4 v103, s[28:31], s67 offen lds
    v_mfma_f32_16x16x32_bf16 v[216:219], v[36:39], v[88:91], v[216:219]
    v_accvgpr_write_b32 a43, 0
    v_mfma_f32_16x16x32_bf16 v[220:223], v[36:39], v[92:95], v[220:223]
    s_waitcnt lgkmcnt(0)
    s_waitcnt vmcnt(8)
    s_barrier
    ds_read_b64_tr_b16 v[32:33], v9 offset:0
    ds_read_b64_tr_b16 v[34:35], v9 offset:16896
    ds_read_b64_tr_b16 v[36:37], v9 offset:32
    ds_read_b64_tr_b16 v[38:39], v9 offset:16928
    v_accvgpr_write_b32 a44, 0
    v_mfma_f32_16x16x32_bf16 v[224:227], v[40:43], v[80:83], v[224:227]
    v_accvgpr_write_b32 a45, 0
    v_mfma_f32_16x16x32_bf16 v[228:231], v[40:43], v[84:87], v[228:231]
    s_add_u32 m0, s56, 33792
    s_add_u32 s67, s67, 262144
    buffer_load_dwordx4 v96, s[28:31], s67 offen lds
    v_mfma_f32_16x16x32_bf16 v[232:235], v[40:43], v[88:91], v[232:235]
    v_accvgpr_write_b32 a46, 0
    v_mfma_f32_16x16x32_bf16 v[236:239], v[40:43], v[92:95], v[236:239]
    ds_read_b64_tr_b16 v[40:41], v9 offset:64
    ds_read_b64_tr_b16 v[42:43], v9 offset:16960
    v_mfma_f32_16x16x32_bf16 v[240:243], v[44:47], v[80:83], v[240:243]
    v_accvgpr_write_b32 a47, 0
    v_mfma_f32_16x16x32_bf16 v[244:247], v[44:47], v[84:87], v[244:247]
    s_add_u32 m0, s56, 34848
    s_nop 0
    buffer_load_dwordx4 v97, s[28:31], s67 offen lds
    v_mfma_f32_16x16x32_bf16 v[248:251], v[44:47], v[88:91], v[248:251]
    v_accvgpr_write_b32 a48, 0
    v_mfma_f32_16x16x32_bf16 v[252:255], v[44:47], v[92:95], v[252:255]
    ds_read_b64_tr_b16 v[44:45], v9 offset:96
    ds_read_b64_tr_b16 v[46:47], v9 offset:16992
    s_waitcnt lgkmcnt(6)
    v_mfma_f32_16x16x32_bf16 v[128:131], v[32:35], v[64:67], v[128:131]
    v_accvgpr_write_b32 a49, 0
    v_mfma_f32_16x16x32_bf16 v[132:135], v[32:35], v[68:71], v[132:135]
    s_add_u32 m0, s56, 35904
    s_nop 0
    buffer_load_dwordx4 v98, s[28:31], s67 offen lds
    v_mfma_f32_16x16x32_bf16 v[136:139], v[32:35], v[72:75], v[136:139]
    ds_read_b128 v[80:83], v11 offset:5120
    v_accvgpr_write_b32 a50, 0
    v_mfma_f32_16x16x32_bf16 v[140:143], v[32:35], v[76:79], v[140:143]
    v_accvgpr_write_b32 a51, 0
    s_waitcnt lgkmcnt(5)
    v_mfma_f32_16x16x32_bf16 v[144:147], v[36:39], v[64:67], v[144:147]
    ds_read_b64_tr_b16 v[32:33], v9 offset:128
    ds_read_b64_tr_b16 v[34:35], v9 offset:17024
    v_mfma_f32_16x16x32_bf16 v[148:151], v[36:39], v[68:71], v[148:151]
    s_add_u32 m0, s56, 36960
    s_nop 0
    buffer_load_dwordx4 v99, s[28:31], s67 offen lds
    v_mfma_f32_16x16x32_bf16 v[152:155], v[36:39], v[72:75], v[152:155]
    ds_read_b128 v[84:87], v11 offset:19456
    v_accvgpr_write_b32 a52, 0
    v_mfma_f32_16x16x32_bf16 v[156:159], v[36:39], v[76:79], v[156:159]
    v_accvgpr_write_b32 a53, 0
    s_waitcnt lgkmcnt(6)
    v_mfma_f32_16x16x32_bf16 v[160:163], v[40:43], v[64:67], v[160:163]
    ds_read_b64_tr_b16 v[36:37], v9 offset:160
    ds_read_b64_tr_b16 v[38:39], v9 offset:17056
    v_mfma_f32_16x16x32_bf16 v[164:167], v[40:43], v[68:71], v[164:167]
    s_add_u32 m0, s56, 38016
    s_nop 0
    buffer_load_dwordx4 v100, s[28:31], s67 offen lds
    v_mfma_f32_16x16x32_bf16 v[168:171], v[40:43], v[72:75], v[168:171]
    ds_read_b128 v[88:91], v11 offset:33792
    v_accvgpr_write_b32 a54, 0
    v_mfma_f32_16x16x32_bf16 v[172:175], v[40:43], v[76:79], v[172:175]
    v_accvgpr_write_b32 a55, 0
    s_waitcnt lgkmcnt(7)
    v_mfma_f32_16x16x32_bf16 v[176:179], v[44:47], v[64:67], v[176:179]
    ds_read_b64_tr_b16 v[40:41], v9 offset:192
    ds_read_b64_tr_b16 v[42:43], v9 offset:17088
    v_mfma_f32_16x16x32_bf16 v[180:183], v[44:47], v[68:71], v[180:183]
    s_add_u32 m0, s56, 39072
    s_nop 0
    buffer_load_dwordx4 v101, s[28:31], s67 offen lds
    v_mfma_f32_16x16x32_bf16 v[184:187], v[44:47], v[72:75], v[184:187]
    ds_read_b128 v[92:95], v11 offset:48128
    v_accvgpr_write_b32 a56, 0
    v_mfma_f32_16x16x32_bf16 v[188:191], v[44:47], v[76:79], v[188:191]
    v_accvgpr_write_b32 a57, 0
    s_waitcnt lgkmcnt(7)
    v_mfma_f32_16x16x32_bf16 v[192:195], v[32:35], v[64:67], v[192:195]
    ds_read_b64_tr_b16 v[44:45], v9 offset:224
    ds_read_b64_tr_b16 v[46:47], v9 offset:17120
    v_mfma_f32_16x16x32_bf16 v[196:199], v[32:35], v[68:71], v[196:199]
    s_add_u32 m0, s56, 40128
    s_nop 0
    buffer_load_dwordx4 v102, s[28:31], s67 offen lds
    v_mfma_f32_16x16x32_bf16 v[200:203], v[32:35], v[72:75], v[200:203]
    v_accvgpr_write_b32 a58, 0
    v_mfma_f32_16x16x32_bf16 v[204:207], v[32:35], v[76:79], v[204:207]
    v_accvgpr_write_b32 a59, 0
    s_waitcnt lgkmcnt(6)
    v_mfma_f32_16x16x32_bf16 v[208:211], v[36:39], v[64:67], v[208:211]
    v_accvgpr_write_b32 a60, 0
    v_mfma_f32_16x16x32_bf16 v[212:215], v[36:39], v[68:71], v[212:215]
    s_add_u32 m0, s56, 41184
    s_nop 0
    buffer_load_dwordx4 v103, s[28:31], s67 offen lds
    v_mfma_f32_16x16x32_bf16 v[216:219], v[36:39], v[72:75], v[216:219]
    v_accvgpr_write_b32 a61, 0
    v_mfma_f32_16x16x32_bf16 v[220:223], v[36:39], v[76:79], v[220:223]
    s_waitcnt lgkmcnt(0)
    s_waitcnt vmcnt(8)
    s_barrier
    ds_read_b64_tr_b16 v[32:33], v10 offset:0
    ds_read_b64_tr_b16 v[34:35], v10 offset:16896
    ds_read_b64_tr_b16 v[36:37], v10 offset:32
    ds_read_b64_tr_b16 v[38:39], v10 offset:16928
    v_accvgpr_write_b32 a62, 0
    v_mfma_f32_16x16x32_bf16 v[224:227], v[40:43], v[64:67], v[224:227]
    v_accvgpr_write_b32 a63, 0
    v_mfma_f32_16x16x32_bf16 v[228:231], v[40:43], v[68:71], v[228:231]
    s_add_u32 m0, s56, 67584
    s_add_u32 s67, s67, 262144
    buffer_load_dwordx4 v96, s[28:31], s67 offen lds
    v_mfma_f32_16x16x32_bf16 v[232:235], v[40:43], v[72:75], v[232:235]
    v_accvgpr_write_b32 a64, 0
    v_mfma_f32_16x16x32_bf16 v[236:239], v[40:43], v[76:79], v[236:239]
    ds_read_b64_tr_b16 v[40:41], v10 offset:64
    ds_read_b64_tr_b16 v[42:43], v10 offset:16960
    v_mfma_f32_16x16x32_bf16 v[240:243], v[44:47], v[64:67], v[240:243]
    v_accvgpr_write_b32 a65, 0
    v_mfma_f32_16x16x32_bf16 v[244:247], v[44:47], v[68:71], v[244:247]
    s_add_u32 m0, s56, 68640
    s_nop 0
    buffer_load_dwordx4 v97, s[28:31], s67 offen lds
    v_mfma_f32_16x16x32_bf16 v[248:251], v[44:47], v[72:75], v[248:251]
    v_accvgpr_write_b32 a66, 0
    v_mfma_f32_16x16x32_bf16 v[252:255], v[44:47], v[76:79], v[252:255]
    ds_read_b64_tr_b16 v[44:45], v10 offset:96
    ds_read_b64_tr_b16 v[46:47], v10 offset:16992
    s_waitcnt lgkmcnt(6)
    v_mfma_f32_16x16x32_bf16 v[128:131], v[32:35], v[80:83], v[128:131]
    v_accvgpr_write_b32 a67, 0
    v_mfma_f32_16x16x32_bf16 v[132:135], v[32:35], v[84:87], v[132:135]
    s_add_u32 m0, s56, 69696
    s_nop 0
    buffer_load_dwordx4 v98, s[28:31], s67 offen lds
    v_mfma_f32_16x16x32_bf16 v[136:139], v[32:35], v[88:91], v[136:139]
    ds_read_b128 v[64:67], v11 offset:6144
    v_accvgpr_write_b32 a68, 0
    v_mfma_f32_16x16x32_bf16 v[140:143], v[32:35], v[92:95], v[140:143]
    v_accvgpr_write_b32 a69, 0
    s_waitcnt lgkmcnt(5)
    v_mfma_f32_16x16x32_bf16 v[144:147], v[36:39], v[80:83], v[144:147]
    ds_read_b64_tr_b16 v[32:33], v10 offset:128
    ds_read_b64_tr_b16 v[34:35], v10 offset:17024
    v_mfma_f32_16x16x32_bf16 v[148:151], v[36:39], v[84:87], v[148:151]
    s_add_u32 m0, s56, 70752
    s_nop 0
    buffer_load_dwordx4 v99, s[28:31], s67 offen lds
    v_mfma_f32_16x16x32_bf16 v[152:155], v[36:39], v[88:91], v[152:155]
    ds_read_b128 v[68:71], v11 offset:20480
    v_accvgpr_write_b32 a70, 0
    v_mfma_f32_16x16x32_bf16 v[156:159], v[36:39], v[92:95], v[156:159]
    v_accvgpr_write_b32 a71, 0
    s_waitcnt lgkmcnt(6)
    v_mfma_f32_16x16x32_bf16 v[160:163], v[40:43], v[80:83], v[160:163]
    ds_read_b64_tr_b16 v[36:37], v10 offset:160
    ds_read_b64_tr_b16 v[38:39], v10 offset:17056
    v_mfma_f32_16x16x32_bf16 v[164:167], v[40:43], v[84:87], v[164:167]
    s_add_u32 m0, s56, 71808
    s_nop 0
    buffer_load_dwordx4 v100, s[28:31], s67 offen lds
    v_mfma_f32_16x16x32_bf16 v[168:171], v[40:43], v[88:91], v[168:171]
    ds_read_b128 v[72:75], v11 offset:34816
    v_accvgpr_write_b32 a72, 0
    v_mfma_f32_16x16x32_bf16 v[172:175], v[40:43], v[92:95], v[172:175]
    v_accvgpr_write_b32 a73, 0
    s_waitcnt lgkmcnt(7)
    v_mfma_f32_16x16x32_bf16 v[176:179], v[44:47], v[80:83], v[176:179]
    ds_read_b64_tr_b16 v[40:41], v10 offset:192
    ds_read_b64_tr_b16 v[42:43], v10 offset:17088
    v_mfma_f32_16x16x32_bf16 v[180:183], v[44:47], v[84:87], v[180:183]
    s_add_u32 m0, s56, 72864
    s_nop 0
    buffer_load_dwordx4 v101, s[28:31], s67 offen lds
    v_mfma_f32_16x16x32_bf16 v[184:187], v[44:47], v[88:91], v[184:187]
    ds_read_b128 v[76:79], v11 offset:49152
    v_accvgpr_write_b32 a74, 0
    v_mfma_f32_16x16x32_bf16 v[188:191], v[44:47], v[92:95], v[188:191]
    v_accvgpr_write_b32 a75, 0
    s_waitcnt lgkmcnt(7)
    v_mfma_f32_16x16x32_bf16 v[192:195], v[32:35], v[80:83], v[192:195]
    ds_read_b64_tr_b16 v[44:45], v10 offset:224
    ds_read_b64_tr_b16 v[46:47], v10 offset:17120
    v_mfma_f32_16x16x32_bf16 v[196:199], v[32:35], v[84:87], v[196:199]
    s_add_u32 m0, s56, 73920
    s_nop 0
    buffer_load_dwordx4 v102, s[28:31], s67 offen lds
    v_mfma_f32_16x16x32_bf16 v[200:203], v[32:35], v[88:91], v[200:203]
    v_accvgpr_write_b32 a76, 0
    v_mfma_f32_16x16x32_bf16 v[204:207], v[32:35], v[92:95], v[204:207]
    v_accvgpr_write_b32 a77, 0
    s_waitcnt lgkmcnt(6)
    v_mfma_f32_16x16x32_bf16 v[208:211], v[36:39], v[80:83], v[208:211]
    v_accvgpr_write_b32 a78, 0
    v_mfma_f32_16x16x32_bf16 v[212:215], v[36:39], v[84:87], v[212:215]
    s_add_u32 m0, s56, 74976
    s_nop 0
    buffer_load_dwordx4 v103, s[28:31], s67 offen lds
    v_mfma_f32_16x16x32_bf16 v[216:219], v[36:39], v[88:91], v[216:219]
    v_accvgpr_write_b32 a79, 0
    v_mfma_f32_16x16x32_bf16 v[220:223], v[36:39], v[92:95], v[220:223]
    s_waitcnt lgkmcnt(0)
    s_waitcnt vmcnt(8)
    s_barrier
    ds_read_b64_tr_b16 v[32:33], v8 offset:0
    ds_read_b64_tr_b16 v[34:35], v8 offset:16896
    ds_read_b64_tr_b16 v[36:37], v8 offset:32
    ds_read_b64_tr_b16 v[38:39], v8 offset:16928
    v_accvgpr_write_b32 a80, 0
    v_mfma_f32_16x16x32_bf16 v[224:227], v[40:43], v[80:83], v[224:227]
    v_accvgpr_write_b32 a81, 0
    v_mfma_f32_16x16x32_bf16 v[228:231], v[40:43], v[84:87], v[228:231]
    s_add_u32 m0, s56, 0
    s_add_u32 s67, s67, 262144
    buffer_load_dwordx4 v96, s[28:31], s67 offen lds
    v_mfma_f32_16x16x32_bf16 v[232:235], v[40:43], v[88:91], v[232:235]
    v_accvgpr_write_b32 a82, 0
    v_mfma_f32_16x16x32_bf16 v[236:239], v[40:43], v[92:95], v[236:239]
    ds_read_b64_tr_b16 v[40:41], v8 offset:64
    ds_read_b64_tr_b16 v[42:43], v8 offset:16960
    v_mfma_f32_16x16x32_bf16 v[240:243], v[44:47], v[80:83], v[240:243]
    v_accvgpr_write_b32 a83, 0
    v_mfma_f32_16x16x32_bf16 v[244:247], v[44:47], v[84:87], v[244:247]
    s_add_u32 m0, s56, 1056
    s_nop 0
    buffer_load_dwordx4 v97, s[28:31], s67 offen lds
    v_mfma_f32_16x16x32_bf16 v[248:251], v[44:47], v[88:91], v[248:251]
    v_accvgpr_write_b32 a84, 0
    v_mfma_f32_16x16x32_bf16 v[252:255], v[44:47], v[92:95], v[252:255]
    ds_read_b64_tr_b16 v[44:45], v8 offset:96
    ds_read_b64_tr_b16 v[46:47], v8 offset:16992
    s_waitcnt lgkmcnt(6)
    v_mfma_f32_16x16x32_bf16 v[128:131], v[32:35], v[64:67], v[128:131]
    v_accvgpr_write_b32 a85, 0
    v_mfma_f32_16x16x32_bf16 v[132:135], v[32:35], v[68:71], v[132:135]
    s_add_u32 m0, s56, 2112
    s_nop 0
    buffer_load_dwordx4 v98, s[28:31], s67 offen lds
    v_mfma_f32_16x16x32_bf16 v[136:139], v[32:35], v[72:75], v[136:139]
    ds_read_b128 v[80:83], v11 offset:7168
    v_accvgpr_write_b32 a86, 0
    v_mfma_f32_16x16x32_bf16 v[140:143], v[32:35], v[76:79], v[140:143]
    v_accvgpr_write_b32 a87, 0
    s_waitcnt lgkmcnt(5)
    v_mfma_f32_16x16x32_bf16 v[144:147], v[36:39], v[64:67], v[144:147]
    ds_read_b64_tr_b16 v[32:33], v8 offset:128
    ds_read_b64_tr_b16 v[34:35], v8 offset:17024
    v_mfma_f32_16x16x32_bf16 v[148:151], v[36:39], v[68:71], v[148:151]
    s_add_u32 m0, s56, 3168
    s_nop 0
    buffer_load_dwordx4 v99, s[28:31], s67 offen lds
    v_mfma_f32_16x16x32_bf16 v[152:155], v[36:39], v[72:75], v[152:155]
    ds_read_b128 v[84:87], v11 offset:21504
    v_accvgpr_write_b32 a88, 0
    v_mfma_f32_16x16x32_bf16 v[156:159], v[36:39], v[76:79], v[156:159]
    v_accvgpr_write_b32 a89, 0
    s_waitcnt lgkmcnt(6)
    v_mfma_f32_16x16x32_bf16 v[160:163], v[40:43], v[64:67], v[160:163]
    ds_read_b64_tr_b16 v[36:37], v8 offset:160
    ds_read_b64_tr_b16 v[38:39], v8 offset:17056
    v_mfma_f32_16x16x32_bf16 v[164:167], v[40:43], v[68:71], v[164:167]
    s_add_u32 m0, s56, 4224
    s_nop 0
    buffer_load_dwordx4 v100, s[28:31], s67 offen lds
    v_mfma_f32_16x16x32_bf16 v[168:171], v[40:43], v[72:75], v[168:171]
    ds_read_b128 v[88:91], v11 offset:35840
    v_accvgpr_write_b32 a90, 0
    v_mfma_f32_16x16x32_bf16 v[172:175], v[40:43], v[76:79], v[172:175]
    v_accvgpr_write_b32 a91, 0
    s_waitcnt lgkmcnt(7)
    v_mfma_f32_16x16x32_bf16 v[176:179], v[44:47], v[64:67], v[176:179]
    ds_read_b64_tr_b16 v[40:41], v8 offset:192
    ds_read_b64_tr_b16 v[42:43], v8 offset:17088
    v_mfma_f32_16x16x32_bf16 v[180:183], v[44:47], v[68:71], v[180:183]
    s_add_u32 m0, s56, 5280
    s_nop 0
    buffer_load_dwordx4 v101, s[28:31], s67 offen lds
    v_mfma_f32_16x16x32_bf16 v[184:187], v[44:47], v[72:75], v[184:187]
    ds_read_b128 v[92:95], v11 offset:50176
    v_accvgpr_write_b32 a92, 0
    v_mfma_f32_16x16x32_bf16 v[188:191], v[44:47], v[76:79], v[188:191]
    v_accvgpr_write_b32 a93, 0
    s_waitcnt lgkmcnt(7)
    v_mfma_f32_16x16x32_bf16 v[192:195], v[32:35], v[64:67], v[192:195]
    ds_read_b64_tr_b16 v[44:45], v8 offset:224
    ds_read_b64_tr_b16 v[46:47], v8 offset:17120
    v_mfma_f32_16x16x32_bf16 v[196:199], v[32:35], v[68:71], v[196:199]
    s_add_u32 m0, s56, 6336
    s_nop 0
    buffer_load_dwordx4 v102, s[28:31], s67 offen lds
    v_mfma_f32_16x16x32_bf16 v[200:203], v[32:35], v[72:75], v[200:203]
    v_accvgpr_write_b32 a94, 0
    v_mfma_f32_16x16x32_bf16 v[204:207], v[32:35], v[76:79], v[204:207]
    v_accvgpr_write_b32 a95, 0
    s_waitcnt lgkmcnt(6)
    v_mfma_f32_16x16x32_bf16 v[208:211], v[36:39], v[64:67], v[208:211]
    v_accvgpr_write_b32 a96, 0
    v_mfma_f32_16x16x32_bf16 v[212:215], v[36:39], v[68:71], v[212:215]
    s_add_u32 m0, s56, 7392
    s_nop 0
    buffer_load_dwordx4 v103, s[28:31], s67 offen lds
    v_mfma_f32_16x16x32_bf16 v[216:219], v[36:39], v[72:75], v[216:219]
    v_accvgpr_write_b32 a97, 0
    v_mfma_f32_16x16x32_bf16 v[220:223], v[36:39], v[76:79], v[220:223]
    s_waitcnt lgkmcnt(0)
    s_waitcnt vmcnt(8)
    s_barrier
    ds_read_b64_tr_b16 v[32:33], v9 offset:0
    ds_read_b64_tr_b16 v[34:35], v9 offset:16896
    ds_read_b64_tr_b16 v[36:37], v9 offset:32
    ds_read_b64_tr_b16 v[38:39], v9 offset:16928
    v_accvgpr_write_b32 a98, 0
    v_mfma_f32_16x16x32_bf16 v[224:227], v[40:43], v[64:67], v[224:227]
    v_accvgpr_write_b32 a99, 0
    v_mfma_f32_16x16x32_bf16 v[228:231], v[40:43], v[68:71], v[228:231]
    s_add_u32 m0, s56, 33792
    s_add_u32 s67, s67, 262144
    buffer_load_dwordx4 v96, s[28:31], s67 offen lds
    v_mfma_f32_16x16x32_bf16 v[232:235], v[40:43], v[72:75], v[232:235]
    v_accvgpr_write_b32 a100, 0
    v_mfma_f32_16x16x32_bf16 v[236:239], v[40:43], v[76:79], v[236:239]
    ds_read_b64_tr_b16 v[40:41], v9 offset:64
    ds_read_b64_tr_b16 v[42:43], v9 offset:16960
    v_mfma_f32_16x16x32_bf16 v[240:243], v[44:47], v[64:67], v[240:243]
    v_accvgpr_write_b32 a101, 0
    v_mfma_f32_16x16x32_bf16 v[244:247], v[44:47], v[68:71], v[244:247]
    s_add_u32 m0, s56, 34848
    s_nop 0
    buffer_load_dwordx4 v97, s[28:31], s67 offen lds
    v_mfma_f32_16x16x32_bf16 v[248:251], v[44:47], v[72:75], v[248:251]
    v_accvgpr_write_b32 a102, 0
    v_mfma_f32_16x16x32_bf16 v[252:255], v[44:47], v[76:79], v[252:255]
    ds_read_b64_tr_b16 v[44:45], v9 offset:96
    ds_read_b64_tr_b16 v[46:47], v9 offset:16992
    s_waitcnt lgkmcnt(6)
    v_mfma_f32_16x16x32_bf16 v[128:131], v[32:35], v[80:83], v[128:131]
    v_accvgpr_write_b32 a103, 0
    v_mfma_f32_16x16x32_bf16 v[132:135], v[32:35], v[84:87], v[132:135]
    s_add_u32 m0, s56, 35904
    s_nop 0
    buffer_load_dwordx4 v98, s[28:31], s67 offen lds
    v_mfma_f32_16x16x32_bf16 v[136:139], v[32:35], v[88:91], v[136:139]
    ds_read_b128 v[64:67], v11 offset:8192
    v_accvgpr_write_b32 a104, 0
    v_mfma_f32_16x16x32_bf16 v[140:143], v[32:35], v[92:95], v[140:143]
    v_accvgpr_write_b32 a105, 0
    s_waitcnt lgkmcnt(5)
    v_mfma_f32_16x16x32_bf16 v[144:147], v[36:39], v[80:83], v[144:147]
    ds_read_b64_tr_b16 v[32:33], v9 offset:128
    ds_read_b64_tr_b16 v[34:35], v9 offset:17024
    v_mfma_f32_16x16x32_bf16 v[148:151], v[36:39], v[84:87], v[148:151]
    s_add_u32 m0, s56, 36960
    s_nop 0
    buffer_load_dwordx4 v99, s[28:31], s67 offen lds
    v_mfma_f32_16x16x32_bf16 v[152:155], v[36:39], v[88:91], v[152:155]
    ds_read_b128 v[68:71], v11 offset:22528
    v_accvgpr_write_b32 a106, 0
    v_mfma_f32_16x16x32_bf16 v[156:159], v[36:39], v[92:95], v[156:159]
    v_accvgpr_write_b32 a107, 0
    s_waitcnt lgkmcnt(6)
    v_mfma_f32_16x16x32_bf16 v[160:163], v[40:43], v[80:83], v[160:163]
    ds_read_b64_tr_b16 v[36:37], v9 offset:160
    ds_read_b64_tr_b16 v[38:39], v9 offset:17056
    v_mfma_f32_16x16x32_bf16 v[164:167], v[40:43], v[84:87], v[164:167]
    s_add_u32 m0, s56, 38016
    s_nop 0
    buffer_load_dwordx4 v100, s[28:31], s67 offen lds
    v_mfma_f32_16x16x32_bf16 v[168:171], v[40:43], v[88:91], v[168:171]
    ds_read_b128 v[72:75], v11 offset:36864
    v_accvgpr_write_b32 a108, 0
    v_mfma_f32_16x16x32_bf16 v[172:175], v[40:43], v[92:95], v[172:175]
    v_accvgpr_write_b32 a109, 0
    s_waitcnt lgkmcnt(7)
    v_mfma_f32_16x16x32_bf16 v[176:179], v[44:47], v[80:83], v[176:179]
    ds_read_b64_tr_b16 v[40:41], v9 offset:192
    ds_read_b64_tr_b16 v[42:43], v9 offset:17088
    v_mfma_f32_16x16x32_bf16 v[180:183], v[44:47], v[84:87], v[180:183]
    s_add_u32 m0, s56, 39072
    s_nop 0
    buffer_load_dwordx4 v101, s[28:31], s67 offen lds
    v_mfma_f32_16x16x32_bf16 v[184:187], v[44:47], v[88:91], v[184:187]
    ds_read_b128 v[76:79], v11 offset:51200
    v_accvgpr_write_b32 a110, 0
    v_mfma_f32_16x16x32_bf16 v[188:191], v[44:47], v[92:95], v[188:191]
    v_accvgpr_write_b32 a111, 0
    s_waitcnt lgkmcnt(7)
    v_mfma_f32_16x16x32_bf16 v[192:195], v[32:35], v[80:83], v[192:195]
    ds_read_b64_tr_b16 v[44:45], v9 offset:224
    ds_read_b64_tr_b16 v[46:47], v9 offset:17120
    v_mfma_f32_16x16x32_bf16 v[196:199], v[32:35], v[84:87], v[196:199]
    s_add_u32 m0, s56, 40128
    s_nop 0
    buffer_load_dwordx4 v102, s[28:31], s67 offen lds
    v_mfma_f32_16x16x32_bf16 v[200:203], v[32:35], v[88:91], v[200:203]
    v_accvgpr_write_b32 a112, 0
    v_mfma_f32_16x16x32_bf16 v[204:207], v[32:35], v[92:95], v[204:207]
    v_accvgpr_write_b32 a113, 0
    s_waitcnt lgkmcnt(6)
    v_mfma_f32_16x16x32_bf16 v[208:211], v[36:39], v[80:83], v[208:211]
    v_accvgpr_write_b32 a114, 0
    v_mfma_f32_16x16x32_bf16 v[212:215], v[36:39], v[84:87], v[212:215]
    s_add_u32 m0, s56, 41184
    s_nop 0
    buffer_load_dwordx4 v103, s[28:31], s67 offen lds
    v_mfma_f32_16x16x32_bf16 v[216:219], v[36:39], v[88:91], v[216:219]
    v_accvgpr_write_b32 a115, 0
    v_mfma_f32_16x16x32_bf16 v[220:223], v[36:39], v[92:95], v[220:223]
    s_waitcnt lgkmcnt(0)
    s_waitcnt vmcnt(8)
    s_barrier
    ds_read_b64_tr_b16 v[32:33], v10 offset:0
    ds_read_b64_tr_b16 v[34:35], v10 offset:16896
    ds_read_b64_tr_b16 v[36:37], v10 offset:32
    ds_read_b64_tr_b16 v[38:39], v10 offset:16928
    v_accvgpr_write_b32 a116, 0
    v_mfma_f32_16x16x32_bf16 v[224:227], v[40:43], v[80:83], v[224:227]
    v_accvgpr_write_b32 a117, 0
    v_mfma_f32_16x16x32_bf16 v[228:231], v[40:43], v[84:87], v[228:231]
    s_add_u32 m0, s56, 67584
    s_add_u32 s67, s67, 262144
    buffer_load_dwordx4 v96, s[28:31], s67 offen lds
    v_mfma_f32_16x16x32_bf16 v[232:235], v[40:43], v[88:91], v[232:235]
    v_accvgpr_write_b32 a118, 0
    v_mfma_f32_16x16x32_bf16 v[236:239], v[40:43], v[92:95], v[236:239]
    ds_read_b64_tr_b16 v[40:41], v10 offset:64
    ds_read_b64_tr_b16 v[42:43], v10 offset:16960
    v_mfma_f32_16x16x32_bf16 v[240:243], v[44:47], v[80:83], v[240:243]
    v_accvgpr_write_b32 a119, 0
    v_mfma_f32_16x16x32_bf16 v[244:247], v[44:47], v[84:87], v[244:247]
    s_add_u32 m0, s56, 68640
    s_nop 0
    buffer_load_dwordx4 v97, s[28:31], s67 offen lds
    v_mfma_f32_16x16x32_bf16 v[248:251], v[44:47], v[88:91], v[248:251]
    v_accvgpr_write_b32 a120, 0
    v_mfma_f32_16x16x32_bf16 v[252:255], v[44:47], v[92:95], v[252:255]
    ds_read_b64_tr_b16 v[44:45], v10 offset:96
    ds_read_b64_tr_b16 v[46:47], v10 offset:16992
    s_waitcnt lgkmcnt(6)
    v_mfma_f32_16x16x32_bf16 v[128:131], v[32:35], v[64:67], v[128:131]
    v_accvgpr_write_b32 a121, 0
    v_mfma_f32_16x16x32_bf16 v[132:135], v[32:35], v[68:71], v[132:135]
    s_add_u32 m0, s56, 69696
    s_nop 0
    buffer_load_dwordx4 v98, s[28:31], s67 offen lds
    v_mfma_f32_16x16x32_bf16 v[136:139], v[32:35], v[72:75], v[136:139]
    ds_read_b128 v[80:83], v11 offset:9216
    v_accvgpr_write_b32 a122, 0
    v_mfma_f32_16x16x32_bf16 v[140:143], v[32:35], v[76:79], v[140:143]
    v_accvgpr_write_b32 a123, 0
    s_waitcnt lgkmcnt(5)
    v_mfma_f32_16x16x32_bf16 v[144:147], v[36:39], v[64:67], v[144:147]
    ds_read_b64_tr_b16 v[32:33], v10 offset:128
    ds_read_b64_tr_b16 v[34:35], v10 offset:17024
    v_mfma_f32_16x16x32_bf16 v[148:151], v[36:39], v[68:71], v[148:151]
    s_add_u32 m0, s56, 70752
    s_nop 0
    buffer_load_dwordx4 v99, s[28:31], s67 offen lds
    v_mfma_f32_16x16x32_bf16 v[152:155], v[36:39], v[72:75], v[152:155]
    ds_read_b128 v[84:87], v11 offset:23552
    v_accvgpr_write_b32 a124, 0
    v_mfma_f32_16x16x32_bf16 v[156:159], v[36:39], v[76:79], v[156:159]
    v_accvgpr_write_b32 a125, 0
    s_waitcnt lgkmcnt(6)
    v_mfma_f32_16x16x32_bf16 v[160:163], v[40:43], v[64:67], v[160:163]
    ds_read_b64_tr_b16 v[36:37], v10 offset:160
    ds_read_b64_tr_b16 v[38:39], v10 offset:17056
    v_mfma_f32_16x16x32_bf16 v[164:167], v[40:43], v[68:71], v[164:167]
    s_add_u32 m0, s56, 71808
    s_nop 0
    buffer_load_dwordx4 v100, s[28:31], s67 offen lds
    v_mfma_f32_16x16x32_bf16 v[168:171], v[40:43], v[72:75], v[168:171]
    ds_read_b128 v[88:91], v11 offset:37888
    v_accvgpr_write_b32 a126, 0
    v_mfma_f32_16x16x32_bf16 v[172:175], v[40:43], v[76:79], v[172:175]
    v_accvgpr_write_b32 a127, 0
    s_waitcnt lgkmcnt(7)
    v_mfma_f32_16x16x32_bf16 v[176:179], v[44:47], v[64:67], v[176:179]
    ds_read_b64_tr_b16 v[40:41], v10 offset:192
    ds_read_b64_tr_b16 v[42:43], v10 offset:17088
    v_mfma_f32_16x16x32_bf16 v[180:183], v[44:47], v[68:71], v[180:183]
    s_add_u32 m0, s56, 72864
    s_nop 0
    buffer_load_dwordx4 v101, s[28:31], s67 offen lds
    v_mfma_f32_16x16x32_bf16 v[184:187], v[44:47], v[72:75], v[184:187]
    ds_read_b128 v[92:95], v11 offset:52224
    v_mfma_f32_16x16x32_bf16 v[188:191], v[44:47], v[76:79], v[188:191]
    s_waitcnt lgkmcnt(7)
    v_mfma_f32_16x16x32_bf16 v[192:195], v[32:35], v[64:67], v[192:195]
    ds_read_b64_tr_b16 v[44:45], v10 offset:224
    ds_read_b64_tr_b16 v[46:47], v10 offset:17120
    v_mfma_f32_16x16x32_bf16 v[196:199], v[32:35], v[68:71], v[196:199]
    s_add_u32 m0, s56, 73920
    s_nop 0
    buffer_load_dwordx4 v102, s[28:31], s67 offen lds
    v_mfma_f32_16x16x32_bf16 v[200:203], v[32:35], v[72:75], v[200:203]
    v_mfma_f32_16x16x32_bf16 v[204:207], v[32:35], v[76:79], v[204:207]
    s_waitcnt lgkmcnt(6)
    v_mfma_f32_16x16x32_bf16 v[208:211], v[36:39], v[64:67], v[208:211]
    v_mfma_f32_16x16x32_bf16 v[212:215], v[36:39], v[68:71], v[212:215]
    s_add_u32 m0, s56, 74976
    s_nop 0
    buffer_load_dwordx4 v103, s[28:31], s67 offen lds
    v_mfma_f32_16x16x32_bf16 v[216:219], v[36:39], v[72:75], v[216:219]
    v_mfma_f32_16x16x32_bf16 v[220:223], v[36:39], v[76:79], v[220:223]
    s_waitcnt lgkmcnt(0)
    s_waitcnt vmcnt(8)
    s_barrier
    ds_read_b64_tr_b16 v[32:33], v8 offset:0
    ds_read_b64_tr_b16 v[34:35], v8 offset:16896
    ds_read_b64_tr_b16 v[36:37], v8 offset:32
    ds_read_b64_tr_b16 v[38:39], v8 offset:16928
    v_mfma_f32_16x16x32_bf16 v[224:227], v[40:43], v[64:67], v[224:227]
    v_mfma_f32_16x16x32_bf16 v[228:231], v[40:43], v[68:71], v[228:231]
    s_add_u32 m0, s56, 0
    s_add_u32 s67, s67, 262144
    buffer_load_dwordx4 v96, s[28:31], s67 offen lds
    v_mfma_f32_16x16x32_bf16 v[232:235], v[40:43], v[72:75], v[232:235]
    v_mfma_f32_16x16x32_bf16 v[236:239], v[40:43], v[76:79], v[236:239]
    ds_read_b64_tr_b16 v[40:41], v8 offset:64
    ds_read_b64_tr_b16 v[42:43], v8 offset:16960
    v_mfma_f32_16x16x32_bf16 v[240:243], v[44:47], v[64:67], v[240:243]
    v_mfma_f32_16x16x32_bf16 v[244:247], v[44:47], v[68:71], v[244:247]
    s_add_u32 m0, s56, 1056
    s_nop 0
    buffer_load_dwordx4 v97, s[28:31], s67 offen lds
    v_mfma_f32_16x16x32_bf16 v[248:251], v[44:47], v[72:75], v[248:251]
    v_mfma_f32_16x16x32_bf16 v[252:255], v[44:47], v[76:79], v[252:255]
    ds_read_b64_tr_b16 v[44:45], v8 offset:96
    ds_read_b64_tr_b16 v[46:47], v8 offset:16992
    s_waitcnt lgkmcnt(6)
    v_mfma_f32_16x16x32_bf16 v[128:131], v[32:35], v[80:83], v[128:131]
    v_mfma_f32_16x16x32_bf16 v[132:135], v[32:35], v[84:87], v[132:135]
    s_add_u32 m0, s56, 2112
    s_nop 0
    buffer_load_dwordx4 v98, s[28:31], s67 offen lds
    v_mfma_f32_16x16x32_bf16 v[136:139], v[32:35], v[88:91], v[136:139]
    ds_read_b128 v[64:67], v11 offset:10240
    v_mfma_f32_16x16x32_bf16 v[140:143], v[32:35], v[92:95], v[140:143]
    s_waitcnt lgkmcnt(5)
    v_mfma_f32_16x16x32_bf16 v[144:147], v[36:39], v[80:83], v[144:147]
    ds_read_b64_tr_b16 v[32:33], v8 offset:128
    ds_read_b64_tr_b16 v[34:35], v8 offset:17024
    v_mfma_f32_16x16x32_bf16 v[148:151], v[36:39], v[84:87], v[148:151]
    s_add_u32 m0, s56, 3168
    s_nop 0
    buffer_load_dwordx4 v99, s[28:31], s67 offen lds
    v_mfma_f32_16x16x32_bf16 v[152:155], v[36:39], v[88:91], v[152:155]
    ds_read_b128 v[68:71], v11 offset:24576
    v_mfma_f32_16x16x32_bf16 v[156:159], v[36:39], v[92:95], v[156:159]
    s_waitcnt lgkmcnt(6)
    v_mfma_f32_16x16x32_bf16 v[160:163], v[40:43], v[80:83], v[160:163]
    ds_read_b64_tr_b16 v[36:37], v8 offset:160
    ds_read_b64_tr_b16 v[38:39], v8 offset:17056
    v_mfma_f32_16x16x32_bf16 v[164:167], v[40:43], v[84:87], v[164:167]
    s_add_u32 m0, s56, 4224
    s_nop 0
    buffer_load_dwordx4 v100, s[28:31], s67 offen lds
    v_mfma_f32_16x16x32_bf16 v[168:171], v[40:43], v[88:91], v[168:171]
    ds_read_b128 v[72:75], v11 offset:38912
    v_mfma_f32_16x16x32_bf16 v[172:175], v[40:43], v[92:95], v[172:175]
    s_waitcnt lgkmcnt(7)
    v_mfma_f32_16x16x32_bf16 v[176:179], v[44:47], v[80:83], v[176:179]
    ds_read_b64_tr_b16 v[40:41], v8 offset:192
    ds_read_b64_tr_b16 v[42:43], v8 offset:17088
    v_mfma_f32_16x16x32_bf16 v[180:183], v[44:47], v[84:87], v[180:183]
    s_add_u32 m0, s56, 5280
    s_nop 0
    buffer_load_dwordx4 v101, s[28:31], s67 offen lds
    v_mfma_f32_16x16x32_bf16 v[184:187], v[44:47], v[88:91], v[184:187]
    ds_read_b128 v[76:79], v11 offset:53248
    v_mfma_f32_16x16x32_bf16 v[188:191], v[44:47], v[92:95], v[188:191]
    s_waitcnt lgkmcnt(7)
    v_mfma_f32_16x16x32_bf16 v[192:195], v[32:35], v[80:83], v[192:195]
    ds_read_b64_tr_b16 v[44:45], v8 offset:224
    ds_read_b64_tr_b16 v[46:47], v8 offset:17120
    v_mfma_f32_16x16x32_bf16 v[196:199], v[32:35], v[84:87], v[196:199]
    s_add_u32 m0, s56, 6336
    s_nop 0
    buffer_load_dwordx4 v102, s[28:31], s67 offen lds
    v_mfma_f32_16x16x32_bf16 v[200:203], v[32:35], v[88:91], v[200:203]
    v_mfma_f32_16x16x32_bf16 v[204:207], v[32:35], v[92:95], v[204:207]
    s_waitcnt lgkmcnt(6)
    v_mfma_f32_16x16x32_bf16 v[208:211], v[36:39], v[80:83], v[208:211]
    v_mfma_f32_16x16x32_bf16 v[212:215], v[36:39], v[84:87], v[212:215]
    s_add_u32 m0, s56, 7392
    s_nop 0
    buffer_load_dwordx4 v103, s[28:31], s67 offen lds
    v_mfma_f32_16x16x32_bf16 v[216:219], v[36:39], v[88:91], v[216:219]
    v_mfma_f32_16x16x32_bf16 v[220:223], v[36:39], v[92:95], v[220:223]
    s_waitcnt lgkmcnt(0)
    s_waitcnt vmcnt(8)
    s_barrier
    ds_read_b64_tr_b16 v[32:33], v9 offset:0
    ds_read_b64_tr_b16 v[34:35], v9 offset:16896
    ds_read_b64_tr_b16 v[36:37], v9 offset:32
    ds_read_b64_tr_b16 v[38:39], v9 offset:16928
    v_mfma_f32_16x16x32_bf16 v[224:227], v[40:43], v[80:83], v[224:227]
    v_mfma_f32_16x16x32_bf16 v[228:231], v[40:43], v[84:87], v[228:231]
    s_add_u32 m0, s56, 33792
    s_add_u32 s67, s67, 262144
    buffer_load_dwordx4 v96, s[28:31], s67 offen lds
    v_mfma_f32_16x16x32_bf16 v[232:235], v[40:43], v[88:91], v[232:235]
    v_mfma_f32_16x16x32_bf16 v[236:239], v[40:43], v[92:95], v[236:239]
    ds_read_b64_tr_b16 v[40:41], v9 offset:64
    ds_read_b64_tr_b16 v[42:43], v9 offset:16960
    v_mfma_f32_16x16x32_bf16 v[240:243], v[44:47], v[80:83], v[240:243]
    v_mfma_f32_16x16x32_bf16 v[244:247], v[44:47], v[84:87], v[244:247]
    s_add_u32 m0, s56, 34848
    s_nop 0
    buffer_load_dwordx4 v97, s[28:31], s67 offen lds
    v_mfma_f32_16x16x32_bf16 v[248:251], v[44:47], v[88:91], v[248:251]
    v_mfma_f32_16x16x32_bf16 v[252:255], v[44:47], v[92:95], v[252:255]
    ds_read_b64_tr_b16 v[44:45], v9 offset:96
    ds_read_b64_tr_b16 v[46:47], v9 offset:16992
    s_waitcnt lgkmcnt(6)
    v_mfma_f32_16x16x32_bf16 v[128:131], v[32:35], v[64:67], v[128:131]
    v_mfma_f32_16x16x32_bf16 v[132:135], v[32:35], v[68:71], v[132:135]
    s_add_u32 m0, s56, 35904
    s_nop 0
    buffer_load_dwordx4 v98, s[28:31], s67 offen lds
    v_mfma_f32_16x16x32_bf16 v[136:139], v[32:35], v[72:75], v[136:139]
    ds_read_b128 v[80:83], v11 offset:11264
    v_mfma_f32_16x16x32_bf16 v[140:143], v[32:35], v[76:79], v[140:143]
    s_waitcnt lgkmcnt(5)
    v_mfma_f32_16x16x32_bf16 v[144:147], v[36:39], v[64:67], v[144:147]
    ds_read_b64_tr_b16 v[32:33], v9 offset:128
    ds_read_b64_tr_b16 v[34:35], v9 offset:17024
    v_mfma_f32_16x16x32_bf16 v[148:151], v[36:39], v[68:71], v[148:151]
    s_add_u32 m0, s56, 36960
    s_nop 0
    buffer_load_dwordx4 v99, s[28:31], s67 offen lds
    v_mfma_f32_16x16x32_bf16 v[152:155], v[36:39], v[72:75], v[152:155]
    ds_read_b128 v[84:87], v11 offset:25600
    v_mfma_f32_16x16x32_bf16 v[156:159], v[36:39], v[76:79], v[156:159]
    s_waitcnt lgkmcnt(6)
    v_mfma_f32_16x16x32_bf16 v[160:163], v[40:43], v[64:67], v[160:163]
    ds_read_b64_tr_b16 v[36:37], v9 offset:160
    ds_read_b64_tr_b16 v[38:39], v9 offset:17056
    v_mfma_f32_16x16x32_bf16 v[164:167], v[40:43], v[68:71], v[164:167]
    s_add_u32 m0, s56, 38016
    s_nop 0
    buffer_load_dwordx4 v100, s[28:31], s67 offen lds
    v_mfma_f32_16x16x32_bf16 v[168:171], v[40:43], v[72:75], v[168:171]
    ds_read_b128 v[88:91], v11 offset:39936
    v_mfma_f32_16x16x32_bf16 v[172:175], v[40:43], v[76:79], v[172:175]
    s_waitcnt lgkmcnt(7)
    v_mfma_f32_16x16x32_bf16 v[176:179], v[44:47], v[64:67], v[176:179]
    ds_read_b64_tr_b16 v[40:41], v9 offset:192
    ds_read_b64_tr_b16 v[42:43], v9 offset:17088
    v_mfma_f32_16x16x32_bf16 v[180:183], v[44:47], v[68:71], v[180:183]
    s_add_u32 m0, s56, 39072
    s_nop 0
    buffer_load_dwordx4 v101, s[28:31], s67 offen lds
    v_mfma_f32_16x16x32_bf16 v[184:187], v[44:47], v[72:75], v[184:187]
    ds_read_b128 v[92:95], v11 offset:54272
    v_mfma_f32_16x16x32_bf16 v[188:191], v[44:47], v[76:79], v[188:191]
    s_waitcnt lgkmcnt(7)
    v_mfma_f32_16x16x32_bf16 v[192:195], v[32:35], v[64:67], v[192:195]
    ds_read_b64_tr_b16 v[44:45], v9 offset:224
    ds_read_b64_tr_b16 v[46:47], v9 offset:17120
    v_mfma_f32_16x16x32_bf16 v[196:199], v[32:35], v[68:71], v[196:199]
    s_add_u32 m0, s56, 40128
    s_nop 0
    buffer_load_dwordx4 v102, s[28:31], s67 offen lds
    v_mfma_f32_16x16x32_bf16 v[200:203], v[32:35], v[72:75], v[200:203]
    v_mfma_f32_16x16x32_bf16 v[204:207], v[32:35], v[76:79], v[204:207]
    s_waitcnt lgkmcnt(6)
    v_mfma_f32_16x16x32_bf16 v[208:211], v[36:39], v[64:67], v[208:211]
    v_mfma_f32_16x16x32_bf16 v[212:215], v[36:39], v[68:71], v[212:215]
    s_add_u32 m0, s56, 41184
    s_nop 0
    buffer_load_dwordx4 v103, s[28:31], s67 offen lds
    v_mfma_f32_16x16x32_bf16 v[216:219], v[36:39], v[72:75], v[216:219]
    v_mfma_f32_16x16x32_bf16 v[220:223], v[36:39], v[76:79], v[220:223]
    s_waitcnt lgkmcnt(0)
    s_waitcnt vmcnt(8)
    s_barrier
    ds_read_b64_tr_b16 v[32:33], v10 offset:0
    ds_read_b64_tr_b16 v[34:35], v10 offset:16896
    ds_read_b64_tr_b16 v[36:37], v10 offset:32
    ds_read_b64_tr_b16 v[38:39], v10 offset:16928
    v_mfma_f32_16x16x32_bf16 v[224:227], v[40:43], v[64:67], v[224:227]
    v_mfma_f32_16x16x32_bf16 v[228:231], v[40:43], v[68:71], v[228:231]
    s_add_u32 m0, s56, 67584
    s_add_u32 s67, s67, 262144
    buffer_load_dwordx4 v96, s[28:31], s67 offen lds
    v_mfma_f32_16x16x32_bf16 v[232:235], v[40:43], v[72:75], v[232:235]
    v_mfma_f32_16x16x32_bf16 v[236:239], v[40:43], v[76:79], v[236:239]
    ds_read_b64_tr_b16 v[40:41], v10 offset:64
    ds_read_b64_tr_b16 v[42:43], v10 offset:16960
    v_mfma_f32_16x16x32_bf16 v[240:243], v[44:47], v[64:67], v[240:243]
    v_mfma_f32_16x16x32_bf16 v[244:247], v[44:47], v[68:71], v[244:247]
    s_add_u32 m0, s56, 68640
    s_nop 0
    buffer_load_dwordx4 v97, s[28:31], s67 offen lds
    v_mfma_f32_16x16x32_bf16 v[248:251], v[44:47], v[72:75], v[248:251]
    v_mfma_f32_16x16x32_bf16 v[252:255], v[44:47], v[76:79], v[252:255]
    ds_read_b64_tr_b16 v[44:45], v10 offset:96
    ds_read_b64_tr_b16 v[46:47], v10 offset:16992
    s_waitcnt lgkmcnt(6)
    v_mfma_f32_16x16x32_bf16 v[128:131], v[32:35], v[80:83], v[128:131]
    v_mfma_f32_16x16x32_bf16 v[132:135], v[32:35], v[84:87], v[132:135]
    s_add_u32 m0, s56, 69696
    s_nop 0
    buffer_load_dwordx4 v98, s[28:31], s67 offen lds
    v_mfma_f32_16x16x32_bf16 v[136:139], v[32:35], v[88:91], v[136:139]
    ds_read_b128 v[64:67], v11 offset:12288
    v_mfma_f32_16x16x32_bf16 v[140:143], v[32:35], v[92:95], v[140:143]
    s_waitcnt lgkmcnt(5)
    v_mfma_f32_16x16x32_bf16 v[144:147], v[36:39], v[80:83], v[144:147]
    ds_read_b64_tr_b16 v[32:33], v10 offset:128
    ds_read_b64_tr_b16 v[34:35], v10 offset:17024
    v_mfma_f32_16x16x32_bf16 v[148:151], v[36:39], v[84:87], v[148:151]
    s_add_u32 m0, s56, 70752
    s_nop 0
    buffer_load_dwordx4 v99, s[28:31], s67 offen lds
    v_mfma_f32_16x16x32_bf16 v[152:155], v[36:39], v[88:91], v[152:155]
    ds_read_b128 v[68:71], v11 offset:26624
    v_mfma_f32_16x16x32_bf16 v[156:159], v[36:39], v[92:95], v[156:159]
    s_waitcnt lgkmcnt(6)
    v_mfma_f32_16x16x32_bf16 v[160:163], v[40:43], v[80:83], v[160:163]
    ds_read_b64_tr_b16 v[36:37], v10 offset:160
    ds_read_b64_tr_b16 v[38:39], v10 offset:17056
    v_mfma_f32_16x16x32_bf16 v[164:167], v[40:43], v[84:87], v[164:167]
    s_add_u32 m0, s56, 71808
    s_nop 0
    buffer_load_dwordx4 v100, s[28:31], s67 offen lds
    v_mfma_f32_16x16x32_bf16 v[168:171], v[40:43], v[88:91], v[168:171]
    ds_read_b128 v[72:75], v11 offset:40960
    v_mfma_f32_16x16x32_bf16 v[172:175], v[40:43], v[92:95], v[172:175]
    s_waitcnt lgkmcnt(7)
    v_mfma_f32_16x16x32_bf16 v[176:179], v[44:47], v[80:83], v[176:179]
    ds_read_b64_tr_b16 v[40:41], v10 offset:192
    ds_read_b64_tr_b16 v[42:43], v10 offset:17088
    v_mfma_f32_16x16x32_bf16 v[180:183], v[44:47], v[84:87], v[180:183]
    s_add_u32 m0, s56, 72864
    s_nop 0
    buffer_load_dwordx4 v101, s[28:31], s67 offen lds
    v_mfma_f32_16x16x32_bf16 v[184:187], v[44:47], v[88:91], v[184:187]
    ds_read_b128 v[76:79], v11 offset:55296
    v_mfma_f32_16x16x32_bf16 v[188:191], v[44:47], v[92:95], v[188:191]
    s_waitcnt lgkmcnt(7)
    v_mfma_f32_16x16x32_bf16 v[192:195], v[32:35], v[80:83], v[192:195]
    ds_read_b64_tr_b16 v[44:45], v10 offset:224
    ds_read_b64_tr_b16 v[46:47], v10 offset:17120
    v_mfma_f32_16x16x32_bf16 v[196:199], v[32:35], v[84:87], v[196:199]
    s_add_u32 m0, s56, 73920
    s_nop 0
    buffer_load_dwordx4 v102, s[28:31], s67 offen lds
    v_mfma_f32_16x16x32_bf16 v[200:203], v[32:35], v[88:91], v[200:203]
    v_mfma_f32_16x16x32_bf16 v[204:207], v[32:35], v[92:95], v[204:207]
    s_waitcnt lgkmcnt(6)
    v_mfma_f32_16x16x32_bf16 v[208:211], v[36:39], v[80:83], v[208:211]
    v_mfma_f32_16x16x32_bf16 v[212:215], v[36:39], v[84:87], v[212:215]
    s_add_u32 m0, s56, 74976
    s_nop 0
    buffer_load_dwordx4 v103, s[28:31], s67 offen lds
    v_mfma_f32_16x16x32_bf16 v[216:219], v[36:39], v[88:91], v[216:219]
    v_mfma_f32_16x16x32_bf16 v[220:223], v[36:39], v[92:95], v[220:223]
    s_waitcnt lgkmcnt(0)
    s_waitcnt vmcnt(8)
    s_barrier
    ds_read_b64_tr_b16 v[32:33], v8 offset:0
    ds_read_b64_tr_b16 v[34:35], v8 offset:16896
    ds_read_b64_tr_b16 v[36:37], v8 offset:32
    ds_read_b64_tr_b16 v[38:39], v8 offset:16928
    v_mfma_f32_16x16x32_bf16 v[224:227], v[40:43], v[80:83], v[224:227]
    v_mfma_f32_16x16x32_bf16 v[228:231], v[40:43], v[84:87], v[228:231]
    s_add_u32 m0, s61, 0
    s_nop 0
    buffer_load_dwordx4 v14, s[20:23], s57 offen offset:0  lds
    v_mfma_f32_16x16x32_bf16 v[232:235], v[40:43], v[88:91], v[232:235]
    v_mfma_f32_16x16x32_bf16 v[236:239], v[40:43], v[92:95], v[236:239]
    ds_read_b64_tr_b16 v[40:41], v8 offset:64
    ds_read_b64_tr_b16 v[42:43], v8 offset:16960
    v_mfma_f32_16x16x32_bf16 v[240:243], v[44:47], v[80:83], v[240:243]
    v_mfma_f32_16x16x32_bf16 v[244:247], v[44:47], v[84:87], v[244:247]
    s_add_u32 m0, s61, 32
    s_nop 0
    buffer_load_dwordx4 v14, s[20:23], s57 offen offset:1024  lds
    v_mfma_f32_16x16x32_bf16 v[248:251], v[44:47], v[88:91], v[248:251]
    v_mfma_f32_16x16x32_bf16 v[252:255], v[44:47], v[92:95], v[252:255]
    ds_read_b64_tr_b16 v[44:45], v8 offset:96
    ds_read_b64_tr_b16 v[46:47], v8 offset:16992
    s_waitcnt lgkmcnt(6)
    v_mfma_f32_16x16x32_bf16 v[128:131], v[32:35], v[64:67], v[128:131]
    v_mfma_f32_16x16x32_bf16 v[132:135], v[32:35], v[68:71], v[132:135]
    s_add_u32 m0, s61, 64
    s_nop 0
    buffer_load_dwordx4 v14, s[20:23], s57 offen offset:2048  lds
    v_mfma_f32_16x16x32_bf16 v[136:139], v[32:35], v[72:75], v[136:139]
    ds_read_b128 v[80:83], v11 offset:13312
    v_mfma_f32_16x16x32_bf16 v[140:143], v[32:35], v[76:79], v[140:143]
    s_waitcnt lgkmcnt(5)
    v_mfma_f32_16x16x32_bf16 v[144:147], v[36:39], v[64:67], v[144:147]
    ds_read_b64_tr_b16 v[32:33], v8 offset:128
    ds_read_b64_tr_b16 v[34:35], v8 offset:17024
    v_mfma_f32_16x16x32_bf16 v[148:151], v[36:39], v[68:71], v[148:151]
    s_add_u32 m0, s61, 96
    s_nop 0
    buffer_load_dwordx4 v14, s[20:23], s57 offen offset:3072  lds
    v_mfma_f32_16x16x32_bf16 v[152:155], v[36:39], v[72:75], v[152:155]
    ds_read_b128 v[84:87], v11 offset:27648
    v_mfma_f32_16x16x32_bf16 v[156:159], v[36:39], v[76:79], v[156:159]
    s_waitcnt lgkmcnt(6)
    v_mfma_f32_16x16x32_bf16 v[160:163], v[40:43], v[64:67], v[160:163]
    ds_read_b64_tr_b16 v[36:37], v8 offset:160
    ds_read_b64_tr_b16 v[38:39], v8 offset:17056
    v_mfma_f32_16x16x32_bf16 v[164:167], v[40:43], v[68:71], v[164:167]
    s_add_u32 m0, s61, 4224
    s_nop 0
    buffer_load_dwordx4 v14, s[20:23], s58 offen offset:0  lds
    v_mfma_f32_16x16x32_bf16 v[168:171], v[40:43], v[72:75], v[168:171]
    ds_read_b128 v[88:91], v11 offset:41984
    v_mfma_f32_16x16x32_bf16 v[172:175], v[40:43], v[76:79], v[172:175]
    s_waitcnt lgkmcnt(7)
    v_mfma_f32_16x16x32_bf16 v[176:179], v[44:47], v[64:67], v[176:179]
    ds_read_b64_tr_b16 v[40:41], v8 offset:192
    ds_read_b64_tr_b16 v[42:43], v8 offset:17088
    v_mfma_f32_16x16x32_bf16 v[180:183], v[44:47], v[68:71], v[180:183]
    s_add_u32 m0, s61, 4256
    s_nop 0
    buffer_load_dwordx4 v14, s[20:23], s58 offen offset:1024  lds
    v_mfma_f32_16x16x32_bf16 v[184:187], v[44:47], v[72:75], v[184:187]
    ds_read_b128 v[92:95], v11 offset:56320
    v_mfma_f32_16x16x32_bf16 v[188:191], v[44:47], v[76:79], v[188:191]
    s_waitcnt lgkmcnt(7)
    v_mfma_f32_16x16x32_bf16 v[192:195], v[32:35], v[64:67], v[192:195]
    ds_read_b64_tr_b16 v[44:45], v8 offset:224
    ds_read_b64_tr_b16 v[46:47], v8 offset:17120
    v_mfma_f32_16x16x32_bf16 v[196:199], v[32:35], v[68:71], v[196:199]
    s_add_u32 m0, s61, 4288
    s_nop 0
    buffer_load_dwordx4 v14, s[20:23], s58 offen offset:2048  lds
    v_mfma_f32_16x16x32_bf16 v[200:203], v[32:35], v[72:75], v[200:203]
    v_mfma_f32_16x16x32_bf16 v[204:207], v[32:35], v[76:79], v[204:207]
    s_waitcnt lgkmcnt(6)
    v_mfma_f32_16x16x32_bf16 v[208:211], v[36:39], v[64:67], v[208:211]
    v_mfma_f32_16x16x32_bf16 v[212:215], v[36:39], v[68:71], v[212:215]
    s_add_u32 m0, s61, 4320
    s_nop 0
    buffer_load_dwordx4 v14, s[20:23], s58 offen offset:3072  lds
    s_add_u32 s57, s57, 32768
    s_add_u32 s58, s58, 32768
    v_mfma_f32_16x16x32_bf16 v[216:219], v[36:39], v[72:75], v[216:219]
    v_mfma_f32_16x16x32_bf16 v[220:223], v[36:39], v[76:79], v[220:223]
    s_waitcnt lgkmcnt(0)
    s_waitcnt vmcnt(8)
    s_barrier
    ds_read_b64_tr_b16 v[32:33], v9 offset:0
    ds_read_b64_tr_b16 v[34:35], v9 offset:16896
    ds_read_b64_tr_b16 v[36:37], v9 offset:32
    ds_read_b64_tr_b16 v[38:39], v9 offset:16928
    v_mfma_f32_16x16x32_bf16 v[224:227], v[40:43], v[64:67], v[224:227]
    v_mfma_f32_16x16x32_bf16 v[228:231], v[40:43], v[68:71], v[228:231]
    s_add_u32 m0, s61, 33792
    s_nop 0
    buffer_load_dwordx4 v14, s[20:23], s57 offen offset:0  lds
    v_mfma_f32_16x16x32_bf16 v[232:235], v[40:43], v[72:75], v[232:235]
    v_mfma_f32_16x16x32_bf16 v[236:239], v[40:43], v[76:79], v[236:239]
    ds_read_b64_tr_b16 v[40:41], v9 offset:64
    ds_read_b64_tr_b16 v[42:43], v9 offset:16960
    v_mfma_f32_16x16x32_bf16 v[240:243], v[44:47], v[64:67], v[240:243]
    v_mfma_f32_16x16x32_bf16 v[244:247], v[44:47], v[68:71], v[244:247]
    s_add_u32 m0, s61, 33824
    s_nop 0
    buffer_load_dwordx4 v14, s[20:23], s57 offen offset:1024  lds
    v_mfma_f32_16x16x32_bf16 v[248:251], v[44:47], v[72:75], v[248:251]
    v_mfma_f32_16x16x32_bf16 v[252:255], v[44:47], v[76:79], v[252:255]
    ds_read_b64_tr_b16 v[44:45], v9 offset:96
    ds_read_b64_tr_b16 v[46:47], v9 offset:16992
    s_waitcnt lgkmcnt(6)
    v_mfma_f32_16x16x32_bf16 v[128:131], v[32:35], v[80:83], v[128:131]
    v_mfma_f32_16x16x32_bf16 v[132:135], v[32:35], v[84:87], v[132:135]
    s_add_u32 m0, s61, 33856
    s_nop 0
    buffer_load_dwordx4 v14, s[20:23], s57 offen offset:2048  lds
    v_mfma_f32_16x16x32_bf16 v[136:139], v[32:35], v[88:91], v[136:139]
    v_mfma_f32_16x16x32_bf16 v[140:143], v[32:35], v[92:95], v[140:143]
    s_waitcnt lgkmcnt(4)
    v_mfma_f32_16x16x32_bf16 v[144:147], v[36:39], v[80:83], v[144:147]
    ds_read_b64_tr_b16 v[32:33], v9 offset:128
    ds_read_b64_tr_b16 v[34:35], v9 offset:17024
    v_mfma_f32_16x16x32_bf16 v[148:151], v[36:39], v[84:87], v[148:151]
    s_add_u32 m0, s61, 33888
    s_nop 0
    buffer_load_dwordx4 v14, s[20:23], s57 offen offset:3072  lds
    v_mfma_f32_16x16x32_bf16 v[152:155], v[36:39], v[88:91], v[152:155]
    v_mfma_f32_16x16x32_bf16 v[156:159], v[36:39], v[92:95], v[156:159]
    s_waitcnt lgkmcnt(4)
    v_mfma_f32_16x16x32_bf16 v[160:163], v[40:43], v[80:83], v[160:163]
    ds_read_b64_tr_b16 v[36:37], v9 offset:160
    ds_read_b64_tr_b16 v[38:39], v9 offset:17056
    v_mfma_f32_16x16x32_bf16 v[164:167], v[40:43], v[84:87], v[164:167]
    s_add_u32 m0, s61, 38016
    s_nop 0
    buffer_load_dwordx4 v14, s[20:23], s58 offen offset:0  lds
    v_mfma_f32_16x16x32_bf16 v[168:171], v[40:43], v[88:91], v[168:171]
    v_mfma_f32_16x16x32_bf16 v[172:175], v[40:43], v[92:95], v[172:175]
    s_waitcnt lgkmcnt(4)
    v_mfma_f32_16x16x32_bf16 v[176:179], v[44:47], v[80:83], v[176:179]
    ds_read_b64_tr_b16 v[40:41], v9 offset:192
    ds_read_b64_tr_b16 v[42:43], v9 offset:17088
    v_mfma_f32_16x16x32_bf16 v[180:183], v[44:47], v[84:87], v[180:183]
    s_add_u32 m0, s61, 38048
    s_nop 0
    buffer_load_dwordx4 v14, s[20:23], s58 offen offset:1024  lds
    v_mfma_f32_16x16x32_bf16 v[184:187], v[44:47], v[88:91], v[184:187]
    v_mfma_f32_16x16x32_bf16 v[188:191], v[44:47], v[92:95], v[188:191]
    s_waitcnt lgkmcnt(4)
    v_mfma_f32_16x16x32_bf16 v[192:195], v[32:35], v[80:83], v[192:195]
    ds_read_b64_tr_b16 v[44:45], v9 offset:224
    ds_read_b64_tr_b16 v[46:47], v9 offset:17120
    v_mfma_f32_16x16x32_bf16 v[196:199], v[32:35], v[84:87], v[196:199]
    s_add_u32 m0, s61, 38080
    s_nop 0
    buffer_load_dwordx4 v14, s[20:23], s58 offen offset:2048  lds
    v_mfma_f32_16x16x32_bf16 v[200:203], v[32:35], v[88:91], v[200:203]
    v_mfma_f32_16x16x32_bf16 v[204:207], v[32:35], v[92:95], v[204:207]
    s_waitcnt lgkmcnt(4)
    v_mfma_f32_16x16x32_bf16 v[208:211], v[36:39], v[80:83], v[208:211]
    v_mfma_f32_16x16x32_bf16 v[212:215], v[36:39], v[84:87], v[212:215]
    s_add_u32 m0, s61, 38112
    s_nop 0
    buffer_load_dwordx4 v14, s[20:23], s58 offen offset:3072  lds
    s_add_u32 s57, s57, 32768
    s_add_u32 s58, s58, 32768
    v_mfma_f32_16x16x32_bf16 v[216:219], v[36:39], v[88:91], v[216:219]
    v_mfma_f32_16x16x32_bf16 v[220:223], v[36:39], v[92:95], v[220:223]
    s_waitcnt lgkmcnt(0)
    s_barrier
    v_mfma_f32_16x16x32_bf16 v[224:227], v[40:43], v[80:83], v[224:227]
    v_mfma_f32_16x16x32_bf16 v[228:231], v[40:43], v[84:87], v[228:231]
    v_mfma_f32_16x16x32_bf16 v[232:235], v[40:43], v[88:91], v[232:235]
    v_mfma_f32_16x16x32_bf16 v[236:239], v[40:43], v[92:95], v[236:239]
    v_mfma_f32_16x16x32_bf16 v[240:243], v[44:47], v[80:83], v[240:243]
    v_mfma_f32_16x16x32_bf16 v[244:247], v[44:47], v[84:87], v[244:247]
    v_mfma_f32_16x16x32_bf16 v[248:251], v[44:47], v[88:91], v[248:251]
    v_mfma_f32_16x16x32_bf16 v[252:255], v[44:47], v[92:95], v[252:255]
    s_nop 7
    v_lshrrev_b32 v13, 1, v3
    v_lshlrev_b32 v13, 8, v13
    v_lshl_add_u32 v13, v2, 4, v13
    v_and_b32 v12, 1, v3
    v_lshl_add_u32 v13, v12, 3, v13
    s_lshl_b32 s53, s49, 15
    s_lshl_b32 s54, s50, 12
    s_add_u32 s53, s53, s54
    s_add_u32 s53, s53, 67584
    v_add_u32 v13, s53, v13
    v_cvt_pk_bf16_f32 v16, v128, v129
    v_cvt_pk_bf16_f32 v17, v130, v131
    ds_write_b64 v13, v[16:17] offset:0
    v_cvt_pk_bf16_f32 v18, v132, v133
    v_cvt_pk_bf16_f32 v19, v134, v135
    ds_write_b64 v13, v[18:19] offset:8192
    v_cvt_pk_bf16_f32 v20, v136, v137
    v_cvt_pk_bf16_f32 v21, v138, v139
    ds_write_b64 v13, v[20:21] offset:16384
    v_cvt_pk_bf16_f32 v22, v140, v141
    v_cvt_pk_bf16_f32 v23, v142, v143
    ds_write_b64 v13, v[22:23] offset:24576
    v_cvt_pk_bf16_f32 v24, v144, v145
    v_cvt_pk_bf16_f32 v25, v146, v147
    ds_write_b64 v13, v[24:25] offset:512
    v_cvt_pk_bf16_f32 v26, v148, v149
    v_cvt_pk_bf16_f32 v27, v150, v151
    ds_write_b64 v13, v[26:27] offset:8704
    v_cvt_pk_bf16_f32 v28, v152, v153
    v_cvt_pk_bf16_f32 v29, v154, v155
    ds_write_b64 v13, v[28:29] offset:16896
    v_cvt_pk_bf16_f32 v30, v156, v157
    v_cvt_pk_bf16_f32 v31, v158, v159
    ds_write_b64 v13, v[30:31] offset:25088
    v_cvt_pk_bf16_f32 v16, v160, v161
    v_cvt_pk_bf16_f32 v17, v162, v163
    ds_write_b64 v13, v[16:17] offset:1024
    v_cvt_pk_bf16_f32 v18, v164, v165
    v_cvt_pk_bf16_f32 v19, v166, v167
    ds_write_b64 v13, v[18:19] offset:9216
    v_cvt_pk_bf16_f32 v20, v168, v169
    v_cvt_pk_bf16_f32 v21, v170, v171
    ds_write_b64 v13, v[20:21] offset:17408
    v_cvt_pk_bf16_f32 v22, v172, v173
    v_cvt_pk_bf16_f32 v23, v174, v175
    ds_write_b64 v13, v[22:23] offset:25600
    v_cvt_pk_bf16_f32 v24, v176, v177
    v_cvt_pk_bf16_f32 v25, v178, v179
    ds_write_b64 v13, v[24:25] offset:1536
    v_cvt_pk_bf16_f32 v26, v180, v181
    v_cvt_pk_bf16_f32 v27, v182, v183
    ds_write_b64 v13, v[26:27] offset:9728
    v_cvt_pk_bf16_f32 v28, v184, v185
    v_cvt_pk_bf16_f32 v29, v186, v187
    ds_write_b64 v13, v[28:29] offset:17920
    v_cvt_pk_bf16_f32 v30, v188, v189
    v_cvt_pk_bf16_f32 v31, v190, v191
    ds_write_b64 v13, v[30:31] offset:26112
    v_cvt_pk_bf16_f32 v16, v192, v193
    v_cvt_pk_bf16_f32 v17, v194, v195
    ds_write_b64 v13, v[16:17] offset:2048
    v_cvt_pk_bf16_f32 v18, v196, v197
    v_cvt_pk_bf16_f32 v19, v198, v199
    ds_write_b64 v13, v[18:19] offset:10240
    v_cvt_pk_bf16_f32 v20, v200, v201
    v_cvt_pk_bf16_f32 v21, v202, v203
    ds_write_b64 v13, v[20:21] offset:18432
    v_cvt_pk_bf16_f32 v22, v204, v205
    v_cvt_pk_bf16_f32 v23, v206, v207
    ds_write_b64 v13, v[22:23] offset:26624
    v_cvt_pk_bf16_f32 v24, v208, v209
    v_cvt_pk_bf16_f32 v25, v210, v211
    ds_write_b64 v13, v[24:25] offset:2560
    v_cvt_pk_bf16_f32 v26, v212, v213
    v_cvt_pk_bf16_f32 v27, v214, v215
    ds_write_b64 v13, v[26:27] offset:10752
    v_cvt_pk_bf16_f32 v28, v216, v217
    v_cvt_pk_bf16_f32 v29, v218, v219
    ds_write_b64 v13, v[28:29] offset:18944
    v_cvt_pk_bf16_f32 v30, v220, v221
    v_cvt_pk_bf16_f32 v31, v222, v223
    ds_write_b64 v13, v[30:31] offset:27136
    v_cvt_pk_bf16_f32 v16, v224, v225
    v_cvt_pk_bf16_f32 v17, v226, v227
    ds_write_b64 v13, v[16:17] offset:3072
    v_cvt_pk_bf16_f32 v18, v228, v229
    v_cvt_pk_bf16_f32 v19, v230, v231
    ds_write_b64 v13, v[18:19] offset:11264
    v_cvt_pk_bf16_f32 v20, v232, v233
    v_cvt_pk_bf16_f32 v21, v234, v235
    ds_write_b64 v13, v[20:21] offset:19456
    v_cvt_pk_bf16_f32 v22, v236, v237
    v_cvt_pk_bf16_f32 v23, v238, v239
    ds_write_b64 v13, v[22:23] offset:27648
    v_cvt_pk_bf16_f32 v24, v240, v241
    v_cvt_pk_bf16_f32 v25, v242, v243
    ds_write_b64 v13, v[24:25] offset:3584
    v_cvt_pk_bf16_f32 v26, v244, v245
    v_cvt_pk_bf16_f32 v27, v246, v247
    ds_write_b64 v13, v[26:27] offset:11776
    v_cvt_pk_bf16_f32 v28, v248, v249
    v_cvt_pk_bf16_f32 v29, v250, v251
    ds_write_b64 v13, v[28:29] offset:19968
    v_cvt_pk_bf16_f32 v30, v252, v253
    v_cvt_pk_bf16_f32 v31, v254, v255
    ds_write_b64 v13, v[30:31] offset:28160
    s_waitcnt lgkmcnt(0)
    s_barrier
    v_lshlrev_b32 v13, 4, v1
    s_lshl_b32 s53, s49, 15
    s_add_u32 s53, s53, 67584
    v_add_u32 v13, s53, v13
    s_lshl_b32 s54, s50, 14
    v_add_u32 v12, s54, v13
    v_subrev_u32 v13, s54, v13
    v_add_u32 v13, 16384, v13
    ds_read_b128 a[128:131], v12 offset:0
    ds_read_b128 a[132:135], v12 offset:1024
    ds_read_b128 a[136:139], v12 offset:2048
    ds_read_b128 a[140:143], v12 offset:3072
    ds_read_b128 a[144:147], v12 offset:4096
    ds_read_b128 a[148:151], v12 offset:5120
    ds_read_b128 a[152:155], v12 offset:6144
    ds_read_b128 a[156:159], v12 offset:7168
    ds_read_b128 a[160:163], v12 offset:8192
    ds_read_b128 a[164:167], v12 offset:9216
    ds_read_b128 a[168:171], v12 offset:10240
    ds_read_b128 a[172:175], v12 offset:11264
    ds_read_b128 a[176:179], v12 offset:12288
    ds_read_b128 a[180:183], v12 offset:13312
    ds_read_b128 a[184:187], v12 offset:14336
    ds_read_b128 a[188:191], v12 offset:15360
    ds_read_b128 a[192:195], v13 offset:0
    ds_read_b128 a[196:199], v13 offset:1024
    ds_read_b128 a[200:203], v13 offset:2048
    ds_read_b128 a[204:207], v13 offset:3072
    ds_read_b128 a[208:211], v13 offset:4096
    ds_read_b128 a[212:215], v13 offset:5120
    ds_read_b128 a[216:219], v13 offset:6144
    ds_read_b128 a[220:223], v13 offset:7168
    ds_read_b128 a[224:227], v13 offset:8192
    ds_read_b128 a[228:231], v13 offset:9216
    ds_read_b128 a[232:235], v13 offset:10240
    ds_read_b128 a[236:239], v13 offset:11264
    ds_read_b128 a[240:243], v13 offset:12288
    ds_read_b128 a[244:247], v13 offset:13312
    ds_read_b128 a[248:251], v13 offset:14336
    ds_read_b128 a[252:255], v13 offset:15360
    s_waitcnt lgkmcnt(0)
    s_waitcnt vmcnt(8)
    s_barrier
    v_mov_b32 v11, v14
    v_lshrrev_b32 v15, 5, v1
    v_lshlrev_b32 v14, 1, v15
    v_and_b32 v12, 31, v1
    v_xor_b32 v12, v12, v14
    v_lshlrev_b32 v12, 4, v12
    v_lshl_add_u32 v12, v15, 9, v12
    v_lshrrev_b32 v13, 1, v2
    v_mul_u32_u24 v13, 1056, v13
    v_and_b32 v14, 1, v2
    v_lshl_add_u32 v13, v14, 9, v13
    v_xor_b32 v14, v14, v3
    v_lshl_add_u32 v13, v14, 4, v13
    s_mul_i32 s53, s50, 16896
    v_add_u32 v8, s53, v13
    v_lshrrev_b32 v13, 1, v4
    v_lshl_add_u32 v13, v3, 1, v13
    v_mul_u32_u24 v13, 1088, v13
    v_and_b32 v14, 1, v4
    v_lshl_add_u32 v13, v14, 9, v13
    v_lshl_add_u32 v13, v5, 3, v13
    s_mul_i32 s53, s50, 17408
    s_add_u32 s53, s53, 67584
    v_add_u32 v13, s53, v13
    v_lshlrev_b32 v14, 5, v14
    v_add_u32 v9, v13, v14
    v_sub_u32 v10, v13, v14
    s_lshl_b32 s59, s48, 13
    s_add_u32 s60, s59, 4096
    ds_read_b128 v[32:35], v8 offset:0
    ds_read_b128 v[36:39], v8 offset:64
    ds_read_b128 v[40:43], v8 offset:128
    ds_read_b128 v[44:47], v8 offset:192
    s_waitcnt lgkmcnt(3)
    v_mfma_f32_16x16x32_bf16 v[96:99], v[32:35], a[128:131], 0
    v_mov_b32 v128, 0
    v_mov_b32 v129, 0
    v_mfma_f32_16x16x32_bf16 v[100:103], v[32:35], a[160:163], 0
    s_add_u32 m0, s62, 67584
    s_nop 0
    buffer_load_dwordx4 v12, s[24:27], s59 offen offset:0  lds
    v_mfma_f32_16x16x32_bf16 v[104:107], v[32:35], a[192:195], 0
    v_mov_b32 v130, 0
    v_mov_b32 v131, 0
    v_mfma_f32_16x16x32_bf16 v[108:111], v[32:35], a[224:227], 0
    ds_read_b128 v[32:35], v8 offset:256
    v_mov_b32 v132, 0
    s_waitcnt lgkmcnt(3)
    v_mfma_f32_16x16x32_bf16 v[96:99], v[36:39], a[132:135], v[96:99]
    v_mov_b32 v133, 0
    v_mov_b32 v134, 0
    v_mfma_f32_16x16x32_bf16 v[100:103], v[36:39], a[164:167], v[100:103]
    v_mov_b32 v135, 0
    v_mov_b32 v136, 0
    v_mfma_f32_16x16x32_bf16 v[104:107], v[36:39], a[196:199], v[104:107]
    v_mov_b32 v137, 0
    v_mov_b32 v138, 0
    v_mfma_f32_16x16x32_bf16 v[108:111], v[36:39], a[228:231], v[108:111]
    ds_read_b128 v[36:39], v8 offset:320
    s_add_u32 m0, s62, 67648
    s_nop 0
    buffer_load_dwordx4 v12, s[24:27], s59 offen offset:1024  lds
    s_waitcnt lgkmcnt(3)
    v_mfma_f32_16x16x32_bf16 v[96:99], v[40:43], a[136:139], v[96:99]
    v_mov_b32 v139, 0
    v_mov_b32 v140, 0
    v_mfma_f32_16x16x32_bf16 v[100:103], v[40:43], a[168:171], v[100:103]
    v_mov_b32 v141, 0
    v_mov_b32 v142, 0
    v_mfma_f32_16x16x32_bf16 v[104:107], v[40:43], a[200:203], v[104:107]
    v_mov_b32 v143, 0
    v_mov_b32 v144, 0
    v_mfma_f32_16x16x32_bf16 v[108:111], v[40:43], a[232:235], v[108:111]
    ds_read_b128 v[40:43], v8 offset:384
    v_mov_b32 v145, 0
    s_waitcnt lgkmcnt(3)
    v_mfma_f32_16x16x32_bf16 v[96:99], v[44:47], a[140:143], v[96:99]
    v_mov_b32 v146, 0
    v_mov_b32 v147, 0
    v_mfma_f32_16x16x32_bf16 v[100:103], v[44:47], a[172:175], v[100:103]
    s_add_u32 m0, s62, 67712
    s_nop 0
    buffer_load_dwordx4 v12, s[24:27], s59 offen offset:2048  lds
    v_mfma_f32_16x16x32_bf16 v[104:107], v[44:47], a[204:207], v[104:107]
    v_mov_b32 v148, 0
    v_mov_b32 v149, 0
    v_mfma_f32_16x16x32_bf16 v[108:111], v[44:47], a[236:239], v[108:111]
    ds_read_b128 v[44:47], v8 offset:448
    v_mov_b32 v150, 0
    s_waitcnt lgkmcnt(3)
    v_mfma_f32_16x16x32_bf16 v[96:99], v[32:35], a[144:147], v[96:99]
    v_mov_b32 v151, 0
    v_mov_b32 v152, 0
    v_mfma_f32_16x16x32_bf16 v[100:103], v[32:35], a[176:179], v[100:103]
    v_mov_b32 v153, 0
    v_mov_b32 v154, 0
    v_mfma_f32_16x16x32_bf16 v[104:107], v[32:35], a[208:211], v[104:107]
    v_mov_b32 v155, 0
    v_mov_b32 v156, 0
    v_mfma_f32_16x16x32_bf16 v[108:111], v[32:35], a[240:243], v[108:111]
    ds_read_b128 v[32:35], v8 offset:8448
    s_add_u32 m0, s62, 67776
    s_nop 0
    buffer_load_dwordx4 v12, s[24:27], s59 offen offset:3072  lds
    s_waitcnt lgkmcnt(3)
    v_mfma_f32_16x16x32_bf16 v[96:99], v[36:39], a[148:151], v[96:99]
    v_mov_b32 v157, 0
    v_mov_b32 v158, 0
    v_mfma_f32_16x16x32_bf16 v[100:103], v[36:39], a[180:183], v[100:103]
    v_mov_b32 v159, 0
    v_mov_b32 v160, 0
    v_mfma_f32_16x16x32_bf16 v[104:107], v[36:39], a[212:215], v[104:107]
    v_mov_b32 v161, 0
    v_mov_b32 v162, 0
    v_mfma_f32_16x16x32_bf16 v[108:111], v[36:39], a[244:247], v[108:111]
    ds_read_b128 v[36:39], v8 offset:8512
    v_mov_b32 v163, 0
    s_waitcnt lgkmcnt(3)
    v_mfma_f32_16x16x32_bf16 v[96:99], v[40:43], a[152:155], v[96:99]
    v_mov_b32 v164, 0
    v_mov_b32 v165, 0
    v_mfma_f32_16x16x32_bf16 v[100:103], v[40:43], a[184:187], v[100:103]
    s_add_u32 m0, s62, 71936
    s_nop 0
    buffer_load_dwordx4 v12, s[24:27], s60 offen offset:0  lds
    v_mfma_f32_16x16x32_bf16 v[104:107], v[40:43], a[216:219], v[104:107]
    v_mov_b32 v166, 0
    v_mov_b32 v167, 0
    v_mfma_f32_16x16x32_bf16 v[108:111], v[40:43], a[248:251], v[108:111]
    ds_read_b128 v[40:43], v8 offset:8576
    v_mov_b32 v168, 0
    s_waitcnt lgkmcnt(3)
    v_mfma_f32_16x16x32_bf16 v[96:99], v[44:47], a[156:159], v[96:99]
    v_mov_b32 v169, 0
    v_mov_b32 v170, 0
    v_mfma_f32_16x16x32_bf16 v[100:103], v[44:47], a[188:191], v[100:103]
    v_mov_b32 v171, 0
    v_mov_b32 v172, 0
    v_mfma_f32_16x16x32_bf16 v[104:107], v[44:47], a[220:223], v[104:107]
    v_mov_b32 v173, 0
    v_mov_b32 v174, 0
    v_mfma_f32_16x16x32_bf16 v[108:111], v[44:47], a[252:255], v[108:111]
    ds_read_b128 v[44:47], v8 offset:8640
    s_add_u32 m0, s62, 72000
    s_nop 0
    buffer_load_dwordx4 v12, s[24:27], s60 offen offset:1024  lds
    s_waitcnt lgkmcnt(3)
    v_mfma_f32_16x16x32_bf16 v[112:115], v[32:35], a[128:131], 0
    v_mov_b32 v175, 0
    v_mov_b32 v176, 0
    v_mfma_f32_16x16x32_bf16 v[116:119], v[32:35], a[160:163], 0
    v_mov_b32 v177, 0
    v_mov_b32 v178, 0
    v_mfma_f32_16x16x32_bf16 v[120:123], v[32:35], a[192:195], 0
    v_mov_b32 v179, 0
    v_mov_b32 v180, 0
    v_mfma_f32_16x16x32_bf16 v[124:127], v[32:35], a[224:227], 0
    ds_read_b128 v[32:35], v8 offset:8704
    v_mov_b32 v181, 0
    s_waitcnt lgkmcnt(3)
    v_mfma_f32_16x16x32_bf16 v[112:115], v[36:39], a[132:135], v[112:115]
    v_mov_b32 v182, 0
    v_mov_b32 v183, 0
    v_mfma_f32_16x16x32_bf16 v[116:119], v[36:39], a[164:167], v[116:119]
    s_add_u32 m0, s62, 72064
    s_nop 0
    buffer_load_dwordx4 v12, s[24:27], s60 offen offset:2048  lds
    v_mfma_f32_16x16x32_bf16 v[120:123], v[36:39], a[196:199], v[120:123]
    v_mov_b32 v184, 0
    v_mov_b32 v185, 0
    v_mfma_f32_16x16x32_bf16 v[124:127], v[36:39], a[228:231], v[124:127]
    ds_read_b128 v[36:39], v8 offset:8768
    v_mov_b32 v186, 0
    s_waitcnt lgkmcnt(3)
    v_mfma_f32_16x16x32_bf16 v[112:115], v[40:43], a[136:139], v[112:115]
    v_mov_b32 v187, 0
    v_mov_b32 v188, 0
    v_mfma_f32_16x16x32_bf16 v[116:119], v[40:43], a[168:171], v[116:119]
    v_mov_b32 v189, 0
    v_mov_b32 v190, 0
    v_mfma_f32_16x16x32_bf16 v[120:123], v[40:43], a[200:203], v[120:123]
    v_mov_b32 v191, 0
    v_mov_b32 v192, 0
    v_mfma_f32_16x16x32_bf16 v[124:127], v[40:43], a[232:235], v[124:127]
    ds_read_b128 v[40:43], v8 offset:8832
    s_add_u32 m0, s62, 72128
    s_nop 0
    buffer_load_dwordx4 v12, s[24:27], s60 offen offset:3072  lds
    s_waitcnt lgkmcnt(3)
    v_mfma_f32_16x16x32_bf16 v[112:115], v[44:47], a[140:143], v[112:115]
    v_mov_b32 v193, 0
    v_mov_b32 v194, 0
    v_mfma_f32_16x16x32_bf16 v[116:119], v[44:47], a[172:175], v[116:119]
    v_mov_b32 v195, 0
    v_mov_b32 v196, 0
    v_mfma_f32_16x16x32_bf16 v[120:123], v[44:47], a[204:207], v[120:123]
    v_mov_b32 v197, 0
    v_mov_b32 v198, 0
    v_mfma_f32_16x16x32_bf16 v[124:127], v[44:47], a[236:239], v[124:127]
    ds_read_b128 v[44:47], v8 offset:8896
    v_mov_b32 v199, 0
    s_waitcnt lgkmcnt(3)
    v_mfma_f32_16x16x32_bf16 v[112:115], v[32:35], a[144:147], v[112:115]
    v_mov_b32 v200, 0
    v_mov_b32 v201, 0
    v_mfma_f32_16x16x32_bf16 v[116:119], v[32:35], a[176:179], v[116:119]
    v_mov_b32 v202, 0
    v_mov_b32 v203, 0
    v_mfma_f32_16x16x32_bf16 v[120:123], v[32:35], a[208:211], v[120:123]
    s_add_u32 s59, s59, 32768
    s_add_u32 s60, s60, 32768
    v_mov_b32 v204, 0
    v_mfma_f32_16x16x32_bf16 v[124:127], v[32:35], a[240:243], v[124:127]
    v_mov_b32 v205, 0
    v_mov_b32 v206, 0
    s_waitcnt lgkmcnt(2)
    v_mfma_f32_16x16x32_bf16 v[112:115], v[36:39], a[148:151], v[112:115]
    v_mov_b32 v207, 0
    v_mov_b32 v208, 0
    v_mfma_f32_16x16x32_bf16 v[116:119], v[36:39], a[180:183], v[116:119]
    v_mov_b32 v209, 0
    v_mov_b32 v210, 0
    v_mfma_f32_16x16x32_bf16 v[120:123], v[36:39], a[212:215], v[120:123]
    v_mov_b32 v211, 0
    v_mov_b32 v212, 0
    v_mfma_f32_16x16x32_bf16 v[124:127], v[36:39], a[244:247], v[124:127]
    v_mov_b32 v213, 0
    v_mov_b32 v214, 0
    s_waitcnt lgkmcnt(0)
    s_waitcnt vmcnt(8)
    s_barrier
    v_mfma_f32_16x16x32_bf16 v[112:115], v[40:43], a[152:155], v[112:115]
    v_mov_b32 v215, 0
    v_mov_b32 v216, 0
    v_mfma_f32_16x16x32_bf16 v[116:119], v[40:43], a[184:187], v[116:119]
    v_mov_b32 v217, 0
    v_mov_b32 v218, 0
    v_mfma_f32_16x16x32_bf16 v[120:123], v[40:43], a[216:219], v[120:123]
    v_mov_b32 v219, 0
    v_mov_b32 v220, 0
    v_mfma_f32_16x16x32_bf16 v[124:127], v[40:43], a[248:251], v[124:127]
    v_mov_b32 v221, 0
    v_mov_b32 v222, 0
    v_mfma_f32_16x16x32_bf16 v[112:115], v[44:47], a[156:159], v[112:115]
    v_mov_b32 v223, 0
    v_mov_b32 v224, 0
    v_mfma_f32_16x16x32_bf16 v[116:119], v[44:47], a[188:191], v[116:119]
    v_mov_b32 v225, 0
    v_mov_b32 v226, 0
    v_mfma_f32_16x16x32_bf16 v[120:123], v[44:47], a[220:223], v[120:123]
    v_mov_b32 v227, 0
    v_mov_b32 v228, 0
    v_mfma_f32_16x16x32_bf16 v[124:127], v[44:47], a[252:255], v[124:127]
    v_mov_b32 v229, 0
    v_mov_b32 v230, 0
    v_mov_b32 v231, 0
    v_mov_b32 v232, 0
    v_mov_b32 v233, 0
    v_mov_b32 v234, 0
    v_mov_b32 v235, 0
    v_mov_b32 v236, 0
    v_mov_b32 v237, 0
    v_mov_b32 v238, 0
    v_mov_b32 v239, 0
    v_mov_b32 v240, 0
    v_mov_b32 v241, 0
    v_mov_b32 v242, 0
    v_mov_b32 v243, 0
    v_mov_b32 v244, 0
    v_mov_b32 v245, 0
    v_mov_b32 v246, 0
    v_mov_b32 v247, 0
    v_mov_b32 v248, 0
    v_mov_b32 v249, 0
    v_mov_b32 v250, 0
    v_mov_b32 v251, 0
    v_mov_b32 v252, 0
    v_mov_b32 v253, 0
    v_mov_b32 v254, 0
    v_mov_b32 v255, 0
    ds_read_b128 v[32:35], v8 offset:33792
    ds_read_b128 v[36:39], v8 offset:33856
    ds_read_b128 v[40:43], v8 offset:33920
    ds_read_b128 v[44:47], v8 offset:33984
    s_nop 3
    v_max3_f32 v24, v96, v97, v98
    v_max3_f32 v26, v100, v101, v102
    v_max3_f32 v28, v104, v105, v106
    v_max3_f32 v30, v108, v109, v110
    v_max3_f32 v24, v24, v99, v112
    v_max3_f32 v26, v26, v103, v116
    v_max3_f32 v28, v28, v107, v120
    v_max3_f32 v30, v30, v111, v124
    v_max3_f32 v24, v24, v113, v114
    v_max3_f32 v26, v26, v117, v118
    v_max3_f32 v28, v28, v121, v122
    v_max3_f32 v30, v30, v125, v126
    v_max_f32 v24, v24, v115
    s_add_u32 m0, s61, 0
    s_nop 0
    buffer_load_dwordx4 v11, s[20:23], s57 offen offset:0  lds
    v_max_f32 v26, v26, v119
    v_max_f32 v28, v28, v123
    v_max_f32 v30, v30, v127
    v_mov_b32 v25, v24
    v_mov_b32 v27, v26
    v_mov_b32 v29, v28
    v_mov_b32 v31, v30
    v_permlane16_swap_b32 v24, v25
    v_permlane16_swap_b32 v26, v27
    v_permlane16_swap_b32 v28, v29
    v_permlane16_swap_b32 v30, v31
    v_max_f32 v24, v24, v25
    v_max_f32 v26, v26, v27
    v_max_f32 v28, v28, v29
    v_max_f32 v30, v30, v31
    v_mov_b32 v25, v24
    v_mov_b32 v27, v26
    v_mov_b32 v29, v28
    s_add_u32 m0, s61, 32
    s_nop 0
    buffer_load_dwordx4 v11, s[20:23], s57 offen offset:1024  lds
    v_mov_b32 v31, v30
    v_permlane32_swap_b32 v24, v25
    v_permlane32_swap_b32 v26, v27
    v_permlane32_swap_b32 v28, v29
    v_permlane32_swap_b32 v30, v31
    v_max_f32 v24, v24, v25
    v_max_f32 v26, v26, v27
    v_max_f32 v28, v28, v29
    v_max_f32 v30, v30, v31
    s_mov_b32 s53, 0x42900000
    v_add_f32 v24, s53, v24
    v_add_f32 v26, s53, v26
    v_add_f32 v28, s53, v28
    v_add_f32 v30, s53, v30
    v_sub_f32 v48, 0, v24
    v_sub_f32 v49, 0, v24
    v_sub_f32 v50, 0, v24
    v_sub_f32 v51, 0, v24
    s_add_u32 m0, s61, 64
    s_nop 0
    buffer_load_dwordx4 v11, s[20:23], s57 offen offset:2048  lds
    v_pk_add_f32 v[96:97], v[96:97], v[24:25] op_sel_hi:[1,0] neg_lo:[0,1] neg_hi:[0,1]
    v_pk_add_f32 v[98:99], v[98:99], v[24:25] op_sel_hi:[1,0] neg_lo:[0,1] neg_hi:[0,1]
    v_pk_add_f32 v[112:113], v[112:113], v[24:25] op_sel_hi:[1,0] neg_lo:[0,1] neg_hi:[0,1]
    v_pk_add_f32 v[114:115], v[114:115], v[24:25] op_sel_hi:[1,0] neg_lo:[0,1] neg_hi:[0,1]
    v_mov_b32 v16, 0
    v_sub_f32 v52, 0, v26
    v_sub_f32 v53, 0, v26
    v_sub_f32 v54, 0, v26
    v_sub_f32 v55, 0, v26
    v_pk_add_f32 v[100:101], v[100:101], v[26:27] op_sel_hi:[1,0] neg_lo:[0,1] neg_hi:[0,1]
    v_pk_add_f32 v[102:103], v[102:103], v[26:27] op_sel_hi:[1,0] neg_lo:[0,1] neg_hi:[0,1]
    v_pk_add_f32 v[116:117], v[116:117], v[26:27] op_sel_hi:[1,0] neg_lo:[0,1] neg_hi:[0,1]
    v_pk_add_f32 v[118:119], v[118:119], v[26:27] op_sel_hi:[1,0] neg_lo:[0,1] neg_hi:[0,1]
    v_mov_b32 v17, 0
    v_sub_f32 v56, 0, v28
    v_sub_f32 v57, 0, v28
    v_sub_f32 v58, 0, v28
    v_sub_f32 v59, 0, v28
    s_add_u32 m0, s61, 96
    s_nop 0
    buffer_load_dwordx4 v11, s[20:23], s57 offen offset:3072  lds
    v_pk_add_f32 v[104:105], v[104:105], v[28:29] op_sel_hi:[1,0] neg_lo:[0,1] neg_hi:[0,1]
    v_pk_add_f32 v[106:107], v[106:107], v[28:29] op_sel_hi:[1,0] neg_lo:[0,1] neg_hi:[0,1]
    v_pk_add_f32 v[120:121], v[120:121], v[28:29] op_sel_hi:[1,0] neg_lo:[0,1] neg_hi:[0,1]
    v_pk_add_f32 v[122:123], v[122:123], v[28:29] op_sel_hi:[1,0] neg_lo:[0,1] neg_hi:[0,1]
    v_mov_b32 v18, 0
    v_sub_f32 v60, 0, v30
    v_sub_f32 v61, 0, v30
    v_sub_f32 v62, 0, v30
    v_sub_f32 v63, 0, v30
    v_pk_add_f32 v[108:109], v[108:109], v[30:31] op_sel_hi:[1,0] neg_lo:[0,1] neg_hi:[0,1]
    v_pk_add_f32 v[110:111], v[110:111], v[30:31] op_sel_hi:[1,0] neg_lo:[0,1] neg_hi:[0,1]
    v_pk_add_f32 v[124:125], v[124:125], v[30:31] op_sel_hi:[1,0] neg_lo:[0,1] neg_hi:[0,1]
    v_pk_add_f32 v[126:127], v[126:127], v[30:31] op_sel_hi:[1,0] neg_lo:[0,1] neg_hi:[0,1]
    v_mov_b32 v19, 0
    v_exp_f32 v96, v96
    v_exp_f32 v97, v97
    v_exp_f32 v98, v98
    v_exp_f32 v99, v99
    s_add_u32 m0, s61, 4224
    s_nop 0
    buffer_load_dwordx4 v11, s[20:23], s58 offen offset:0  lds
    v_exp_f32 v112, v112
    v_exp_f32 v113, v113
    v_exp_f32 v114, v114
    v_exp_f32 v115, v115
    v_exp_f32 v100, v100
    v_exp_f32 v101, v101
    v_exp_f32 v102, v102
    v_exp_f32 v103, v103
    v_exp_f32 v116, v116
    v_exp_f32 v117, v117
    v_exp_f32 v118, v118
    v_exp_f32 v119, v119
    v_exp_f32 v104, v104
    v_exp_f32 v105, v105
    v_exp_f32 v106, v106
    v_exp_f32 v107, v107
    v_exp_f32 v120, v120
    v_exp_f32 v121, v121
    s_add_u32 m0, s61, 4256
    s_nop 0
    buffer_load_dwordx4 v11, s[20:23], s58 offen offset:1024  lds
    v_exp_f32 v122, v122
    v_exp_f32 v123, v123
    v_exp_f32 v108, v108
    v_exp_f32 v109, v109
    v_exp_f32 v110, v110
    v_exp_f32 v111, v111
    v_exp_f32 v124, v124
    v_exp_f32 v125, v125
    v_exp_f32 v126, v126
    v_exp_f32 v127, v127
    v_add_f32 v20, v96, v97
    v_add_f32 v21, v100, v101
    v_add_f32 v22, v104, v105
    v_add_f32 v23, v108, v109
    v_add_f32 v20, v20, v98
    v_add_f32 v21, v21, v102
    v_add_f32 v22, v22, v106
    v_add_f32 v23, v23, v110
    s_add_u32 m0, s61, 4288
    s_nop 0
    buffer_load_dwordx4 v11, s[20:23], s58 offen offset:2048  lds
    v_add_f32 v20, v20, v99
    v_add_f32 v21, v21, v103
    v_add_f32 v22, v22, v107
    v_add_f32 v23, v23, v111
    v_add_f32 v20, v20, v112
    v_add_f32 v21, v21, v116
    v_add_f32 v22, v22, v120
    v_add_f32 v23, v23, v124
    v_add_f32 v20, v20, v113
    v_add_f32 v21, v21, v117
    v_add_f32 v22, v22, v121
    v_add_f32 v23, v23, v125
    v_add_f32 v20, v20, v114
    v_add_f32 v21, v21, v118
    v_add_f32 v22, v22, v122
    v_add_f32 v23, v23, v126
    v_add_f32 v20, v20, v115
    v_add_f32 v21, v21, v119
    s_add_u32 m0, s61, 4320
    s_nop 0
    buffer_load_dwordx4 v11, s[20:23], s58 offen offset:3072  lds
    v_add_f32 v22, v22, v123
    v_add_f32 v23, v23, v127
    v_cvt_pk_bf16_f32 v64, v96, v97
    v_cvt_pk_bf16_f32 v65, v98, v99
    v_cvt_pk_bf16_f32 v66, v112, v113
    v_cvt_pk_bf16_f32 v67, v114, v115
    v_cvt_pk_bf16_f32 v68, v100, v101
    v_cvt_pk_bf16_f32 v69, v102, v103
    v_cvt_pk_bf16_f32 v70, v116, v117
    v_cvt_pk_bf16_f32 v71, v118, v119
    v_cvt_pk_bf16_f32 v72, v104, v105
    v_cvt_pk_bf16_f32 v73, v106, v107
    v_cvt_pk_bf16_f32 v74, v120, v121
    v_cvt_pk_bf16_f32 v75, v122, v123
    v_cvt_pk_bf16_f32 v76, v108, v109
    v_cvt_pk_bf16_f32 v77, v110, v111
    v_cvt_pk_bf16_f32 v78, v124, v125
    v_cvt_pk_bf16_f32 v79, v126, v127
    s_mov_b32 s63, 15
    s_add_u32 s57, s57, 32768
    s_add_u32 s58, s58, 32768
    v_lshrrev_b32 v13, 3, v1
    v_mul_u32_u24 v14, 896, v13
    v_bfe_u32 v13, v1, 1, 2
    v_xor_b32 v13, v13, v3
    v_lshl_add_u32 v14, v13, 5, v14
    v_and_b32 v13, 1, v1
    v_lshl_add_u32 v14, v13, 4, v14
    s_mul_i32 s68, s48, 57344
    s_lshl_b32 s56, s48, 13
    s_lshl_b32 s53, s48, 6
    v_add_u32 v6, s53, v1
    v_min_u32 v6, 111, v6
    v_lshlrev_b32 v6, 7, v6
    s_mul_i32 s53, s52, 14336
    buffer_load_dword v7, v6, s[32:35], s53 offen
K2_loop:
    s_waitcnt lgkmcnt(3)
    v_mfma_f32_16x16x32_bf16 v[96:99], v[32:35], a[128:131], v[48:51]
    v_add_f32 v16, v16, v20
    v_mfma_f32_16x16x32_bf16 v[100:103], v[32:35], a[160:163], v[52:55]
    v_add_f32 v17, v17, v21
    s_add_u32 m0, s62, 102400
    v_mfma_f32_16x16x32_bf16 v[104:107], v[32:35], a[192:195], v[56:59]
    v_add_f32 v18, v18, v22
    buffer_load_dwordx4 v12, s[24:27], s59 offen offset:0  lds
    v_mfma_f32_16x16x32_bf16 v[108:111], v[32:35], a[224:227], v[60:63]
    v_add_f32 v19, v19, v23
    ds_read_b128 v[32:35], v8 offset:34048
    s_waitcnt lgkmcnt(3)
    v_mfma_f32_16x16x32_bf16 v[96:99], v[36:39], a[132:135], v[96:99]
    v_mfma_f32_16x16x32_bf16 v[100:103], v[36:39], a[164:167], v[100:103]
    s_add_u32 m0, s62, 102464
    v_mfma_f32_16x16x32_bf16 v[104:107], v[36:39], a[196:199], v[104:107]
    buffer_load_dwordx4 v12, s[24:27], s59 offen offset:1024  lds
    v_mfma_f32_16x16x32_bf16 v[108:111], v[36:39], a[228:231], v[108:111]
    ds_read_b128 v[36:39], v8 offset:34112
    s_waitcnt lgkmcnt(3)
    v_mfma_f32_16x16x32_bf16 v[96:99], v[40:43], a[136:139], v[96:99]
    v_mfma_f32_16x16x32_bf16 v[100:103], v[40:43], a[168:171], v[100:103]
    s_add_u32 m0, s62, 102528
    v_mfma_f32_16x16x32_bf16 v[104:107], v[40:43], a[200:203], v[104:107]
    buffer_load_dwordx4 v12, s[24:27], s59 offen offset:2048  lds
    v_mfma_f32_16x16x32_bf16 v[108:111], v[40:43], a[232:235], v[108:111]
    ds_read_b128 v[40:43], v8 offset:34176
    s_waitcnt lgkmcnt(3)
    v_mfma_f32_16x16x32_bf16 v[96:99], v[44:47], a[140:143], v[96:99]
    v_mfma_f32_16x16x32_bf16 v[100:103], v[44:47], a[172:175], v[100:103]
    s_add_u32 m0, s62, 102592
    v_mfma_f32_16x16x32_bf16 v[104:107], v[44:47], a[204:207], v[104:107]
    buffer_load_dwordx4 v12, s[24:27], s59 offen offset:3072  lds
    v_mfma_f32_16x16x32_bf16 v[108:111], v[44:47], a[236:239], v[108:111]
    ds_read_b128 v[44:47], v8 offset:34240
    s_waitcnt lgkmcnt(3)
    v_mfma_f32_16x16x32_bf16 v[96:99], v[32:35], a[144:147], v[96:99]
    v_mfma_f32_16x16x32_bf16 v[100:103], v[32:35], a[176:179], v[100:103]
    s_add_u32 m0, s62, 106752
    v_mfma_f32_16x16x32_bf16 v[104:107], v[32:35], a[208:211], v[104:107]
    buffer_load_dwordx4 v12, s[24:27], s60 offen offset:0  lds
    v_mfma_f32_16x16x32_bf16 v[108:111], v[32:35], a[240:243], v[108:111]
    ds_read_b128 v[32:35], v8 offset:42240
    s_waitcnt lgkmcnt(3)
    v_mfma_f32_16x16x32_bf16 v[96:99], v[36:39], a[148:151], v[96:99]
    v_mfma_f32_16x16x32_bf16 v[100:103], v[36:39], a[180:183], v[100:103]
    s_add_u32 m0, s62, 106816
    v_mfma_f32_16x16x32_bf16 v[104:107], v[36:39], a[212:215], v[104:107]
    buffer_load_dwordx4 v12, s[24:27], s60 offen offset:1024  lds
    v_mfma_f32_16x16x32_bf16 v[108:111], v[36:39], a[244:247], v[108:111]
    ds_read_b128 v[36:39], v8 offset:42304
    s_waitcnt lgkmcnt(3)
    v_mfma_f32_16x16x32_bf16 v[96:99], v[40:43], a[152:155], v[96:99]
    v_mfma_f32_16x16x32_bf16 v[100:103], v[40:43], a[184:187], v[100:103]
    s_add_u32 m0, s62, 106880
    v_mfma_f32_16x16x32_bf16 v[104:107], v[40:43], a[216:219], v[104:107]
    buffer_load_dwordx4 v12, s[24:27], s60 offen offset:2048  lds
    v_mfma_f32_16x16x32_bf16 v[108:111], v[40:43], a[248:251], v[108:111]
    ds_read_b128 v[40:43], v8 offset:42368
    s_waitcnt lgkmcnt(3)
    v_mfma_f32_16x16x32_bf16 v[96:99], v[44:47], a[156:159], v[96:99]
    v_mfma_f32_16x16x32_bf16 v[100:103], v[44:47], a[188:191], v[100:103]
    s_add_u32 m0, s62, 106944
    v_mfma_f32_16x16x32_bf16 v[104:107], v[44:47], a[220:223], v[104:107]
    buffer_load_dwordx4 v12, s[24:27], s60 offen offset:3072  lds
    v_mfma_f32_16x16x32_bf16 v[108:111], v[44:47], a[252:255], v[108:111]
    ds_read_b128 v[44:47], v8 offset:42432
    s_waitcnt lgkmcnt(3)
    v_mfma_f32_16x16x32_bf16 v[112:115], v[32:35], a[128:131], v[48:51]
    v_mfma_f32_16x16x32_bf16 v[116:119], v[32:35], a[160:163], v[52:55]
    v_mfma_f32_16x16x32_bf16 v[120:123], v[32:35], a[192:195], v[56:59]
    v_exp_f32 v24, v96
    v_mfma_f32_16x16x32_bf16 v[124:127], v[32:35], a[224:227], v[60:63]
    ds_read_b128 v[32:35], v8 offset:42496
    s_waitcnt lgkmcnt(3)
    v_mfma_f32_16x16x32_bf16 v[112:115], v[36:39], a[132:135], v[112:115]
    v_exp_f32 v25, v97
    v_mfma_f32_16x16x32_bf16 v[116:119], v[36:39], a[164:167], v[116:119]
    v_exp_f32 v26, v98
    v_mfma_f32_16x16x32_bf16 v[120:123], v[36:39], a[196:199], v[120:123]
    v_add_f32 v20, v24, v25
    v_cvt_pk_bf16_f32 v80, v24, v25
    v_mfma_f32_16x16x32_bf16 v[124:127], v[36:39], a[228:231], v[124:127]
    ds_read_b128 v[36:39], v8 offset:42560
    s_waitcnt lgkmcnt(3)
    v_mfma_f32_16x16x32_bf16 v[112:115], v[40:43], a[136:139], v[112:115]
    v_exp_f32 v27, v99
    v_mfma_f32_16x16x32_bf16 v[116:119], v[40:43], a[168:171], v[116:119]
    v_add_f32 v20, v20, v26
    v_mfma_f32_16x16x32_bf16 v[120:123], v[40:43], a[200:203], v[120:123]
    v_add_f32 v20, v20, v27
    v_cvt_pk_bf16_f32 v81, v26, v27
    v_mfma_f32_16x16x32_bf16 v[124:127], v[40:43], a[232:235], v[124:127]
    ds_read_b128 v[40:43], v8 offset:42624
    s_waitcnt lgkmcnt(3)
    v_mfma_f32_16x16x32_bf16 v[112:115], v[44:47], a[140:143], v[112:115]
    v_exp_f32 v28, v100
    v_mfma_f32_16x16x32_bf16 v[116:119], v[44:47], a[172:175], v[116:119]
    v_exp_f32 v29, v101
    v_mfma_f32_16x16x32_bf16 v[120:123], v[44:47], a[204:207], v[120:123]
    v_exp_f32 v30, v102
    v_mfma_f32_16x16x32_bf16 v[124:127], v[44:47], a[236:239], v[124:127]
    ds_read_b128 v[44:47], v8 offset:42688
    v_add_f32 v21, v28, v29
    s_waitcnt lgkmcnt(3)
    v_mfma_f32_16x16x32_bf16 v[112:115], v[32:35], a[144:147], v[112:115]
    v_cvt_pk_bf16_f32 v84, v28, v29
    v_mfma_f32_16x16x32_bf16 v[116:119], v[32:35], a[176:179], v[116:119]
    v_exp_f32 v31, v103
    v_mfma_f32_16x16x32_bf16 v[120:123], v[32:35], a[208:211], v[120:123]
    v_add_f32 v21, v21, v30
    v_mfma_f32_16x16x32_bf16 v[124:127], v[32:35], a[240:243], v[124:127]
    v_add_f32 v21, v21, v31
    v_cvt_pk_bf16_f32 v85, v30, v31
    s_waitcnt lgkmcnt(2)
    v_mfma_f32_16x16x32_bf16 v[112:115], v[36:39], a[148:151], v[112:115]
    v_exp_f32 v24, v104
    v_mfma_f32_16x16x32_bf16 v[116:119], v[36:39], a[180:183], v[116:119]
    s_add_u32 s59, s59, 32768
    s_add_u32 s60, s60, 32768
    v_mfma_f32_16x16x32_bf16 v[120:123], v[36:39], a[212:215], v[120:123]
    v_exp_f32 v25, v105
    v_mfma_f32_16x16x32_bf16 v[124:127], v[36:39], a[244:247], v[124:127]
    s_waitcnt lgkmcnt(0)
    s_waitcnt vmcnt(16)
    s_barrier
    ds_read_b64_tr_b16 v[32:33], v9 offset:0
    ds_read_b64_tr_b16 v[34:35], v9 offset:8704
    ds_read_b64_tr_b16 v[36:37], v10 offset:32
    ds_read_b64_tr_b16 v[38:39], v10 offset:8736
    v_mfma_f32_16x16x32_bf16 v[112:115], v[40:43], a[152:155], v[112:115]
    v_exp_f32 v26, v106
    v_mfma_f32_16x16x32_bf16 v[116:119], v[40:43], a[184:187], v[116:119]
    s_add_u32 m0, s61, 33792
    v_add_f32 v22, v24, v25
    v_mfma_f32_16x16x32_bf16 v[120:123], v[40:43], a[216:219], v[120:123]
    buffer_load_dwordx4 v11, s[20:23], s57 offen offset:0  lds
    v_mfma_f32_16x16x32_bf16 v[124:127], v[40:43], a[248:251], v[124:127]
    ds_read_b64_tr_b16 v[40:41], v9 offset:64
    ds_read_b64_tr_b16 v[42:43], v9 offset:8768
    v_mfma_f32_16x16x32_bf16 v[112:115], v[44:47], a[156:159], v[112:115]
    v_cvt_pk_bf16_f32 v88, v24, v25
    v_mfma_f32_16x16x32_bf16 v[116:119], v[44:47], a[188:191], v[116:119]
    v_exp_f32 v27, v107
    v_mfma_f32_16x16x32_bf16 v[120:123], v[44:47], a[220:223], v[120:123]
    v_add_f32 v22, v22, v26
    v_mfma_f32_16x16x32_bf16 v[124:127], v[44:47], a[252:255], v[124:127]
    ds_read_b64_tr_b16 v[44:45], v10 offset:96
    ds_read_b64_tr_b16 v[46:47], v10 offset:8800
    s_waitcnt lgkmcnt(6)
    v_mfma_f32_16x16x32_bf16 v[128:131], v[32:35], v[64:67], v[128:131]
    s_add_u32 m0, s61, 33824
    v_add_f32 v22, v22, v27
    v_mfma_f32_16x16x32_bf16 v[132:135], v[32:35], v[68:71], v[132:135]
    buffer_load_dwordx4 v11, s[20:23], s57 offen offset:1024  lds
    v_mfma_f32_16x16x32_bf16 a[0:3], v[32:35], v[72:75], a[0:3]
    v_cvt_pk_bf16_f32 v89, v26, v27
    v_mfma_f32_16x16x32_bf16 a[4:7], v[32:35], v[76:79], a[4:7]
    ds_read_b64_tr_b16 v[32:33], v9 offset:128
    ds_read_b64_tr_b16 v[34:35], v9 offset:8832
    s_waitcnt lgkmcnt(6)
    v_mfma_f32_16x16x32_bf16 v[136:139], v[36:39], v[64:67], v[136:139]
    v_exp_f32 v28, v108
    v_mfma_f32_16x16x32_bf16 v[140:143], v[36:39], v[68:71], v[140:143]
    v_exp_f32 v29, v109
    v_mfma_f32_16x16x32_bf16 a[8:11], v[36:39], v[72:75], a[8:11]
    v_exp_f32 v30, v110
    v_mfma_f32_16x16x32_bf16 a[12:15], v[36:39], v[76:79], a[12:15]
    ds_read_b64_tr_b16 v[36:37], v10 offset:160
    ds_read_b64_tr_b16 v[38:39], v10 offset:8864
    s_add_u32 m0, s61, 33856
    s_waitcnt lgkmcnt(6)
    v_mfma_f32_16x16x32_bf16 v[144:147], v[40:43], v[64:67], v[144:147]
    buffer_load_dwordx4 v11, s[20:23], s57 offen offset:2048  lds
    v_mfma_f32_16x16x32_bf16 v[148:151], v[40:43], v[68:71], v[148:151]
    v_add_f32 v23, v28, v29
    v_cvt_pk_bf16_f32 v92, v28, v29
    v_mfma_f32_16x16x32_bf16 a[16:19], v[40:43], v[72:75], a[16:19]
    v_exp_f32 v31, v111
    v_mfma_f32_16x16x32_bf16 a[20:23], v[40:43], v[76:79], a[20:23]
    ds_read_b64_tr_b16 v[40:41], v9 offset:192
    ds_read_b64_tr_b16 v[42:43], v9 offset:8896
    s_waitcnt lgkmcnt(6)
    v_mfma_f32_16x16x32_bf16 v[152:155], v[44:47], v[64:67], v[152:155]
    v_add_f32 v23, v23, v30
    v_mfma_f32_16x16x32_bf16 v[156:159], v[44:47], v[68:71], v[156:159]
    v_add_f32 v23, v23, v31
    v_cvt_pk_bf16_f32 v93, v30, v31
    v_mfma_f32_16x16x32_bf16 a[24:27], v[44:47], v[72:75], a[24:27]
    s_add_u32 m0, s61, 33888
    v_mfma_f32_16x16x32_bf16 a[28:31], v[44:47], v[76:79], a[28:31]
    ds_read_b64_tr_b16 v[44:45], v10 offset:224
    ds_read_b64_tr_b16 v[46:47], v10 offset:8928
    buffer_load_dwordx4 v11, s[20:23], s57 offen offset:3072  lds
    s_waitcnt lgkmcnt(6)
    v_mfma_f32_16x16x32_bf16 v[160:163], v[32:35], v[64:67], v[160:163]
    v_exp_f32 v24, v112
    v_mfma_f32_16x16x32_bf16 v[164:167], v[32:35], v[68:71], v[164:167]
    v_exp_f32 v25, v113
    v_mfma_f32_16x16x32_bf16 a[32:35], v[32:35], v[72:75], a[32:35]
    v_exp_f32 v26, v114
    v_mfma_f32_16x16x32_bf16 a[36:39], v[32:35], v[76:79], a[36:39]
    ds_read_b64_tr_b16 v[32:33], v9 offset:256
    ds_read_b64_tr_b16 v[34:35], v9 offset:8960
    s_waitcnt lgkmcnt(6)
    v_mfma_f32_16x16x32_bf16 v[168:171], v[36:39], v[64:67], v[168:171]
    v_add_f32 v20, v20, v24
    v_cvt_pk_bf16_f32 v82, v24, v25
    v_mfma_f32_16x16x32_bf16 v[172:175], v[36:39], v[68:71], v[172:175]
    s_add_u32 m0, s61, 38016
    v_mfma_f32_16x16x32_bf16 a[40:43], v[36:39], v[72:75], a[40:43]
    buffer_load_dwordx4 v11, s[20:23], s58 offen offset:0  lds
    v_mfma_f32_16x16x32_bf16 a[44:47], v[36:39], v[76:79], a[44:47]
    ds_read_b64_tr_b16 v[36:37], v10 offset:288
    ds_read_b64_tr_b16 v[38:39], v10 offset:8992
    s_waitcnt lgkmcnt(6)
    v_mfma_f32_16x16x32_bf16 v[176:179], v[40:43], v[64:67], v[176:179]
    v_exp_f32 v27, v115
    v_mfma_f32_16x16x32_bf16 v[180:183], v[40:43], v[68:71], v[180:183]
    v_add_f32 v20, v20, v25
    v_add_f32 v20, v20, v26
    v_mfma_f32_16x16x32_bf16 a[48:51], v[40:43], v[72:75], a[48:51]
    v_add_f32 v20, v20, v27
    v_cvt_pk_bf16_f32 v83, v26, v27
    v_mfma_f32_16x16x32_bf16 a[52:55], v[40:43], v[76:79], a[52:55]
    ds_read_b64_tr_b16 v[40:41], v9 offset:320
    ds_read_b64_tr_b16 v[42:43], v9 offset:9024
    s_waitcnt lgkmcnt(6)
    v_mfma_f32_16x16x32_bf16 v[184:187], v[44:47], v[64:67], v[184:187]
    s_add_u32 m0, s61, 38048
    v_mfma_f32_16x16x32_bf16 v[188:191], v[44:47], v[68:71], v[188:191]
    buffer_load_dwordx4 v11, s[20:23], s58 offen offset:1024  lds
    v_mfma_f32_16x16x32_bf16 a[56:59], v[44:47], v[72:75], a[56:59]
    v_exp_f32 v28, v116
    v_mfma_f32_16x16x32_bf16 a[60:63], v[44:47], v[76:79], a[60:63]
    ds_read_b64_tr_b16 v[44:45], v10 offset:352
    ds_read_b64_tr_b16 v[46:47], v10 offset:9056
    s_waitcnt lgkmcnt(6)
    v_mfma_f32_16x16x32_bf16 v[192:195], v[32:35], v[64:67], v[192:195]
    v_exp_f32 v29, v117
    v_mfma_f32_16x16x32_bf16 v[196:199], v[32:35], v[68:71], v[196:199]
    v_exp_f32 v30, v118
    v_mfma_f32_16x16x32_bf16 a[64:67], v[32:35], v[72:75], a[64:67]
    v_add_f32 v21, v21, v28
    v_cvt_pk_bf16_f32 v86, v28, v29
    v_mfma_f32_16x16x32_bf16 a[68:71], v[32:35], v[76:79], a[68:71]
    ds_read_b64_tr_b16 v[32:33], v9 offset:384
    ds_read_b64_tr_b16 v[34:35], v9 offset:9088
    s_add_u32 m0, s61, 38080
    s_waitcnt lgkmcnt(6)
    v_mfma_f32_16x16x32_bf16 v[200:203], v[36:39], v[64:67], v[200:203]
    buffer_load_dwordx4 v11, s[20:23], s58 offen offset:2048  lds
    v_mfma_f32_16x16x32_bf16 v[204:207], v[36:39], v[68:71], v[204:207]
    v_exp_f32 v31, v119
    v_mfma_f32_16x16x32_bf16 a[72:75], v[36:39], v[72:75], a[72:75]
    v_add_f32 v21, v21, v29
    v_add_f32 v21, v21, v30
    v_mfma_f32_16x16x32_bf16 a[76:79], v[36:39], v[76:79], a[76:79]
    ds_read_b64_tr_b16 v[36:37], v10 offset:416
    ds_read_b64_tr_b16 v[38:39], v10 offset:9120
    s_waitcnt lgkmcnt(6)
    v_mfma_f32_16x16x32_bf16 v[208:211], v[40:43], v[64:67], v[208:211]
    v_add_f32 v21, v21, v31
    v_cvt_pk_bf16_f32 v87, v30, v31
    v_mfma_f32_16x16x32_bf16 v[212:215], v[40:43], v[68:71], v[212:215]
    v_exp_f32 v24, v120
    v_mfma_f32_16x16x32_bf16 a[80:83], v[40:43], v[72:75], a[80:83]
    s_add_u32 m0, s61, 38112
    v_mfma_f32_16x16x32_bf16 a[84:87], v[40:43], v[76:79], a[84:87]
    ds_read_b64_tr_b16 v[40:41], v9 offset:448
    ds_read_b64_tr_b16 v[42:43], v9 offset:9152
    buffer_load_dwordx4 v11, s[20:23], s58 offen offset:3072  lds
    s_waitcnt lgkmcnt(6)
    v_mfma_f32_16x16x32_bf16 v[216:219], v[44:47], v[64:67], v[216:219]
    v_exp_f32 v25, v121
    v_mfma_f32_16x16x32_bf16 v[220:223], v[44:47], v[68:71], v[220:223]
    v_exp_f32 v26, v122
    v_mfma_f32_16x16x32_bf16 a[88:91], v[44:47], v[72:75], a[88:91]
    v_add_f32 v22, v22, v24
    v_cvt_pk_bf16_f32 v90, v24, v25
    v_mfma_f32_16x16x32_bf16 a[92:95], v[44:47], v[76:79], a[92:95]
    ds_read_b64_tr_b16 v[44:45], v10 offset:480
    ds_read_b64_tr_b16 v[46:47], v10 offset:9184
    s_waitcnt lgkmcnt(6)
    v_mfma_f32_16x16x32_bf16 v[224:227], v[32:35], v[64:67], v[224:227]
    v_exp_f32 v27, v123
    v_mfma_f32_16x16x32_bf16 v[228:231], v[32:35], v[68:71], v[228:231]
    v_add_f32 v22, v22, v25
    v_add_f32 v22, v22, v26
    v_mfma_f32_16x16x32_bf16 a[96:99], v[32:35], v[72:75], a[96:99]
    v_add_f32 v22, v22, v27
    v_cvt_pk_bf16_f32 v91, v26, v27
    v_mfma_f32_16x16x32_bf16 a[100:103], v[32:35], v[76:79], a[100:103]
    v_exp_f32 v28, v124
    s_waitcnt lgkmcnt(4)
    v_mfma_f32_16x16x32_bf16 v[232:235], v[36:39], v[64:67], v[232:235]
    v_exp_f32 v29, v125
    v_mfma_f32_16x16x32_bf16 v[236:239], v[36:39], v[68:71], v[236:239]
    s_add_u32 s57, s57, 32768
    s_add_u32 s58, s58, 32768
    v_mfma_f32_16x16x32_bf16 a[104:107], v[36:39], v[72:75], a[104:107]
    v_exp_f32 v30, v126
    v_mfma_f32_16x16x32_bf16 a[108:111], v[36:39], v[76:79], a[108:111]
    s_waitcnt lgkmcnt(0)
    s_waitcnt vmcnt(16)
    s_barrier
    ds_read_b128 v[32:35], v8 offset:0
    ds_read_b128 v[36:39], v8 offset:64
    v_mfma_f32_16x16x32_bf16 v[240:243], v[40:43], v[64:67], v[240:243]
    v_add_f32 v23, v23, v28
    v_cvt_pk_bf16_f32 v94, v28, v29
    v_mfma_f32_16x16x32_bf16 v[244:247], v[40:43], v[68:71], v[244:247]
    v_exp_f32 v31, v127
    v_mfma_f32_16x16x32_bf16 a[112:115], v[40:43], v[72:75], a[112:115]
    v_add_f32 v23, v23, v29
    v_add_f32 v23, v23, v30
    v_mfma_f32_16x16x32_bf16 a[116:119], v[40:43], v[76:79], a[116:119]
    ds_read_b128 v[40:43], v8 offset:128
    v_add_f32 v23, v23, v31
    v_mfma_f32_16x16x32_bf16 v[248:251], v[44:47], v[64:67], v[248:251]
    v_cvt_pk_bf16_f32 v95, v30, v31
    v_mfma_f32_16x16x32_bf16 v[252:255], v[44:47], v[68:71], v[252:255]
    v_mfma_f32_16x16x32_bf16 a[120:123], v[44:47], v[72:75], a[120:123]
    v_mfma_f32_16x16x32_bf16 a[124:127], v[44:47], v[76:79], a[124:127]
    ds_read_b128 v[44:47], v8 offset:192
    v_max3_f32 v13, v20, v21, v22
    v_max_f32 v13, v13, v23
    v_cmp_lt_f32 vcc, s64, v13
    s_mov_b32 s66, 0
    s_nop 0
    s_cbranch_vccnz K2_rare1
K2_ret0:
    s_waitcnt lgkmcnt(3)
    v_mfma_f32_16x16x32_bf16 v[96:99], v[32:35], a[128:131], v[48:51]
    v_add_f32 v16, v16, v20
    v_mfma_f32_16x16x32_bf16 v[100:103], v[32:35], a[160:163], v[52:55]
    v_add_f32 v17, v17, v21
    s_add_u32 m0, s62, 67584
    v_mfma_f32_16x16x32_bf16 v[104:107], v[32:35], a[192:195], v[56:59]
    v_add_f32 v18, v18, v22
    buffer_load_dwordx4 v12, s[24:27], s59 offen offset:0  lds
    v_mfma_f32_16x16x32_bf16 v[108:111], v[32:35], a[224:227], v[60:63]
    v_add_f32 v19, v19, v23
    ds_read_b128 v[32:35], v8 offset:256
    s_waitcnt lgkmcnt(3)
    v_mfma_f32_16x16x32_bf16 v[96:99], v[36:39], a[132:135], v[96:99]
    v_mfma_f32_16x16x32_bf16 v[100:103], v[36:39], a[164:167], v[100:103]
    s_add_u32 m0, s62, 67648
    v_mfma_f32_16x16x32_bf16 v[104:107], v[36:39], a[196:199], v[104:107]
    buffer_load_dwordx4 v12, s[24:27], s59 offen offset:1024  lds
    v_mfma_f32_16x16x32_bf16 v[108:111], v[36:39], a[228:231], v[108:111]
    ds_read_b128 v[36:39], v8 offset:320
    s_waitcnt lgkmcnt(3)
    v_mfma_f32_16x16x32_bf16 v[96:99], v[40:43], a[136:139], v[96:99]
    v_mfma_f32_16x16x32_bf16 v[100:103], v[40:43], a[168:171], v[100:103]
    s_add_u32 m0, s62, 67712
    v_mfma_f32_16x16x32_bf16 v[104:107], v[40:43], a[200:203], v[104:107]
    buffer_load_dwordx4 v12, s[24:27], s59 offen offset:2048  lds
    v_mfma_f32_16x16x32_bf16 v[108:111], v[40:43], a[232:235], v[108:111]
    ds_read_b128 v[40:43], v8 offset:384
    s_waitcnt lgkmcnt(3)
    v_mfma_f32_16x16x32_bf16 v[96:99], v[44:47], a[140:143], v[96:99]
    v_mfma_f32_16x16x32_bf16 v[100:103], v[44:47], a[172:175], v[100:103]
    s_add_u32 m0, s62, 67776
    v_mfma_f32_16x16x32_bf16 v[104:107], v[44:47], a[204:207], v[104:107]
    buffer_load_dwordx4 v12, s[24:27], s59 offen offset:3072  lds
    v_mfma_f32_16x16x32_bf16 v[108:111], v[44:47], a[236:239], v[108:111]
    ds_read_b128 v[44:47], v8 offset:448
    s_waitcnt lgkmcnt(3)
    v_mfma_f32_16x16x32_bf16 v[96:99], v[32:35], a[144:147], v[96:99]
    v_mfma_f32_16x16x32_bf16 v[100:103], v[32:35], a[176:179], v[100:103]
    s_add_u32 m0, s62, 71936
    v_mfma_f32_16x16x32_bf16 v[104:107], v[32:35], a[208:211], v[104:107]
    buffer_load_dwordx4 v12, s[24:27], s60 offen offset:0  lds
    v_mfma_f32_16x16x32_bf16 v[108:111], v[32:35], a[240:243], v[108:111]
    ds_read_b128 v[32:35], v8 offset:8448
    s_waitcnt lgkmcnt(3)
    v_mfma_f32_16x16x32_bf16 v[96:99], v[36:39], a[148:151], v[96:99]
    v_mfma_f32_16x16x32_bf16 v[100:103], v[36:39], a[180:183], v[100:103]
    s_add_u32 m0, s62, 72000
    v_mfma_f32_16x16x32_bf16 v[104:107], v[36:39], a[212:215], v[104:107]
    buffer_load_dwordx4 v12, s[24:27], s60 offen offset:1024  lds
    v_mfma_f32_16x16x32_bf16 v[108:111], v[36:39], a[244:247], v[108:111]
    ds_read_b128 v[36:39], v8 offset:8512
    s_waitcnt lgkmcnt(3)
    v_mfma_f32_16x16x32_bf16 v[96:99], v[40:43], a[152:155], v[96:99]
    v_mfma_f32_16x16x32_bf16 v[100:103], v[40:43], a[184:187], v[100:103]
    s_add_u32 m0, s62, 72064
    v_mfma_f32_16x16x32_bf16 v[104:107], v[40:43], a[216:219], v[104:107]
    buffer_load_dwordx4 v12, s[24:27], s60 offen offset:2048  lds
    v_mfma_f32_16x16x32_bf16 v[108:111], v[40:43], a[248:251], v[108:111]
    ds_read_b128 v[40:43], v8 offset:8576
    s_waitcnt lgkmcnt(3)
    v_mfma_f32_16x16x32_bf16 v[96:99], v[44:47], a[156:159], v[96:99]
    v_mfma_f32_16x16x32_bf16 v[100:103], v[44:47], a[188:191], v[100:103]
    s_add_u32 m0, s62, 72128
    v_mfma_f32_16x16x32_bf16 v[104:107], v[44:47], a[220:223], v[104:107]
    buffer_load_dwordx4 v12, s[24:27], s60 offen offset:3072  lds
    v_mfma_f32_16x16x32_bf16 v[108:111], v[44:47], a[252:255], v[108:111]
    ds_read_b128 v[44:47], v8 offset:8640
    s_waitcnt lgkmcnt(3)
    v_mfma_f32_16x16x32_bf16 v[112:115], v[32:35], a[128:131], v[48:51]
    v_mfma_f32_16x16x32_bf16 v[116:119], v[32:35], a[160:163], v[52:55]
    v_mfma_f32_16x16x32_bf16 v[120:123], v[32:35], a[192:195], v[56:59]
    v_exp_f32 v24, v96
    v_mfma_f32_16x16x32_bf16 v[124:127], v[32:35], a[224:227], v[60:63]
    ds_read_b128 v[32:35], v8 offset:8704
    s_waitcnt lgkmcnt(3)
    v_mfma_f32_16x16x32_bf16 v[112:115], v[36:39], a[132:135], v[112:115]
    v_exp_f32 v25, v97
    v_mfma_f32_16x16x32_bf16 v[116:119], v[36:39], a[164:167], v[116:119]
    v_exp_f32 v26, v98
    v_mfma_f32_16x16x32_bf16 v[120:123], v[36:39], a[196:199], v[120:123]
    v_add_f32 v20, v24, v25
    v_cvt_pk_bf16_f32 v64, v24, v25
    v_mfma_f32_16x16x32_bf16 v[124:127], v[36:39], a[228:231], v[124:127]
    ds_read_b128 v[36:39], v8 offset:8768
    s_waitcnt lgkmcnt(3)
    v_mfma_f32_16x16x32_bf16 v[112:115], v[40:43], a[136:139], v[112:115]
    v_exp_f32 v27, v99
    v_mfma_f32_16x16x32_bf16 v[116:119], v[40:43], a[168:171], v[116:119]
    v_add_f32 v20, v20, v26
    v_mfma_f32_16x16x32_bf16 v[120:123], v[40:43], a[200:203], v[120:123]
    v_add_f32 v20, v20, v27
    v_cvt_pk_bf16_f32 v65, v26, v27
    v_mfma_f32_16x16x32_bf16 v[124:127], v[40:43], a[232:235], v[124:127]
    ds_read_b128 v[40:43], v8 offset:8832
    s_waitcnt lgkmcnt(3)
    v_mfma_f32_16x16x32_bf16 v[112:115], v[44:47], a[140:143], v[112:115]
    v_exp_f32 v28, v100
    v_mfma_f32_16x16x32_bf16 v[116:119], v[44:47], a[172:175], v[116:119]
    v_exp_f32 v29, v101
    v_mfma_f32_16x16x32_bf16 v[120:123], v[44:47], a[204:207], v[120:123]
    v_exp_f32 v30, v102
    v_mfma_f32_16x16x32_bf16 v[124:127], v[44:47], a[236:239], v[124:127]
    ds_read_b128 v[44:47], v8 offset:8896
    v_add_f32 v21, v28, v29
    s_waitcnt lgkmcnt(3)
    v_mfma_f32_16x16x32_bf16 v[112:115], v[32:35], a[144:147], v[112:115]
    v_cvt_pk_bf16_f32 v68, v28, v29
    v_mfma_f32_16x16x32_bf16 v[116:119], v[32:35], a[176:179], v[116:119]
    v_exp_f32 v31, v103
    v_mfma_f32_16x16x32_bf16 v[120:123], v[32:35], a[208:211], v[120:123]
    v_add_f32 v21, v21, v30
    v_mfma_f32_16x16x32_bf16 v[124:127], v[32:35], a[240:243], v[124:127]
    v_add_f32 v21, v21, v31
    v_cvt_pk_bf16_f32 v69, v30, v31
    s_waitcnt lgkmcnt(2)
    v_mfma_f32_16x16x32_bf16 v[112:115], v[36:39], a[148:151], v[112:115]
    v_exp_f32 v24, v104
    v_mfma_f32_16x16x32_bf16 v[116:119], v[36:39], a[180:183], v[116:119]
    s_add_u32 s59, s59, 32768
    s_add_u32 s60, s60, 32768
    v_mfma_f32_16x16x32_bf16 v[120:123], v[36:39], a[212:215], v[120:123]
    v_exp_f32 v25, v105
    v_mfma_f32_16x16x32_bf16 v[124:127], v[36:39], a[244:247], v[124:127]
    s_waitcnt lgkmcnt(0)
    s_waitcnt vmcnt(16)
    s_barrier
    ds_read_b64_tr_b16 v[32:33], v9 offset:34816
    ds_read_b64_tr_b16 v[34:35], v9 offset:43520
    ds_read_b64_tr_b16 v[36:37], v10 offset:34848
    ds_read_b64_tr_b16 v[38:39], v10 offset:43552
    v_mfma_f32_16x16x32_bf16 v[112:115], v[40:43], a[152:155], v[112:115]
    v_exp_f32 v26, v106
    v_mfma_f32_16x16x32_bf16 v[116:119], v[40:43], a[184:187], v[116:119]
    s_add_u32 m0, s61, 0
    v_add_f32 v22, v24, v25
    v_mfma_f32_16x16x32_bf16 v[120:123], v[40:43], a[216:219], v[120:123]
    buffer_load_dwordx4 v11, s[20:23], s57 offen offset:0  lds
    v_mfma_f32_16x16x32_bf16 v[124:127], v[40:43], a[248:251], v[124:127]
    ds_read_b64_tr_b16 v[40:41], v9 offset:34880
    ds_read_b64_tr_b16 v[42:43], v9 offset:43584
    v_mfma_f32_16x16x32_bf16 v[112:115], v[44:47], a[156:159], v[112:115]
    v_cvt_pk_bf16_f32 v72, v24, v25
    v_mfma_f32_16x16x32_bf16 v[116:119], v[44:47], a[188:191], v[116:119]
    v_exp_f32 v27, v107
    v_mfma_f32_16x16x32_bf16 v[120:123], v[44:47], a[220:223], v[120:123]
    v_add_f32 v22, v22, v26
    v_mfma_f32_16x16x32_bf16 v[124:127], v[44:47], a[252:255], v[124:127]
    ds_read_b64_tr_b16 v[44:45], v10 offset:34912
    ds_read_b64_tr_b16 v[46:47], v10 offset:43616
    s_waitcnt lgkmcnt(6)
    v_mfma_f32_16x16x32_bf16 v[128:131], v[32:35], v[80:83], v[128:131]
    s_add_u32 m0, s61, 32
    v_add_f32 v22, v22, v27
    v_mfma_f32_16x16x32_bf16 v[132:135], v[32:35], v[84:87], v[132:135]
    buffer_load_dwordx4 v11, s[20:23], s57 offen offset:1024  lds
    v_mfma_f32_16x16x32_bf16 a[0:3], v[32:35], v[88:91], a[0:3]
    v_cvt_pk_bf16_f32 v73, v26, v27
    v_mfma_f32_16x16x32_bf16 a[4:7], v[32:35], v[92:95], a[4:7]
    ds_read_b64_tr_b16 v[32:33], v9 offset:34944
    ds_read_b64_tr_b16 v[34:35], v9 offset:43648
    s_waitcnt lgkmcnt(6)
    v_mfma_f32_16x16x32_bf16 v[136:139], v[36:39], v[80:83], v[136:139]
    v_exp_f32 v28, v108
    v_mfma_f32_16x16x32_bf16 v[140:143], v[36:39], v[84:87], v[140:143]
    v_exp_f32 v29, v109
    v_mfma_f32_16x16x32_bf16 a[8:11], v[36:39], v[88:91], a[8:11]
    v_exp_f32 v30, v110
    v_mfma_f32_16x16x32_bf16 a[12:15], v[36:39], v[92:95], a[12:15]
    ds_read_b64_tr_b16 v[36:37], v10 offset:34976
    ds_read_b64_tr_b16 v[38:39], v10 offset:43680
    s_add_u32 m0, s61, 64
    s_waitcnt lgkmcnt(6)
    v_mfma_f32_16x16x32_bf16 v[144:147], v[40:43], v[80:83], v[144:147]
    buffer_load_dwordx4 v11, s[20:23], s57 offen offset:2048  lds
    v_mfma_f32_16x16x32_bf16 v[148:151], v[40:43], v[84:87], v[148:151]
    v_add_f32 v23, v28, v29
    v_cvt_pk_bf16_f32 v76, v28, v29
    v_mfma_f32_16x16x32_bf16 a[16:19], v[40:43], v[88:91], a[16:19]
    v_exp_f32 v31, v111
    v_mfma_f32_16x16x32_bf16 a[20:23], v[40:43], v[92:95], a[20:23]
    ds_read_b64_tr_b16 v[40:41], v9 offset:35008
    ds_read_b64_tr_b16 v[42:43], v9 offset:43712
    s_waitcnt lgkmcnt(6)
    v_mfma_f32_16x16x32_bf16 v[152:155], v[44:47], v[80:83], v[152:155]
    v_add_f32 v23, v23, v30
    v_mfma_f32_16x16x32_bf16 v[156:159], v[44:47], v[84:87], v[156:159]
    v_add_f32 v23, v23, v31
    v_cvt_pk_bf16_f32 v77, v30, v31
    v_mfma_f32_16x16x32_bf16 a[24:27], v[44:47], v[88:91], a[24:27]
    s_add_u32 m0, s61, 96
    v_mfma_f32_16x16x32_bf16 a[28:31], v[44:47], v[92:95], a[28:31]
    ds_read_b64_tr_b16 v[44:45], v10 offset:35040
    ds_read_b64_tr_b16 v[46:47], v10 offset:43744
    buffer_load_dwordx4 v11, s[20:23], s57 offen offset:3072  lds
    s_waitcnt lgkmcnt(6)
    v_mfma_f32_16x16x32_bf16 v[160:163], v[32:35], v[80:83], v[160:163]
    v_exp_f32 v24, v112
    v_mfma_f32_16x16x32_bf16 v[164:167], v[32:35], v[84:87], v[164:167]
    v_exp_f32 v25, v113
    v_mfma_f32_16x16x32_bf16 a[32:35], v[32:35], v[88:91], a[32:35]
    v_exp_f32 v26, v114
    v_mfma_f32_16x16x32_bf16 a[36:39], v[32:35], v[92:95], a[36:39]
    ds_read_b64_tr_b16 v[32:33], v9 offset:35072
    ds_read_b64_tr_b16 v[34:35], v9 offset:43776
    s_waitcnt lgkmcnt(6)
    v_mfma_f32_16x16x32_bf16 v[168:171], v[36:39], v[80:83], v[168:171]
    v_add_f32 v20, v20, v24
    v_cvt_pk_bf16_f32 v66, v24, v25
    v_mfma_f32_16x16x32_bf16 v[172:175], v[36:39], v[84:87], v[172:175]
    s_add_u32 m0, s61, 4224
    v_mfma_f32_16x16x32_bf16 a[40:43], v[36:39], v[88:91], a[40:43]
    buffer_load_dwordx4 v11, s[20:23], s58 offen offset:0  lds
    v_mfma_f32_16x16x32_bf16 a[44:47], v[36:39], v[92:95], a[44:47]
    ds_read_b64_tr_b16 v[36:37], v10 offset:35104
    ds_read_b64_tr_b16 v[38:39], v10 offset:43808
    s_waitcnt lgkmcnt(6)
    v_mfma_f32_16x16x32_bf16 v[176:179], v[40:43], v[80:83], v[176:179]
    v_exp_f32 v27, v115
    v_mfma_f32_16x16x32_bf16 v[180:183], v[40:43], v[84:87], v[180:183]
    v_add_f32 v20, v20, v25
    v_add_f32 v20, v20, v26
    v_mfma_f32_16x16x32_bf16 a[48:51], v[40:43], v[88:91], a[48:51]
    v_add_f32 v20, v20, v27
    v_cvt_pk_bf16_f32 v67, v26, v27
    v_mfma_f32_16x16x32_bf16 a[52:55], v[40:43], v[92:95], a[52:55]
    ds_read_b64_tr_b16 v[40:41], v9 offset:35136
    ds_read_b64_tr_b16 v[42:43], v9 offset:43840
    s_waitcnt lgkmcnt(6)
    v_mfma_f32_16x16x32_bf16 v[184:187], v[44:47], v[80:83], v[184:187]
    s_add_u32 m0, s61, 4256
    v_mfma_f32_16x16x32_bf16 v[188:191], v[44:47], v[84:87], v[188:191]
    buffer_load_dwordx4 v11, s[20:23], s58 offen offset:1024  lds
    v_mfma_f32_16x16x32_bf16 a[56:59], v[44:47], v[88:91], a[56:59]
    v_exp_f32 v28, v116
    v_mfma_f32_16x16x32_bf16 a[60:63], v[44:47], v[92:95], a[60:63]
    ds_read_b64_tr_b16 v[44:45], v10 offset:35168
    ds_read_b64_tr_b16 v[46:47], v10 offset:43872
    s_waitcnt lgkmcnt(6)
    v_mfma_f32_16x16x32_bf16 v[192:195], v[32:35], v[80:83], v[192:195]
    v_exp_f32 v29, v117
    v_mfma_f32_16x16x32_bf16 v[196:199], v[32:35], v[84:87], v[196:199]
    v_exp_f32 v30, v118
    v_mfma_f32_16x16x32_bf16 a[64:67], v[32:35], v[88:91], a[64:67]
    v_add_f32 v21, v21, v28
    v_cvt_pk_bf16_f32 v70, v28, v29
    v_mfma_f32_16x16x32_bf16 a[68:71], v[32:35], v[92:95], a[68:71]
    ds_read_b64_tr_b16 v[32:33], v9 offset:35200
    ds_read_b64_tr_b16 v[34:35], v9 offset:43904
    s_add_u32 m0, s61, 4288
    s_waitcnt lgkmcnt(6)
    v_mfma_f32_16x16x32_bf16 v[200:203], v[36:39], v[80:83], v[200:203]
    buffer_load_dwordx4 v11, s[20:23], s58 offen offset:2048  lds
    v_mfma_f32_16x16x32_bf16 v[204:207], v[36:39], v[84:87], v[204:207]
    v_exp_f32 v31, v119
    v_mfma_f32_16x16x32_bf16 a[72:75], v[36:39], v[88:91], a[72:75]
    v_add_f32 v21, v21, v29
    v_add_f32 v21, v21, v30
    v_mfma_f32_16x16x32_bf16 a[76:79], v[36:39], v[92:95], a[76:79]
    ds_read_b64_tr_b16 v[36:37], v10 offset:35232
    ds_read_b64_tr_b16 v[38:39], v10 offset:43936
    s_waitcnt lgkmcnt(6)
    v_mfma_f32_16x16x32_bf16 v[208:211], v[40:43], v[80:83], v[208:211]
    v_add_f32 v21, v21, v31
    v_cvt_pk_bf16_f32 v71, v30, v31
    v_mfma_f32_16x16x32_bf16 v[212:215], v[40:43], v[84:87], v[212:215]
    v_exp_f32 v24, v120
    v_mfma_f32_16x16x32_bf16 a[80:83], v[40:43], v[88:91], a[80:83]
    s_add_u32 m0, s61, 4320
    v_mfma_f32_16x16x32_bf16 a[84:87], v[40:43], v[92:95], a[84:87]
    ds_read_b64_tr_b16 v[40:41], v9 offset:35264
    ds_read_b64_tr_b16 v[42:43], v9 offset:43968
    buffer_load_dwordx4 v11, s[20:23], s58 offen offset:3072  lds
    s_waitcnt lgkmcnt(6)
    v_mfma_f32_16x16x32_bf16 v[216:219], v[44:47], v[80:83], v[216:219]
    v_exp_f32 v25, v121
    v_mfma_f32_16x16x32_bf16 v[220:223], v[44:47], v[84:87], v[220:223]
    v_exp_f32 v26, v122
    v_mfma_f32_16x16x32_bf16 a[88:91], v[44:47], v[88:91], a[88:91]
    v_add_f32 v22, v22, v24
    v_cvt_pk_bf16_f32 v74, v24, v25
    v_mfma_f32_16x16x32_bf16 a[92:95], v[44:47], v[92:95], a[92:95]
    ds_read_b64_tr_b16 v[44:45], v10 offset:35296
    ds_read_b64_tr_b16 v[46:47], v10 offset:44000
    s_waitcnt lgkmcnt(6)
    v_mfma_f32_16x16x32_bf16 v[224:227], v[32:35], v[80:83], v[224:227]
    v_exp_f32 v27, v123
    v_mfma_f32_16x16x32_bf16 v[228:231], v[32:35], v[84:87], v[228:231]
    v_add_f32 v22, v22, v25
    v_add_f32 v22, v22, v26
    v_mfma_f32_16x16x32_bf16 a[96:99], v[32:35], v[88:91], a[96:99]
    v_add_f32 v22, v22, v27
    v_cvt_pk_bf16_f32 v75, v26, v27
    v_mfma_f32_16x16x32_bf16 a[100:103], v[32:35], v[92:95], a[100:103]
    v_exp_f32 v28, v124
    s_waitcnt lgkmcnt(4)
    v_mfma_f32_16x16x32_bf16 v[232:235], v[36:39], v[80:83], v[232:235]
    v_exp_f32 v29, v125
    v_mfma_f32_16x16x32_bf16 v[236:239], v[36:39], v[84:87], v[236:239]
    s_add_u32 s57, s57, 32768
    s_add_u32 s58, s58, 32768
    v_mfma_f32_16x16x32_bf16 a[104:107], v[36:39], v[88:91], a[104:107]
    v_exp_f32 v30, v126
    v_mfma_f32_16x16x32_bf16 a[108:111], v[36:39], v[92:95], a[108:111]
    s_waitcnt lgkmcnt(0)
    s_waitcnt vmcnt(16)
    s_barrier
    ds_read_b128 v[32:35], v8 offset:33792
    ds_read_b128 v[36:39], v8 offset:33856
    v_mfma_f32_16x16x32_bf16 v[240:243], v[40:43], v[80:83], v[240:243]
    v_add_f32 v23, v23, v28
    v_cvt_pk_bf16_f32 v78, v28, v29
    v_mfma_f32_16x16x32_bf16 v[244:247], v[40:43], v[84:87], v[244:247]
    v_exp_f32 v31, v127
    v_mfma_f32_16x16x32_bf16 a[112:115], v[40:43], v[88:91], a[112:115]
    v_add_f32 v23, v23, v29
    v_add_f32 v23, v23, v30
    v_mfma_f32_16x16x32_bf16 a[116:119], v[40:43], v[92:95], a[116:119]
    ds_read_b128 v[40:43], v8 offset:33920
    v_add_f32 v23, v23, v31
    v_mfma_f32_16x16x32_bf16 v[248:251], v[44:47], v[80:83], v[248:251]
    v_cvt_pk_bf16_f32 v79, v30, v31
    v_mfma_f32_16x16x32_bf16 v[252:255], v[44:47], v[84:87], v[252:255]
    v_mfma_f32_16x16x32_bf16 a[120:123], v[44:47], v[88:91], a[120:123]
    v_mfma_f32_16x16x32_bf16 a[124:127], v[44:47], v[92:95], a[124:127]
    ds_read_b128 v[44:47], v8 offset:33984
    v_max3_f32 v13, v20, v21, v22
    v_max_f32 v13, v13, v23
    v_cmp_lt_f32 vcc, s64, v13
    s_mov_b32 s66, 1
    s_nop 0
    s_cbranch_vccnz K2_rare0
K2_ret1:
    s_sub_u32 s63, s63, 1
    s_cmp_lg_u32 s63, 0
    s_cbranch_scc1 K2_loop
    s_waitcnt lgkmcnt(3)
    v_mfma_f32_16x16x32_bf16 v[96:99], v[32:35], a[128:131], v[48:51]
    v_add_f32 v16, v16, v20
    v_mfma_f32_16x16x32_bf16 v[100:103], v[32:35], a[160:163], v[52:55]
    v_add_f32 v17, v17, v21
    s_add_u32 m0, s62, 102400
    v_mfma_f32_16x16x32_bf16 v[104:107], v[32:35], a[192:195], v[56:59]
    v_add_f32 v18, v18, v22
    buffer_load_dwordx4 v12, s[24:27], s59 offen offset:0  lds
    v_mfma_f32_16x16x32_bf16 v[108:111], v[32:35], a[224:227], v[60:63]
    v_add_f32 v19, v19, v23
    ds_read_b128 v[32:35], v8 offset:34048
    s_waitcnt lgkmcnt(3)
    v_mfma_f32_16x16x32_bf16 v[96:99], v[36:39], a[132:135], v[96:99]
    v_mfma_f32_16x16x32_bf16 v[100:103], v[36:39], a[164:167], v[100:103]
    s_add_u32 m0, s62, 102464
    v_mfma_f32_16x16x32_bf16 v[104:107], v[36:39], a[196:199], v[104:107]
    buffer_load_dwordx4 v12, s[24:27], s59 offen offset:1024  lds
    v_mfma_f32_16x16x32_bf16 v[108:111], v[36:39], a[228:231], v[108:111]
    ds_read_b128 v[36:39], v8 offset:34112
    s_waitcnt lgkmcnt(3)
    v_mfma_f32_16x16x32_bf16 v[96:99], v[40:43], a[136:139], v[96:99]
    v_mfma_f32_16x16x32_bf16 v[100:103], v[40:43], a[168:171], v[100:103]
    s_add_u32 m0, s62, 102528
    v_mfma_f32_16x16x32_bf16 v[104:107], v[40:43], a[200:203], v[104:107]
    buffer_load_dwordx4 v12, s[24:27], s59 offen offset:2048  lds
    v_mfma_f32_16x16x32_bf16 v[108:111], v[40:43], a[232:235], v[108:111]
    ds_read_b128 v[40:43], v8 offset:34176
    s_waitcnt lgkmcnt(3)
    v_mfma_f32_16x16x32_bf16 v[96:99], v[44:47], a[140:143], v[96:99]
    v_mfma_f32_16x16x32_bf16 v[100:103], v[44:47], a[172:175], v[100:103]
    s_add_u32 m0, s62, 102592
    v_mfma_f32_16x16x32_bf16 v[104:107], v[44:47], a[204:207], v[104:107]
    buffer_load_dwordx4 v12, s[24:27], s59 offen offset:3072  lds
    v_mfma_f32_16x16x32_bf16 v[108:111], v[44:47], a[236:239], v[108:111]
    ds_read_b128 v[44:47], v8 offset:34240
    s_waitcnt lgkmcnt(3)
    v_mfma_f32_16x16x32_bf16 v[96:99], v[32:35], a[144:147], v[96:99]
    v_mfma_f32_16x16x32_bf16 v[100:103], v[32:35], a[176:179], v[100:103]
    s_add_u32 m0, s62, 106752
    v_mfma_f32_16x16x32_bf16 v[104:107], v[32:35], a[208:211], v[104:107]
    buffer_load_dwordx4 v12, s[24:27], s60 offen offset:0  lds
    v_mfma_f32_16x16x32_bf16 v[108:111], v[32:35], a[240:243], v[108:111]
    ds_read_b128 v[32:35], v8 offset:42240
    s_waitcnt lgkmcnt(3)
    v_mfma_f32_16x16x32_bf16 v[96:99], v[36:39], a[148:151], v[96:99]
    v_mfma_f32_16x16x32_bf16 v[100:103], v[36:39], a[180:183], v[100:103]
    s_add_u32 m0, s62, 106816
    v_mfma_f32_16x16x32_bf16 v[104:107], v[36:39], a[212:215], v[104:107]
    buffer_load_dwordx4 v12, s[24:27], s60 offen offset:1024  lds
    v_mfma_f32_16x16x32_bf16 v[108:111], v[36:39], a[244:247], v[108:111]
    ds_read_b128 v[36:39], v8 offset:42304
    s_waitcnt lgkmcnt(3)
    v_mfma_f32_16x16x32_bf16 v[96:99], v[40:43], a[152:155], v[96:99]
    v_mfma_f32_16x16x32_bf16 v[100:103], v[40:43], a[184:187], v[100:103]
    s_add_u32 m0, s62, 106880
    v_mfma_f32_16x16x32_bf16 v[104:107], v[40:43], a[216:219], v[104:107]
    buffer_load_dwordx4 v12, s[24:27], s60 offen offset:2048  lds
    v_mfma_f32_16x16x32_bf16 v[108:111], v[40:43], a[248:251], v[108:111]
    ds_read_b128 v[40:43], v8 offset:42368
    s_waitcnt lgkmcnt(3)
    v_mfma_f32_16x16x32_bf16 v[96:99], v[44:47], a[156:159], v[96:99]
    v_mfma_f32_16x16x32_bf16 v[100:103], v[44:47], a[188:191], v[100:103]
    s_add_u32 m0, s62, 106944
    v_mfma_f32_16x16x32_bf16 v[104:107], v[44:47], a[220:223], v[104:107]
    buffer_load_dwordx4 v12, s[24:27], s60 offen offset:3072  lds
    v_mfma_f32_16x16x32_bf16 v[108:111], v[44:47], a[252:255], v[108:111]
    ds_read_b128 v[44:47], v8 offset:42432
    s_waitcnt lgkmcnt(3)
    v_mfma_f32_16x16x32_bf16 v[112:115], v[32:35], a[128:131], v[48:51]
    v_mfma_f32_16x16x32_bf16 v[116:119], v[32:35], a[160:163], v[52:55]
    v_mfma_f32_16x16x32_bf16 v[120:123], v[32:35], a[192:195], v[56:59]
    v_exp_f32 v24, v96
    v_mfma_f32_16x16x32_bf16 v[124:127], v[32:35], a[224:227], v[60:63]
    ds_read_b128 v[32:35], v8 offset:42496
    s_waitcnt lgkmcnt(3)
    v_mfma_f32_16x16x32_bf16 v[112:115], v[36:39], a[132:135], v[112:115]
    v_exp_f32 v25, v97
    v_mfma_f32_16x16x32_bf16 v[116:119], v[36:39], a[164:167], v[116:119]
    v_exp_f32 v26, v98
    v_mfma_f32_16x16x32_bf16 v[120:123], v[36:39], a[196:199], v[120:123]
    v_add_f32 v20, v24, v25
    v_cvt_pk_bf16_f32 v80, v24, v25
    v_mfma_f32_16x16x32_bf16 v[124:127], v[36:39], a[228:231], v[124:127]
    ds_read_b128 v[36:39], v8 offset:42560
    s_waitcnt lgkmcnt(3)
    v_mfma_f32_16x16x32_bf16 v[112:115], v[40:43], a[136:139], v[112:115]
    v_exp_f32 v27, v99
    v_mfma_f32_16x16x32_bf16 v[116:119], v[40:43], a[168:171], v[116:119]
    v_add_f32 v20, v20, v26
    v_mfma_f32_16x16x32_bf16 v[120:123], v[40:43], a[200:203], v[120:123]
    v_add_f32 v20, v20, v27
    v_cvt_pk_bf16_f32 v81, v26, v27
    v_mfma_f32_16x16x32_bf16 v[124:127], v[40:43], a[232:235], v[124:127]
    ds_read_b128 v[40:43], v8 offset:42624
    s_waitcnt lgkmcnt(3)
    v_mfma_f32_16x16x32_bf16 v[112:115], v[44:47], a[140:143], v[112:115]
    v_exp_f32 v28, v100
    v_mfma_f32_16x16x32_bf16 v[116:119], v[44:47], a[172:175], v[116:119]
    v_exp_f32 v29, v101
    v_mfma_f32_16x16x32_bf16 v[120:123], v[44:47], a[204:207], v[120:123]
    v_exp_f32 v30, v102
    v_mfma_f32_16x16x32_bf16 v[124:127], v[44:47], a[236:239], v[124:127]
    ds_read_b128 v[44:47], v8 offset:42688
    v_add_f32 v21, v28, v29
    s_waitcnt lgkmcnt(3)
    v_mfma_f32_16x16x32_bf16 v[112:115], v[32:35], a[144:147], v[112:115]
    v_cvt_pk_bf16_f32 v84, v28, v29
    v_mfma_f32_16x16x32_bf16 v[116:119], v[32:35], a[176:179], v[116:119]
    v_exp_f32 v31, v103
    v_mfma_f32_16x16x32_bf16 v[120:123], v[32:35], a[208:211], v[120:123]
    v_add_f32 v21, v21, v30
    v_mfma_f32_16x16x32_bf16 v[124:127], v[32:35], a[240:243], v[124:127]
    v_add_f32 v21, v21, v31
    v_cvt_pk_bf16_f32 v85, v30, v31
    s_waitcnt lgkmcnt(2)
    v_mfma_f32_16x16x32_bf16 v[112:115], v[36:39], a[148:151], v[112:115]
    v_exp_f32 v24, v104
    v_mfma_f32_16x16x32_bf16 v[116:119], v[36:39], a[180:183], v[116:119]
    s_add_u32 s59, s59, 32768
    s_add_u32 s60, s60, 32768
    v_mfma_f32_16x16x32_bf16 v[120:123], v[36:39], a[212:215], v[120:123]
    v_exp_f32 v25, v105
    v_mfma_f32_16x16x32_bf16 v[124:127], v[36:39], a[244:247], v[124:127]
    s_waitcnt lgkmcnt(0)
    s_waitcnt vmcnt(8)
    s_barrier
    ds_read_b64_tr_b16 v[32:33], v9 offset:0
    ds_read_b64_tr_b16 v[34:35], v9 offset:8704
    ds_read_b64_tr_b16 v[36:37], v10 offset:32
    ds_read_b64_tr_b16 v[38:39], v10 offset:8736
    v_mfma_f32_16x16x32_bf16 v[112:115], v[40:43], a[152:155], v[112:115]
    v_exp_f32 v26, v106
    v_mfma_f32_16x16x32_bf16 v[116:119], v[40:43], a[184:187], v[116:119]
    s_add_u32 m0, s56, 0
    s_add_u32 s55, s68, 0
    buffer_load_dwordx4 v14, s[32:35], s55 offen lds
    v_mfma_f32_16x16x32_bf16 v[120:123], v[40:43], a[216:219], v[120:123]
    v_add_f32 v22, v24, v25
    v_cvt_pk_bf16_f32 v88, v24, v25
    v_mfma_f32_16x16x32_bf16 v[124:127], v[40:43], a[248:251], v[124:127]
    ds_read_b64_tr_b16 v[40:41], v9 offset:64
    ds_read_b64_tr_b16 v[42:43], v9 offset:8768
    v_mfma_f32_16x16x32_bf16 v[112:115], v[44:47], a[156:159], v[112:115]
    v_exp_f32 v27, v107
    v_mfma_f32_16x16x32_bf16 v[116:119], v[44:47], a[188:191], v[116:119]
    s_add_u32 m0, s56, 1024
    s_add_u32 s55, s68, 7168
    buffer_load_dwordx4 v14, s[32:35], s55 offen lds
    v_mfma_f32_16x16x32_bf16 v[120:123], v[44:47], a[220:223], v[120:123]
    v_add_f32 v22, v22, v26
    v_mfma_f32_16x16x32_bf16 v[124:127], v[44:47], a[252:255], v[124:127]
    ds_read_b64_tr_b16 v[44:45], v10 offset:96
    ds_read_b64_tr_b16 v[46:47], v10 offset:8800
    s_waitcnt lgkmcnt(6)
    v_mfma_f32_16x16x32_bf16 v[128:131], v[32:35], v[64:67], v[128:131]
    v_add_f32 v22, v22, v27
    v_cvt_pk_bf16_f32 v89, v26, v27
    v_mfma_f32_16x16x32_bf16 v[132:135], v[32:35], v[68:71], v[132:135]
    s_add_u32 m0, s56, 2048
    s_add_u32 s55, s68, 14336
    buffer_load_dwordx4 v14, s[32:35], s55 offen lds
    v_mfma_f32_16x16x32_bf16 a[0:3], v[32:35], v[72:75], a[0:3]
    v_exp_f32 v28, v108
    v_mfma_f32_16x16x32_bf16 a[4:7], v[32:35], v[76:79], a[4:7]
    ds_read_b64_tr_b16 v[32:33], v9 offset:128
    ds_read_b64_tr_b16 v[34:35], v9 offset:8832
    s_waitcnt lgkmcnt(6)
    v_mfma_f32_16x16x32_bf16 v[136:139], v[36:39], v[64:67], v[136:139]
    v_exp_f32 v29, v109
    v_mfma_f32_16x16x32_bf16 v[140:143], v[36:39], v[68:71], v[140:143]
    s_add_u32 m0, s56, 3072
    s_add_u32 s55, s68, 21504
    buffer_load_dwordx4 v14, s[32:35], s55 offen lds
    v_mfma_f32_16x16x32_bf16 a[8:11], v[36:39], v[72:75], a[8:11]
    v_exp_f32 v30, v110
    v_mfma_f32_16x16x32_bf16 a[12:15], v[36:39], v[76:79], a[12:15]
    ds_read_b64_tr_b16 v[36:37], v10 offset:160
    ds_read_b64_tr_b16 v[38:39], v10 offset:8864
    s_waitcnt lgkmcnt(6)
    v_mfma_f32_16x16x32_bf16 v[144:147], v[40:43], v[64:67], v[144:147]
    v_add_f32 v23, v28, v29
    v_cvt_pk_bf16_f32 v92, v28, v29
    v_mfma_f32_16x16x32_bf16 v[148:151], v[40:43], v[68:71], v[148:151]
    s_add_u32 m0, s56, 4096
    s_add_u32 s55, s68, 28672
    buffer_load_dwordx4 v14, s[32:35], s55 offen lds
    v_mfma_f32_16x16x32_bf16 a[16:19], v[40:43], v[72:75], a[16:19]
    v_exp_f32 v31, v111
    v_mfma_f32_16x16x32_bf16 a[20:23], v[40:43], v[76:79], a[20:23]
    ds_read_b64_tr_b16 v[40:41], v9 offset:192
    ds_read_b64_tr_b16 v[42:43], v9 offset:8896
    s_waitcnt lgkmcnt(6)
    v_mfma_f32_16x16x32_bf16 v[152:155], v[44:47], v[64:67], v[152:155]
    v_add_f32 v23, v23, v30
    v_mfma_f32_16x16x32_bf16 v[156:159], v[44:47], v[68:71], v[156:159]
    s_add_u32 m0, s56, 5120
    s_add_u32 s55, s68, 35840
    buffer_load_dwordx4 v14, s[32:35], s55 offen lds
    v_mfma_f32_16x16x32_bf16 a[24:27], v[44:47], v[72:75], a[24:27]
    v_add_f32 v23, v23, v31
    v_cvt_pk_bf16_f32 v93, v30, v31
    v_mfma_f32_16x16x32_bf16 a[28:31], v[44:47], v[76:79], a[28:31]
    ds_read_b64_tr_b16 v[44:45], v10 offset:224
    ds_read_b64_tr_b16 v[46:47], v10 offset:8928
    s_waitcnt lgkmcnt(6)
    v_mfma_f32_16x16x32_bf16 v[160:163], v[32:35], v[64:67], v[160:163]
    v_exp_f32 v24, v112
    v_mfma_f32_16x16x32_bf16 v[164:167], v[32:35], v[68:71], v[164:167]
    s_add_u32 m0, s56, 6144
    s_add_u32 s55, s68, 43008
    buffer_load_dwordx4 v14, s[32:35], s55 offen lds
    v_mfma_f32_16x16x32_bf16 a[32:35], v[32:35], v[72:75], a[32:35]
    v_exp_f32 v25, v113
    v_mfma_f32_16x16x32_bf16 a[36:39], v[32:35], v[76:79], a[36:39]
    ds_read_b64_tr_b16 v[32:33], v9 offset:256
    ds_read_b64_tr_b16 v[34:35], v9 offset:8960
    s_waitcnt lgkmcnt(6)
    v_mfma_f32_16x16x32_bf16 v[168:171], v[36:39], v[64:67], v[168:171]
    v_exp_f32 v26, v114
    v_mfma_f32_16x16x32_bf16 v[172:175], v[36:39], v[68:71], v[172:175]
    s_add_u32 m0, s56, 7168
    s_add_u32 s55, s68, 50176
    buffer_load_dwordx4 v14, s[32:35], s55 offen lds
    v_mfma_f32_16x16x32_bf16 a[40:43], v[36:39], v[72:75], a[40:43]
    v_add_f32 v20, v20, v24
    v_cvt_pk_bf16_f32 v82, v24, v25
    v_mfma_f32_16x16x32_bf16 a[44:47], v[36:39], v[76:79], a[44:47]
    ds_read_b64_tr_b16 v[36:37], v10 offset:288
    ds_read_b64_tr_b16 v[38:39], v10 offset:8992
    s_waitcnt lgkmcnt(6)
    v_mfma_f32_16x16x32_bf16 v[176:179], v[40:43], v[64:67], v[176:179]
    v_exp_f32 v27, v115
    v_mfma_f32_16x16x32_bf16 v[180:183], v[40:43], v[68:71], v[180:183]
    s_add_u32 m0, s56, 32768
    s_add_u32 s55, s68, 229376
    buffer_load_dwordx4 v14, s[32:35], s55 offen lds
    v_mfma_f32_16x16x32_bf16 a[48:51], v[40:43], v[72:75], a[48:51]
    v_add_f32 v20, v20, v25
    v_add_f32 v20, v20, v26
    v_mfma_f32_16x16x32_bf16 a[52:55], v[40:43], v[76:79], a[52:55]
    ds_read_b64_tr_b16 v[40:41], v9 offset:320
    ds_read_b64_tr_b16 v[42:43], v9 offset:9024
    s_waitcnt lgkmcnt(6)
    v_mfma_f32_16x16x32_bf16 v[184:187], v[44:47], v[64:67], v[184:187]
    v_add_f32 v20, v20, v27
    v_cvt_pk_bf16_f32 v83, v26, v27
    v_mfma_f32_16x16x32_bf16 v[188:191], v[44:47], v[68:71], v[188:191]
    s_add_u32 m0, s56, 33792
    s_add_u32 s55, s68, 236544
    buffer_load_dwordx4 v14, s[32:35], s55 offen lds
    v_mfma_f32_16x16x32_bf16 a[56:59], v[44:47], v[72:75], a[56:59]
    v_exp_f32 v28, v116
    v_mfma_f32_16x16x32_bf16 a[60:63], v[44:47], v[76:79], a[60:63]
    ds_read_b64_tr_b16 v[44:45], v10 offset:352
    ds_read_b64_tr_b16 v[46:47], v10 offset:9056
    s_waitcnt lgkmcnt(6)
    v_mfma_f32_16x16x32_bf16 v[192:195], v[32:35], v[64:67], v[192:195]
    v_exp_f32 v29, v117
    v_mfma_f32_16x16x32_bf16 v[196:199], v[32:35], v[68:71], v[196:199]
    s_add_u32 m0, s56, 34816
    s_add_u32 s55, s68, 243712
    buffer_load_dwordx4 v14, s[32:35], s55 offen lds
    v_mfma_f32_16x16x32_bf16 a[64:67], v[32:35], v[72:75], a[64:67]
    v_exp_f32 v30, v118
    v_mfma_f32_16x16x32_bf16 a[68:71], v[32:35], v[76:79], a[68:71]
    ds_read_b64_tr_b16 v[32:33], v9 offset:384
    ds_read_b64_tr_b16 v[34:35], v9 offset:9088
    s_waitcnt lgkmcnt(6)
    v_mfma_f32_16x16x32_bf16 v[200:203], v[36:39], v[64:67], v[200:203]
    v_add_f32 v21, v21, v28
    v_cvt_pk_bf16_f32 v86, v28, v29
    v_mfma_f32_16x16x32_bf16 v[204:207], v[36:39], v[68:71], v[204:207]
    s_add_u32 m0, s56, 35840
    s_add_u32 s55, s68, 250880
    buffer_load_dwordx4 v14, s[32:35], s55 offen lds
    v_mfma_f32_16x16x32_bf16 a[72:75], v[36:39], v[72:75], a[72:75]
    v_exp_f32 v31, v119
    v_mfma_f32_16x16x32_bf16 a[76:79], v[36:39], v[76:79], a[76:79]
    ds_read_b64_tr_b16 v[36:37], v10 offset:416
    ds_read_b64_tr_b16 v[38:39], v10 offset:9120
    s_waitcnt lgkmcnt(6)
    v_mfma_f32_16x16x32_bf16 v[208:211], v[40:43], v[64:67], v[208:211]
    v_add_f32 v21, v21, v29
    v_add_f32 v21, v21, v30
    v_mfma_f32_16x16x32_bf16 v[212:215], v[40:43], v[68:71], v[212:215]
    s_add_u32 m0, s56, 36864
    s_add_u32 s55, s68, 258048
    buffer_load_dwordx4 v14, s[32:35], s55 offen lds
    v_mfma_f32_16x16x32_bf16 a[80:83], v[40:43], v[72:75], a[80:83]
    v_add_f32 v21, v21, v31
    v_cvt_pk_bf16_f32 v87, v30, v31
    v_mfma_f32_16x16x32_bf16 a[84:87], v[40:43], v[76:79], a[84:87]
    ds_read_b64_tr_b16 v[40:41], v9 offset:448
    ds_read_b64_tr_b16 v[42:43], v9 offset:9152
    s_waitcnt lgkmcnt(6)
    v_mfma_f32_16x16x32_bf16 v[216:219], v[44:47], v[64:67], v[216:219]
    v_exp_f32 v24, v120
    v_mfma_f32_16x16x32_bf16 v[220:223], v[44:47], v[68:71], v[220:223]
    s_add_u32 m0, s56, 37888
    s_add_u32 s55, s68, 265216
    buffer_load_dwordx4 v14, s[32:35], s55 offen lds
    v_mfma_f32_16x16x32_bf16 a[88:91], v[44:47], v[72:75], a[88:91]
    v_exp_f32 v25, v121
    v_mfma_f32_16x16x32_bf16 a[92:95], v[44:47], v[76:79], a[92:95]
    ds_read_b64_tr_b16 v[44:45], v10 offset:480
    ds_read_b64_tr_b16 v[46:47], v10 offset:9184
    s_waitcnt lgkmcnt(6)
    v_mfma_f32_16x16x32_bf16 v[224:227], v[32:35], v[64:67], v[224:227]
    v_exp_f32 v26, v122
    v_mfma_f32_16x16x32_bf16 v[228:231], v[32:35], v[68:71], v[228:231]
    s_add_u32 m0, s56, 38912
    s_add_u32 s55, s68, 272384
    buffer_load_dwordx4 v14, s[32:35], s55 offen lds
    v_mfma_f32_16x16x32_bf16 a[96:99], v[32:35], v[72:75], a[96:99]
    v_add_f32 v22, v22, v24
    v_cvt_pk_bf16_f32 v90, v24, v25
    v_mfma_f32_16x16x32_bf16 a[100:103], v[32:35], v[76:79], a[100:103]
    v_exp_f32 v27, v123
    s_waitcnt lgkmcnt(4)
    v_mfma_f32_16x16x32_bf16 v[232:235], v[36:39], v[64:67], v[232:235]
    v_add_f32 v22, v22, v25
    v_add_f32 v22, v22, v26
    v_mfma_f32_16x16x32_bf16 v[236:239], v[36:39], v[68:71], v[236:239]
    s_add_u32 m0, s56, 39936
    s_add_u32 s55, s68, 279552
    buffer_load_dwordx4 v14, s[32:35], s55 offen lds
    v_mfma_f32_16x16x32_bf16 a[104:107], v[36:39], v[72:75], a[104:107]
    v_add_f32 v22, v22, v27
    v_cvt_pk_bf16_f32 v91, v26, v27
    v_mfma_f32_16x16x32_bf16 a[108:111], v[36:39], v[76:79], a[108:111]
    s_waitcnt lgkmcnt(0)
    s_waitcnt vmcnt(16)
    s_barrier
    ds_read_b64_tr_b16 v[32:33], v9 offset:34816
    ds_read_b64_tr_b16 v[34:35], v9 offset:43520
    ds_read_b64_tr_b16 v[36:37], v10 offset:34848
    ds_read_b64_tr_b16 v[38:39], v10 offset:43552
    v_mfma_f32_16x16x32_bf16 v[240:243], v[40:43], v[64:67], v[240:243]
    v_exp_f32 v28, v124
    v_mfma_f32_16x16x32_bf16 v[244:247], v[40:43], v[68:71], v[244:247]
    v_exp_f32 v29, v125
    v_mfma_f32_16x16x32_bf16 a[112:115], v[40:43], v[72:75], a[112:115]
    v_exp_f32 v30, v126
    v_mfma_f32_16x16x32_bf16 a[116:119], v[40:43], v[76:79], a[116:119]
    ds_read_b64_tr_b16 v[40:41], v9 offset:34880
    ds_read_b64_tr_b16 v[42:43], v9 offset:43584
    v_mfma_f32_16x16x32_bf16 v[248:251], v[44:47], v[64:67], v[248:251]
    v_add_f32 v23, v23, v28
    v_cvt_pk_bf16_f32 v94, v28, v29
    v_mfma_f32_16x16x32_bf16 v[252:255], v[44:47], v[68:71], v[252:255]
    v_exp_f32 v31, v127
    v_mfma_f32_16x16x32_bf16 a[120:123], v[44:47], v[72:75], a[120:123]
    v_add_f32 v23, v23, v29
    v_add_f32 v23, v23, v30
    v_mfma_f32_16x16x32_bf16 a[124:127], v[44:47], v[76:79], a[124:127]
    ds_read_b64_tr_b16 v[44:45], v10 offset:34912
    ds_read_b64_tr_b16 v[46:47], v10 offset:43616
    v_add_f32 v23, v23, v31
    v_cvt_pk_bf16_f32 v95, v30, v31
    v_max3_f32 v13, v20, v21, v22
    v_max_f32 v13, v13, v23
    v_cmp_lt_f32 vcc, s64, v13
    s_mov_b32 s66, 2
    s_nop 0
    s_cbranch_vccnz K2_rare1
K2_ret2:
    s_waitcnt lgkmcnt(6)
    v_mfma_f32_16x16x32_bf16 v[128:131], v[32:35], v[80:83], v[128:131]
    v_add_f32 v16, v16, v20
    v_mfma_f32_16x16x32_bf16 v[132:135], v[32:35], v[84:87], v[132:135]
    v_add_f32 v17, v17, v21
    v_mfma_f32_16x16x32_bf16 a[0:3], v[32:35], v[88:91], a[0:3]
    v_add_f32 v18, v18, v22
    v_mfma_f32_16x16x32_bf16 a[4:7], v[32:35], v[92:95], a[4:7]
    v_add_f32 v19, v19, v23
    ds_read_b64_tr_b16 v[32:33], v9 offset:34944
    ds_read_b64_tr_b16 v[34:35], v9 offset:43648
    s_waitcnt lgkmcnt(6)
    v_mfma_f32_16x16x32_bf16 v[136:139], v[36:39], v[80:83], v[136:139]
    v_mfma_f32_16x16x32_bf16 v[140:143], v[36:39], v[84:87], v[140:143]
    v_mfma_f32_16x16x32_bf16 a[8:11], v[36:39], v[88:91], a[8:11]
    v_mov_b32 v96, v16
    v_mfma_f32_16x16x32_bf16 a[12:15], v[36:39], v[92:95], a[12:15]
    ds_read_b64_tr_b16 v[36:37], v10 offset:34976
    ds_read_b64_tr_b16 v[38:39], v10 offset:43680
    s_waitcnt lgkmcnt(6)
    v_mfma_f32_16x16x32_bf16 v[144:147], v[40:43], v[80:83], v[144:147]
    v_mov_b32 v97, v17
    v_mfma_f32_16x16x32_bf16 v[148:151], v[40:43], v[84:87], v[148:151]
    v_mov_b32 v98, v18
    v_mfma_f32_16x16x32_bf16 a[16:19], v[40:43], v[88:91], a[16:19]
    v_mov_b32 v99, v19
    v_mfma_f32_16x16x32_bf16 a[20:23], v[40:43], v[92:95], a[20:23]
    ds_read_b64_tr_b16 v[40:41], v9 offset:35008
    ds_read_b64_tr_b16 v[42:43], v9 offset:43712
    s_waitcnt lgkmcnt(6)
    v_mfma_f32_16x16x32_bf16 v[152:155], v[44:47], v[80:83], v[152:155]
    v_permlane16_swap_b32 v16, v96
    v_mfma_f32_16x16x32_bf16 v[156:159], v[44:47], v[84:87], v[156:159]
    v_permlane16_swap_b32 v17, v97
    v_mfma_f32_16x16x32_bf16 a[24:27], v[44:47], v[88:91], a[24:27]
    v_permlane16_swap_b32 v18, v98
    v_mfma_f32_16x16x32_bf16 a[28:31], v[44:47], v[92:95], a[28:31]
    ds_read_b64_tr_b16 v[44:45], v10 offset:35040
    ds_read_b64_tr_b16 v[46:47], v10 offset:43744
    s_waitcnt lgkmcnt(6)
    v_mfma_f32_16x16x32_bf16 v[160:163], v[32:35], v[80:83], v[160:163]
    v_permlane16_swap_b32 v19, v99
    v_mfma_f32_16x16x32_bf16 v[164:167], v[32:35], v[84:87], v[164:167]
    v_add_f32 v16, v16, v96
    v_mfma_f32_16x16x32_bf16 a[32:35], v[32:35], v[88:91], a[32:35]
    v_add_f32 v17, v17, v97
    v_mfma_f32_16x16x32_bf16 a[36:39], v[32:35], v[92:95], a[36:39]
    ds_read_b64_tr_b16 v[32:33], v9 offset:35072
    ds_read_b64_tr_b16 v[34:35], v9 offset:43776
    s_waitcnt lgkmcnt(6)
    v_mfma_f32_16x16x32_bf16 v[168:171], v[36:39], v[80:83], v[168:171]
    v_add_f32 v18, v18, v98
    v_mfma_f32_16x16x32_bf16 v[172:175], v[36:39], v[84:87], v[172:175]
    v_add_f32 v19, v19, v99
    v_mfma_f32_16x16x32_bf16 a[40:43], v[36:39], v[88:91], a[40:43]
    v_mov_b32 v96, v16
    v_mfma_f32_16x16x32_bf16 a[44:47], v[36:39], v[92:95], a[44:47]
    ds_read_b64_tr_b16 v[36:37], v10 offset:35104
    ds_read_b64_tr_b16 v[38:39], v10 offset:43808
    s_waitcnt lgkmcnt(6)
    v_mfma_f32_16x16x32_bf16 v[176:179], v[40:43], v[80:83], v[176:179]
    v_mov_b32 v97, v17
    v_mfma_f32_16x16x32_bf16 v[180:183], v[40:43], v[84:87], v[180:183]
    v_mov_b32 v98, v18
    v_mfma_f32_16x16x32_bf16 a[48:51], v[40:43], v[88:91], a[48:51]
    v_mov_b32 v99, v19
    v_mfma_f32_16x16x32_bf16 a[52:55], v[40:43], v[92:95], a[52:55]
    ds_read_b64_tr_b16 v[40:41], v9 offset:35136
    ds_read_b64_tr_b16 v[42:43], v9 offset:43840
    s_waitcnt lgkmcnt(6)
    v_mfma_f32_16x16x32_bf16 v[184:187], v[44:47], v[80:83], v[184:187]
    v_permlane32_swap_b32 v16, v96
    v_mfma_f32_16x16x32_bf16 v[188:191], v[44:47], v[84:87], v[188:191]
    v_permlane32_swap_b32 v17, v97
    v_mfma_f32_16x16x32_bf16 a[56:59], v[44:47], v[88:91], a[56:59]
    v_permlane32_swap_b32 v18, v98
    v_mfma_f32_16x16x32_bf16 a[60:63], v[44:47], v[92:95], a[60:63]
    ds_read_b64_tr_b16 v[44:45], v10 offset:35168
    ds_read_b64_tr_b16 v[46:47], v10 offset:43872
    s_waitcnt lgkmcnt(6)
    v_mfma_f32_16x16x32_bf16 v[192:195], v[32:35], v[80:83], v[192:195]
    v_permlane32_swap_b32 v19, v99
    v_mfma_f32_16x16x32_bf16 v[196:199], v[32:35], v[84:87], v[196:199]
    v_add_f32 v16, v16, v96
    v_mfma_f32_16x16x32_bf16 a[64:67], v[32:35], v[88:91], a[64:67]
    v_add_f32 v17, v17, v97
    v_mfma_f32_16x16x32_bf16 a[68:71], v[32:35], v[92:95], a[68:71]
    ds_read_b64_tr_b16 v[32:33], v9 offset:35200
    ds_read_b64_tr_b16 v[34:35], v9 offset:43904
    s_waitcnt lgkmcnt(6)
    v_mfma_f32_16x16x32_bf16 v[200:203], v[36:39], v[80:83], v[200:203]
    v_add_f32 v18, v18, v98
    v_mfma_f32_16x16x32_bf16 v[204:207], v[36:39], v[84:87], v[204:207]
    v_add_f32 v19, v19, v99
    v_mfma_f32_16x16x32_bf16 a[72:75], v[36:39], v[88:91], a[72:75]
    v_lshlrev_b32 v104, 3, v1
    v_mfma_f32_16x16x32_bf16 a[76:79], v[36:39], v[92:95], a[76:79]
    ds_read_b64_tr_b16 v[36:37], v10 offset:35232
    ds_read_b64_tr_b16 v[38:39], v10 offset:43936
    s_waitcnt lgkmcnt(6)
    v_mfma_f32_16x16x32_bf16 v[208:211], v[40:43], v[80:83], v[208:211]
    s_lshl_b32 s53, s48, 10
    v_mfma_f32_16x16x32_bf16 v[212:215], v[40:43], v[84:87], v[212:215]
    s_add_u32 s53, s53, 137216
    v_mfma_f32_16x16x32_bf16 a[80:83], v[40:43], v[88:91], a[80:83]
    v_add_u32 v100, s53, v104
    v_mfma_f32_16x16x32_bf16 a[84:87], v[40:43], v[92:95], a[84:87]
    ds_read_b64_tr_b16 v[40:41], v9 offset:35264
    ds_read_b64_tr_b16 v[42:43], v9 offset:43968
    s_waitcnt lgkmcnt(6)
    v_mfma_f32_16x16x32_bf16 v[216:219], v[44:47], v[80:83], v[216:219]
    s_xor_b32 s54, s48, 2
    v_mfma_f32_16x16x32_bf16 v[220:223], v[44:47], v[84:87], v[220:223]
    s_lshl_b32 s53, s54, 10
    v_mfma_f32_16x16x32_bf16 a[88:91], v[44:47], v[88:91], a[88:91]
    s_add_u32 s53, s53, 137216
    v_mfma_f32_16x16x32_bf16 a[92:95], v[44:47], v[92:95], a[92:95]
    ds_read_b64_tr_b16 v[44:45], v10 offset:35296
    ds_read_b64_tr_b16 v[46:47], v10 offset:44000
    s_waitcnt lgkmcnt(6)
    v_mfma_f32_16x16x32_bf16 v[224:227], v[32:35], v[80:83], v[224:227]
    v_add_u32 v101, s53, v104
    v_mfma_f32_16x16x32_bf16 v[228:231], v[32:35], v[84:87], v[228:231]
    v_mov_b32 v106, v56
    v_mfma_f32_16x16x32_bf16 a[96:99], v[32:35], v[88:91], a[96:99]
    v_mov_b32 v107, v18
    v_mfma_f32_16x16x32_bf16 a[100:103], v[32:35], v[92:95], a[100:103]
    ds_write_b64 v100, v[106:107] offset:0
    s_waitcnt lgkmcnt(5)
    v_mfma_f32_16x16x32_bf16 v[232:235], v[36:39], v[80:83], v[232:235]
    v_mov_b32 v108, v60
    v_mfma_f32_16x16x32_bf16 v[236:239], v[36:39], v[84:87], v[236:239]
    v_mov_b32 v109, v19
    v_mfma_f32_16x16x32_bf16 a[104:107], v[36:39], v[88:91], a[104:107]
    ds_write_b64 v100, v[108:109] offset:512
    v_mfma_f32_16x16x32_bf16 a[108:111], v[36:39], v[92:95], a[108:111]
    v_lshlrev_b32 v104, 4, v1
    s_waitcnt lgkmcnt(4)
    v_mfma_f32_16x16x32_bf16 v[240:243], v[40:43], v[80:83], v[240:243]
    s_lshl_b32 s53, s48, 13
    v_mfma_f32_16x16x32_bf16 v[244:247], v[40:43], v[84:87], v[244:247]
    s_add_u32 s53, s53, 67584
    v_mfma_f32_16x16x32_bf16 a[112:115], v[40:43], v[88:91], a[112:115]
    v_add_u32 v102, s53, v104
    v_mfma_f32_16x16x32_bf16 a[116:119], v[40:43], v[92:95], a[116:119]
    s_lshl_b32 s53, s54, 13
    s_waitcnt lgkmcnt(2)
    v_mfma_f32_16x16x32_bf16 v[248:251], v[44:47], v[80:83], v[248:251]
    s_add_u32 s53, s53, 67584
    v_mfma_f32_16x16x32_bf16 v[252:255], v[44:47], v[84:87], v[252:255]
    v_add_u32 v103, s53, v104
    v_mfma_f32_16x16x32_bf16 a[120:123], v[44:47], v[88:91], a[120:123]
    v_mfma_f32_16x16x32_bf16 a[124:127], v[44:47], v[92:95], a[124:127]
    s_waitcnt lgkmcnt(0)
    s_barrier
    ds_read_b64 v[28:29], v101 offset:0
    ds_read_b64 v[30:31], v101 offset:512
    s_nop 3
    ds_write_b128 v102, a[0:3] offset:0
    ds_write_b128 v102, a[4:7] offset:1024
    ds_write_b128 v102, a[8:11] offset:2048
    ds_write_b128 v102, a[12:15] offset:3072
    ds_write_b128 v102, a[16:19] offset:4096
    ds_write_b128 v102, a[20:23] offset:5120
    ds_write_b128 v102, a[24:27] offset:6144
    ds_write_b128 v102, a[28:31] offset:7168
    ds_write_b128 v102, a[32:35] offset:32768
    ds_write_b128 v102, a[36:39] offset:33792
    ds_write_b128 v102, a[40:43] offset:34816
    ds_write_b128 v102, a[44:47] offset:35840
    ds_write_b128 v102, a[48:51] offset:36864
    ds_write_b128 v102, a[52:55] offset:37888
    ds_write_b128 v102, a[56:59] offset:38912
    ds_write_b128 v102, a[60:63] offset:39936
    s_waitcnt lgkmcnt(15)
    v_min_f32 v13, v48, v28
    v_sub_f32 v104, v13, v48
    v_sub_f32 v106, v13, v28
    v_exp_f32 v104, v104
    v_exp_f32 v106, v106
    s_nop 0
    v_mul_f32 v13, v104, v16
    v_fmac_f32 v13, v106, v29
    v_rcp_f32 v13, v13
    s_nop 0
    v_mul_f32 v104, v104, v13
    v_mul_f32 v106, v106, v13
    v_min_f32 v13, v52, v30
    v_sub_f32 v108, v13, v52
    v_sub_f32 v110, v13, v30
    v_exp_f32 v108, v108
    v_exp_f32 v110, v110
    s_nop 0
    v_mul_f32 v13, v108, v17
    v_fmac_f32 v13, v110, v31
    v_rcp_f32 v13, v13
    s_nop 0
    v_mul_f32 v108, v108, v13
    v_mul_f32 v110, v110, v13
    s_waitcnt lgkmcnt(0)
    s_barrier
    ds_read_b128 v[64:67], v103 offset:0
    ds_read_b128 v[68:71], v103 offset:1024
    ds_read_b128 v[72:75], v103 offset:2048
    ds_read_b128 v[76:79], v103 offset:3072
    ds_read_b128 v[80:83], v103 offset:4096
    ds_read_b128 v[84:87], v103 offset:5120
    ds_read_b128 v[88:91], v103 offset:6144
    ds_read_b128 v[92:95], v103 offset:7168
    ds_read_b128 v[16:19], v103 offset:32768
    ds_read_b128 v[20:23], v103 offset:33792
    ds_read_b128 v[24:27], v103 offset:34816
    ds_read_b128 v[28:31], v103 offset:35840
    ds_read_b128 v[32:35], v103 offset:36864
    ds_read_b128 v[36:39], v103 offset:37888
    ds_read_b128 v[40:43], v103 offset:38912
    ds_read_b128 v[44:47], v103 offset:39936
    s_waitcnt lgkmcnt(15)
    v_pk_mul_f32 v[64:65], v[64:65], v[106:107] op_sel_hi:[1,0]
    v_pk_mul_f32 v[66:67], v[66:67], v[106:107] op_sel_hi:[1,0]
    v_pk_fma_f32 v[128:129], v[128:129], v[104:105], v[64:65] op_sel_hi:[1,0,1]
    v_pk_fma_f32 v[130:131], v[130:131], v[104:105], v[66:67] op_sel_hi:[1,0,1]
    s_waitcnt lgkmcnt(14)
    v_pk_mul_f32 v[68:69], v[68:69], v[110:111] op_sel_hi:[1,0]
    v_pk_mul_f32 v[70:71], v[70:71], v[110:111] op_sel_hi:[1,0]
    v_pk_fma_f32 v[132:133], v[132:133], v[108:109], v[68:69] op_sel_hi:[1,0,1]
    v_pk_fma_f32 v[134:135], v[134:135], v[108:109], v[70:71] op_sel_hi:[1,0,1]
    s_waitcnt lgkmcnt(13)
    v_pk_mul_f32 v[72:73], v[72:73], v[106:107] op_sel_hi:[1,0]
    v_pk_mul_f32 v[74:75], v[74:75], v[106:107] op_sel_hi:[1,0]
    v_pk_fma_f32 v[136:137], v[136:137], v[104:105], v[72:73] op_sel_hi:[1,0,1]
    v_pk_fma_f32 v[138:139], v[138:139], v[104:105], v[74:75] op_sel_hi:[1,0,1]
    s_waitcnt lgkmcnt(12)
    v_pk_mul_f32 v[76:77], v[76:77], v[110:111] op_sel_hi:[1,0]
    v_pk_mul_f32 v[78:79], v[78:79], v[110:111] op_sel_hi:[1,0]
    v_pk_fma_f32 v[140:141], v[140:141], v[108:109], v[76:77] op_sel_hi:[1,0,1]
    v_pk_fma_f32 v[142:143], v[142:143], v[108:109], v[78:79] op_sel_hi:[1,0,1]
    s_waitcnt lgkmcnt(11)
    v_pk_mul_f32 v[80:81], v[80:81], v[106:107] op_sel_hi:[1,0]
    v_pk_mul_f32 v[82:83], v[82:83], v[106:107] op_sel_hi:[1,0]
    v_pk_fma_f32 v[144:145], v[144:145], v[104:105], v[80:81] op_sel_hi:[1,0,1]
    v_pk_fma_f32 v[146:147], v[146:147], v[104:105], v[82:83] op_sel_hi:[1,0,1]
    s_waitcnt lgkmcnt(10)
    v_pk_mul_f32 v[84:85], v[84:85], v[110:111] op_sel_hi:[1,0]
    v_pk_mul_f32 v[86:87], v[86:87], v[110:111] op_sel_hi:[1,0]
    v_pk_fma_f32 v[148:149], v[148:149], v[108:109], v[84:85] op_sel_hi:[1,0,1]
    v_pk_fma_f32 v[150:151], v[150:151], v[108:109], v[86:87] op_sel_hi:[1,0,1]
    s_waitcnt lgkmcnt(9)
    v_pk_mul_f32 v[88:89], v[88:89], v[106:107] op_sel_hi:[1,0]
    v_pk_mul_f32 v[90:91], v[90:91], v[106:107] op_sel_hi:[1,0]
    v_pk_fma_f32 v[152:153], v[152:153], v[104:105], v[88:89] op_sel_hi:[1,0,1]
    v_pk_fma_f32 v[154:155], v[154:155], v[104:105], v[90:91] op_sel_hi:[1,0,1]
    s_waitcnt lgkmcnt(8)
    v_pk_mul_f32 v[92:93], v[92:93], v[110:111] op_sel_hi:[1,0]
    v_pk_mul_f32 v[94:95], v[94:95], v[110:111] op_sel_hi:[1,0]
    v_pk_fma_f32 v[156:157], v[156:157], v[108:109], v[92:93] op_sel_hi:[1,0,1]
    v_pk_fma_f32 v[158:159], v[158:159], v[108:109], v[94:95] op_sel_hi:[1,0,1]
    v_cvt_pk_bf16_f32 v128, v128, v129
    v_cvt_pk_bf16_f32 v129, v130, v131
    v_cvt_pk_bf16_f32 v130, v136, v137
    v_cvt_pk_bf16_f32 v131, v138, v139
    v_cvt_pk_bf16_f32 v132, v132, v133
    v_cvt_pk_bf16_f32 v133, v134, v135
    v_cvt_pk_bf16_f32 v134, v140, v141
    v_cvt_pk_bf16_f32 v135, v142, v143
    v_cvt_pk_bf16_f32 v144, v144, v145
    v_cvt_pk_bf16_f32 v145, v146, v147
    v_cvt_pk_bf16_f32 v146, v152, v153
    v_cvt_pk_bf16_f32 v147, v154, v155
    v_cvt_pk_bf16_f32 v148, v148, v149
    v_cvt_pk_bf16_f32 v149, v150, v151
    v_cvt_pk_bf16_f32 v150, v156, v157
    v_cvt_pk_bf16_f32 v151, v158, v159
    s_waitcnt lgkmcnt(0)
    s_barrier
    ds_write_b128 v102, a[64:67] offset:0
    ds_write_b128 v102, a[68:71] offset:1024
    ds_write_b128 v102, a[72:75] offset:2048
    ds_write_b128 v102, a[76:79] offset:3072
    ds_write_b128 v102, a[80:83] offset:4096
    ds_write_b128 v102, a[84:87] offset:5120
    ds_write_b128 v102, a[88:91] offset:6144
    ds_write_b128 v102, a[92:95] offset:7168
    ds_write_b128 v102, a[96:99] offset:32768
    ds_write_b128 v102, a[100:103] offset:33792
    ds_write_b128 v102, a[104:107] offset:34816
    ds_write_b128 v102, a[108:111] offset:35840
    ds_write_b128 v102, a[112:115] offset:36864
    ds_write_b128 v102, a[116:119] offset:37888
    ds_write_b128 v102, a[120:123] offset:38912
    ds_write_b128 v102, a[124:127] offset:39936
    v_pk_mul_f32 v[16:17], v[16:17], v[106:107] op_sel_hi:[1,0]
    v_pk_mul_f32 v[18:19], v[18:19], v[106:107] op_sel_hi:[1,0]
    v_pk_fma_f32 v[160:161], v[160:161], v[104:105], v[16:17] op_sel_hi:[1,0,1]
    v_pk_fma_f32 v[162:163], v[162:163], v[104:105], v[18:19] op_sel_hi:[1,0,1]
    v_pk_mul_f32 v[20:21], v[20:21], v[110:111] op_sel_hi:[1,0]
    v_pk_mul_f32 v[22:23], v[22:23], v[110:111] op_sel_hi:[1,0]
    v_pk_fma_f32 v[164:165], v[164:165], v[108:109], v[20:21] op_sel_hi:[1,0,1]
    v_pk_fma_f32 v[166:167], v[166:167], v[108:109], v[22:23] op_sel_hi:[1,0,1]
    v_pk_mul_f32 v[24:25], v[24:25], v[106:107] op_sel_hi:[1,0]
    v_pk_mul_f32 v[26:27], v[26:27], v[106:107] op_sel_hi:[1,0]
    v_pk_fma_f32 v[168:169], v[168:169], v[104:105], v[24:25] op_sel_hi:[1,0,1]
    v_pk_fma_f32 v[170:171], v[170:171], v[104:105], v[26:27] op_sel_hi:[1,0,1]
    v_pk_mul_f32 v[28:29], v[28:29], v[110:111] op_sel_hi:[1,0]
    v_pk_mul_f32 v[30:31], v[30:31], v[110:111] op_sel_hi:[1,0]
    v_pk_fma_f32 v[172:173], v[172:173], v[108:109], v[28:29] op_sel_hi:[1,0,1]
    v_pk_fma_f32 v[174:175], v[174:175], v[108:109], v[30:31] op_sel_hi:[1,0,1]
    v_pk_mul_f32 v[32:33], v[32:33], v[106:107] op_sel_hi:[1,0]
    v_pk_mul_f32 v[34:35], v[34:35], v[106:107] op_sel_hi:[1,0]
    v_pk_fma_f32 v[176:177], v[176:177], v[104:105], v[32:33] op_sel_hi:[1,0,1]
    v_pk_fma_f32 v[178:179], v[178:179], v[104:105], v[34:35] op_sel_hi:[1,0,1]
    v_pk_mul_f32 v[36:37], v[36:37], v[110:111] op_sel_hi:[1,0]
    v_pk_mul_f32 v[38:39], v[38:39], v[110:111] op_sel_hi:[1,0]
    v_pk_fma_f32 v[180:181], v[180:181], v[108:109], v[36:37] op_sel_hi:[1,0,1]
    v_pk_fma_f32 v[182:183], v[182:183], v[108:109], v[38:39] op_sel_hi:[1,0,1]
    v_pk_mul_f32 v[40:41], v[40:41], v[106:107] op_sel_hi:[1,0]
    v_pk_mul_f32 v[42:43], v[42:43], v[106:107] op_sel_hi:[1,0]
    v_pk_fma_f32 v[184:185], v[184:185], v[104:105], v[40:41] op_sel_hi:[1,0,1]
    v_pk_fma_f32 v[186:187], v[186:187], v[104:105], v[42:43] op_sel_hi:[1,0,1]
    v_pk_mul_f32 v[44:45], v[44:45], v[110:111] op_sel_hi:[1,0]
    v_pk_mul_f32 v[46:47], v[46:47], v[110:111] op_sel_hi:[1,0]
    v_pk_fma_f32 v[188:189], v[188:189], v[108:109], v[44:45] op_sel_hi:[1,0,1]
    v_pk_fma_f32 v[190:191], v[190:191], v[108:109], v[46:47] op_sel_hi:[1,0,1]
    v_cvt_pk_bf16_f32 v160, v160, v161
    v_cvt_pk_bf16_f32 v161, v162, v163
    v_cvt_pk_bf16_f32 v162, v168, v169
    v_cvt_pk_bf16_f32 v163, v170, v171
    v_cvt_pk_bf16_f32 v164, v164, v165
    v_cvt_pk_bf16_f32 v165, v166, v167
    v_cvt_pk_bf16_f32 v166, v172, v173
    v_cvt_pk_bf16_f32 v167, v174, v175
    v_cvt_pk_bf16_f32 v176, v176, v177
    v_cvt_pk_bf16_f32 v177, v178, v179
    v_cvt_pk_bf16_f32 v178, v184, v185
    v_cvt_pk_bf16_f32 v179, v186, v187
    v_cvt_pk_bf16_f32 v180, v180, v181
    v_cvt_pk_bf16_f32 v181, v182, v183
    v_cvt_pk_bf16_f32 v182, v188, v189
    v_cvt_pk_bf16_f32 v183, v190, v191
    s_waitcnt lgkmcnt(0)
    s_barrier
    ds_read_b128 v[64:67], v103 offset:0
    ds_read_b128 v[68:71], v103 offset:1024
    ds_read_b128 v[72:75], v103 offset:2048
    ds_read_b128 v[76:79], v103 offset:3072
    ds_read_b128 v[80:83], v103 offset:4096
    ds_read_b128 v[84:87], v103 offset:5120
    ds_read_b128 v[88:91], v103 offset:6144
    ds_read_b128 v[92:95], v103 offset:7168
    ds_read_b128 v[16:19], v103 offset:32768
    ds_read_b128 v[20:23], v103 offset:33792
    ds_read_b128 v[24:27], v103 offset:34816
    ds_read_b128 v[28:31], v103 offset:35840
    ds_read_b128 v[32:35], v103 offset:36864
    ds_read_b128 v[36:39], v103 offset:37888
    ds_read_b128 v[40:43], v103 offset:38912
    ds_read_b128 v[44:47], v103 offset:39936
    s_waitcnt lgkmcnt(15)
    v_pk_mul_f32 v[64:65], v[64:65], v[106:107] op_sel_hi:[1,0]
    v_pk_mul_f32 v[66:67], v[66:67], v[106:107] op_sel_hi:[1,0]
    v_pk_fma_f32 v[192:193], v[192:193], v[104:105], v[64:65] op_sel_hi:[1,0,1]
    v_pk_fma_f32 v[194:195], v[194:195], v[104:105], v[66:67] op_sel_hi:[1,0,1]
    s_waitcnt lgkmcnt(14)
    v_pk_mul_f32 v[68:69], v[68:69], v[110:111] op_sel_hi:[1,0]
    v_pk_mul_f32 v[70:71], v[70:71], v[110:111] op_sel_hi:[1,0]
    v_pk_fma_f32 v[196:197], v[196:197], v[108:109], v[68:69] op_sel_hi:[1,0,1]
    v_pk_fma_f32 v[198:199], v[198:199], v[108:109], v[70:71] op_sel_hi:[1,0,1]
    s_waitcnt lgkmcnt(13)
    v_pk_mul_f32 v[72:73], v[72:73], v[106:107] op_sel_hi:[1,0]
    v_pk_mul_f32 v[74:75], v[74:75], v[106:107] op_sel_hi:[1,0]
    v_pk_fma_f32 v[200:201], v[200:201], v[104:105], v[72:73] op_sel_hi:[1,0,1]
    v_pk_fma_f32 v[202:203], v[202:203], v[104:105], v[74:75] op_sel_hi:[1,0,1]
    s_waitcnt lgkmcnt(12)
    v_pk_mul_f32 v[76:77], v[76:77], v[110:111] op_sel_hi:[1,0]
    v_pk_mul_f32 v[78:79], v[78:79], v[110:111] op_sel_hi:[1,0]
    v_pk_fma_f32 v[204:205], v[204:205], v[108:109], v[76:77] op_sel_hi:[1,0,1]
    v_pk_fma_f32 v[206:207], v[206:207], v[108:109], v[78:79] op_sel_hi:[1,0,1]
    s_waitcnt lgkmcnt(11)
    v_pk_mul_f32 v[80:81], v[80:81], v[106:107] op_sel_hi:[1,0]
    v_pk_mul_f32 v[82:83], v[82:83], v[106:107] op_sel_hi:[1,0]
    v_pk_fma_f32 v[208:209], v[208:209], v[104:105], v[80:81] op_sel_hi:[1,0,1]
    v_pk_fma_f32 v[210:211], v[210:211], v[104:105], v[82:83] op_sel_hi:[1,0,1]
    s_waitcnt lgkmcnt(10)
    v_pk_mul_f32 v[84:85], v[84:85], v[110:111] op_sel_hi:[1,0]
    v_pk_mul_f32 v[86:87], v[86:87], v[110:111] op_sel_hi:[1,0]
    v_pk_fma_f32 v[212:213], v[212:213], v[108:109], v[84:85] op_sel_hi:[1,0,1]
    v_pk_fma_f32 v[214:215], v[214:215], v[108:109], v[86:87] op_sel_hi:[1,0,1]
    s_waitcnt lgkmcnt(9)
    v_pk_mul_f32 v[88:89], v[88:89], v[106:107] op_sel_hi:[1,0]
    v_pk_mul_f32 v[90:91], v[90:91], v[106:107] op_sel_hi:[1,0]
    v_pk_fma_f32 v[216:217], v[216:217], v[104:105], v[88:89] op_sel_hi:[1,0,1]
    v_pk_fma_f32 v[218:219], v[218:219], v[104:105], v[90:91] op_sel_hi:[1,0,1]
    s_waitcnt lgkmcnt(8)
    v_pk_mul_f32 v[92:93], v[92:93], v[110:111] op_sel_hi:[1,0]
    v_pk_mul_f32 v[94:95], v[94:95], v[110:111] op_sel_hi:[1,0]
    v_pk_fma_f32 v[220:221], v[220:221], v[108:109], v[92:93] op_sel_hi:[1,0,1]
    v_pk_fma_f32 v[222:223], v[222:223], v[108:109], v[94:95] op_sel_hi:[1,0,1]
    v_cvt_pk_bf16_f32 v192, v192, v193
    v_cvt_pk_bf16_f32 v193, v194, v195
    v_cvt_pk_bf16_f32 v194, v200, v201
    v_cvt_pk_bf16_f32 v195, v202, v203
    v_cvt_pk_bf16_f32 v196, v196, v197
    v_cvt_pk_bf16_f32 v197, v198, v199
    v_cvt_pk_bf16_f32 v198, v204, v205
    v_cvt_pk_bf16_f32 v199, v206, v207
    v_cvt_pk_bf16_f32 v208, v208, v209
    v_cvt_pk_bf16_f32 v209, v210, v211
    v_cvt_pk_bf16_f32 v210, v216, v217
    v_cvt_pk_bf16_f32 v211, v218, v219
    v_cvt_pk_bf16_f32 v212, v212, v213
    v_cvt_pk_bf16_f32 v213, v214, v215
    v_cvt_pk_bf16_f32 v214, v220, v221
    v_cvt_pk_bf16_f32 v215, v222, v223
    s_waitcnt lgkmcnt(7)
    v_pk_mul_f32 v[16:17], v[16:17], v[106:107] op_sel_hi:[1,0]
    v_pk_mul_f32 v[18:19], v[18:19], v[106:107] op_sel_hi:[1,0]
    v_pk_fma_f32 v[224:225], v[224:225], v[104:105], v[16:17] op_sel_hi:[1,0,1]
    v_pk_fma_f32 v[226:227], v[226:227], v[104:105], v[18:19] op_sel_hi:[1,0,1]
    s_waitcnt lgkmcnt(6)
    v_pk_mul_f32 v[20:21], v[20:21], v[110:111] op_sel_hi:[1,0]
    v_pk_mul_f32 v[22:23], v[22:23], v[110:111] op_sel_hi:[1,0]
    v_pk_fma_f32 v[228:229], v[228:229], v[108:109], v[20:21] op_sel_hi:[1,0,1]
    v_pk_fma_f32 v[230:231], v[230:231], v[108:109], v[22:23] op_sel_hi:[1,0,1]
    s_waitcnt lgkmcnt(5)
    v_pk_mul_f32 v[24:25], v[24:25], v[106:107] op_sel_hi:[1,0]
    v_pk_mul_f32 v[26:27], v[26:27], v[106:107] op_sel_hi:[1,0]
    v_pk_fma_f32 v[232:233], v[232:233], v[104:105], v[24:25] op_sel_hi:[1,0,1]
    v_pk_fma_f32 v[234:235], v[234:235], v[104:105], v[26:27] op_sel_hi:[1,0,1]
    s_waitcnt lgkmcnt(4)
    v_pk_mul_f32 v[28:29], v[28:29], v[110:111] op_sel_hi:[1,0]
    v_pk_mul_f32 v[30:31], v[30:31], v[110:111] op_sel_hi:[1,0]
    v_pk_fma_f32 v[236:237], v[236:237], v[108:109], v[28:29] op_sel_hi:[1,0,1]
    v_pk_fma_f32 v[238:239], v[238:239], v[108:109], v[30:31] op_sel_hi:[1,0,1]
    s_waitcnt lgkmcnt(3)
    v_pk_mul_f32 v[32:33], v[32:33], v[106:107] op_sel_hi:[1,0]
    v_pk_mul_f32 v[34:35], v[34:35], v[106:107] op_sel_hi:[1,0]
    v_pk_fma_f32 v[240:241], v[240:241], v[104:105], v[32:33] op_sel_hi:[1,0,1]
    v_pk_fma_f32 v[242:243], v[242:243], v[104:105], v[34:35] op_sel_hi:[1,0,1]
    s_waitcnt lgkmcnt(2)
    v_pk_mul_f32 v[36:37], v[36:37], v[110:111] op_sel_hi:[1,0]
    v_pk_mul_f32 v[38:39], v[38:39], v[110:111] op_sel_hi:[1,0]
    v_pk_fma_f32 v[244:245], v[244:245], v[108:109], v[36:37] op_sel_hi:[1,0,1]
    v_pk_fma_f32 v[246:247], v[246:247], v[108:109], v[38:39] op_sel_hi:[1,0,1]
    s_waitcnt lgkmcnt(1)
    v_pk_mul_f32 v[40:41], v[40:41], v[106:107] op_sel_hi:[1,0]
    v_pk_mul_f32 v[42:43], v[42:43], v[106:107] op_sel_hi:[1,0]
    v_pk_fma_f32 v[248:249], v[248:249], v[104:105], v[40:41] op_sel_hi:[1,0,1]
    v_pk_fma_f32 v[250:251], v[250:251], v[104:105], v[42:43] op_sel_hi:[1,0,1]
    s_waitcnt lgkmcnt(0)
    v_pk_mul_f32 v[44:45], v[44:45], v[110:111] op_sel_hi:[1,0]
    v_pk_mul_f32 v[46:47], v[46:47], v[110:111] op_sel_hi:[1,0]
    v_pk_fma_f32 v[252:253], v[252:253], v[108:109], v[44:45] op_sel_hi:[1,0,1]
    v_pk_fma_f32 v[254:255], v[254:255], v[108:109], v[46:47] op_sel_hi:[1,0,1]
    v_cvt_pk_bf16_f32 v224, v224, v225
    v_cvt_pk_bf16_f32 v225, v226, v227
    v_cvt_pk_bf16_f32 v226, v232, v233
    v_cvt_pk_bf16_f32 v227, v234, v235
    v_cvt_pk_bf16_f32 v228, v228, v229
    v_cvt_pk_bf16_f32 v229, v230, v231
    v_cvt_pk_bf16_f32 v230, v236, v237
    v_cvt_pk_bf16_f32 v231, v238, v239
    v_cvt_pk_bf16_f32 v240, v240, v241
    v_cvt_pk_bf16_f32 v241, v242, v243
    v_cvt_pk_bf16_f32 v242, v248, v249
    v_cvt_pk_bf16_f32 v243, v250, v251
    v_cvt_pk_bf16_f32 v244, v244, v245
    v_cvt_pk_bf16_f32 v245, v246, v247
    v_cvt_pk_bf16_f32 v246, v252, v253
    v_cvt_pk_bf16_f32 v247, v254, v255
    s_waitcnt lgkmcnt(0)
    s_barrier
    v_lshlrev_b32 v8, 4, v1
    s_lshl_b32 s53, s49, 15
    s_lshl_b32 s54, s50, 11
    s_add_u32 s53, s53, s54
    s_add_u32 s53, s53, 67584
    v_add_u32 v9, s53, v8
    ds_write_b128 v9, v[128:131] offset:0
    ds_write_b128 v9, v[132:135] offset:1024
    ds_write_b128 v9, v[144:147] offset:4096
    ds_write_b128 v9, v[148:151] offset:5120
    ds_write_b128 v9, v[160:163] offset:8192
    ds_write_b128 v9, v[164:167] offset:9216
    ds_write_b128 v9, v[176:179] offset:12288
    ds_write_b128 v9, v[180:183] offset:13312
    ds_write_b128 v9, v[192:195] offset:16384
    ds_write_b128 v9, v[196:199] offset:17408
    ds_write_b128 v9, v[208:211] offset:20480
    ds_write_b128 v9, v[212:215] offset:21504
    ds_write_b128 v9, v[224:227] offset:24576
    ds_write_b128 v9, v[228:231] offset:25600
    ds_write_b128 v9, v[240:243] offset:28672
    ds_write_b128 v9, v[244:247] offset:29696
    v_add_u32 v9, 67584, v8
    s_waitcnt lgkmcnt(0)
    s_barrier
    ds_read_b128 a[0:3], v9 offset:0
    ds_read_b128 a[4:7], v9 offset:1024
    ds_read_b128 a[8:11], v9 offset:2048
    ds_read_b128 a[12:15], v9 offset:3072
    ds_read_b128 a[16:19], v9 offset:4096
    ds_read_b128 a[20:23], v9 offset:5120
    ds_read_b128 a[24:27], v9 offset:6144
    ds_read_b128 a[28:31], v9 offset:7168
    ds_read_b128 a[32:35], v9 offset:8192
    ds_read_b128 a[36:39], v9 offset:9216
    ds_read_b128 a[40:43], v9 offset:10240
    ds_read_b128 a[44:47], v9 offset:11264
    ds_read_b128 a[48:51], v9 offset:12288
    ds_read_b128 a[52:55], v9 offset:13312
    ds_read_b128 a[56:59], v9 offset:14336
    ds_read_b128 a[60:63], v9 offset:15360
    ds_read_b128 a[64:67], v9 offset:16384
    ds_read_b128 a[68:71], v9 offset:17408
    ds_read_b128 a[72:75], v9 offset:18432
    ds_read_b128 a[76:79], v9 offset:19456
    ds_read_b128 a[80:83], v9 offset:20480
    ds_read_b128 a[84:87], v9 offset:21504
    ds_read_b128 a[88:91], v9 offset:22528
    ds_read_b128 a[92:95], v9 offset:23552
    ds_read_b128 a[96:99], v9 offset:24576
    ds_read_b128 a[100:103], v9 offset:25600
    ds_read_b128 a[104:107], v9 offset:26624
    ds_read_b128 a[108:111], v9 offset:27648
    ds_read_b128 a[112:115], v9 offset:28672
    ds_read_b128 a[116:119], v9 offset:29696
    ds_read_b128 a[120:123], v9 offset:30720
    ds_read_b128 a[124:127], v9 offset:31744
    s_waitcnt lgkmcnt(0)
    s_waitcnt vmcnt(8)
    s_barrier
    v_and_b32 v13, 1, v3
    v_lshl_add_u32 v13, v13, 2, v4
    v_lshrrev_b32 v10, 1, v13
    v_xor_b32 v10, s48, v10
    v_lshlrev_b32 v10, 5, v10
    v_lshl_add_u32 v10, v13, 7, v10
    v_lshl_add_u32 v10, v5, 3, v10
    v_lshrrev_b32 v13, 1, v3
    v_lshl_add_u32 v10, v13, 10, v10
    v_add_u32 v11, 67584, v10
    s_lshl_b32 s53, s48, 11
    v_add_u32 v12, s53, v8
    ds_read_b64_tr_b16 v[32:33], v10 offset:0
    ds_read_b64_tr_b16 v[34:35], v10 offset:2048
    ds_read_b64_tr_b16 v[36:37], v10 offset:4096
    ds_read_b64_tr_b16 v[38:39], v10 offset:6144
    ds_read_b64_tr_b16 v[40:41], v10 offset:8192
    ds_read_b64_tr_b16 v[42:43], v10 offset:10240
    ds_read_b64_tr_b16 v[44:45], v10 offset:12288
    ds_read_b64_tr_b16 v[46:47], v10 offset:14336
    s_waitcnt lgkmcnt(6)
    v_mfma_f32_16x16x32_bf16 v[48:51], v[32:35], a[0:3], 0
    ds_read_b128 a[128:131], v9 offset:32768
    ds_read_b128 a[132:135], v9 offset:33792
    v_mfma_f32_16x16x32_bf16 v[52:55], v[32:35], a[4:7], 0
    ds_read_b128 a[136:139], v9 offset:34816
    ds_read_b128 a[140:143], v9 offset:35840
    s_add_u32 m0, s56, 67584
    s_add_u32 s55, s68, 128
    buffer_load_dwordx4 v14, s[32:35], s55 offen lds
    v_mfma_f32_16x16x32_bf16 v[56:59], v[32:35], a[8:11], 0
    ds_read_b128 a[144:147], v9 offset:36864
    v_mfma_f32_16x16x32_bf16 v[60:63], v[32:35], a[12:15], 0
    ds_read_b64_tr_b16 v[32:33], v10 offset:16384
    ds_read_b64_tr_b16 v[34:35], v10 offset:18432
    ds_read_b128 a[148:151], v9 offset:37888
    ds_read_b128 a[152:155], v9 offset:38912
    s_waitcnt lgkmcnt(13)
    v_mfma_f32_16x16x32_bf16 v[48:51], v[36:39], a[16:19], v[48:51]
    ds_read_b128 a[156:159], v9 offset:39936
    v_mfma_f32_16x16x32_bf16 v[52:55], v[36:39], a[20:23], v[52:55]
    ds_read_b128 a[160:163], v9 offset:40960
    ds_read_b128 a[164:167], v9 offset:41984
    s_add_u32 m0, s56, 68608
    s_add_u32 s55, s68, 7296
    buffer_load_dwordx4 v14, s[32:35], s55 offen lds
    v_mfma_f32_16x16x32_bf16 v[56:59], v[36:39], a[24:27], v[56:59]
    ds_read_b128 a[168:171], v9 offset:43008
    ds_read_b128 a[172:175], v9 offset:44032
    v_mfma_f32_16x16x32_bf16 v[60:63], v[36:39], a[28:31], v[60:63]
    ds_read_b64_tr_b16 v[36:37], v10 offset:20480
    ds_read_b64_tr_b16 v[38:39], v10 offset:22528
    ds_read_b128 a[176:179], v9 offset:45056
    s_waitcnt lgkmcnt(15)
    v_mfma_f32_16x16x32_bf16 v[48:51], v[40:43], a[32:35], v[48:51]
    ds_read_b128 a[180:183], v9 offset:46080
    ds_read_b128 a[184:187], v9 offset:47104
    v_mfma_f32_16x16x32_bf16 v[52:55], v[40:43], a[36:39], v[52:55]
    ds_read_b128 a[188:191], v9 offset:48128
    s_add_u32 m0, s56, 69632
    s_add_u32 s55, s68, 14464
    buffer_load_dwordx4 v14, s[32:35], s55 offen lds
    v_mfma_f32_16x16x32_bf16 v[56:59], v[40:43], a[40:43], v[56:59]
    ds_read_b128 a[192:195], v9 offset:49152
    ds_read_b128 a[196:199], v9 offset:50176
    v_mfma_f32_16x16x32_bf16 v[60:63], v[40:43], a[44:47], v[60:63]
    ds_read_b64_tr_b16 v[40:41], v10 offset:24576
    ds_read_b64_tr_b16 v[42:43], v10 offset:26624
    ds_read_b128 a[200:203], v9 offset:51200
    ds_read_b128 a[204:207], v9 offset:52224
    v_mfma_f32_16x16x32_bf16 v[48:51], v[44:47], a[48:51], v[48:51]
    ds_read_b128 a[208:211], v9 offset:53248
    v_mfma_f32_16x16x32_bf16 v[52:55], v[44:47], a[52:55], v[52:55]
    ds_read_b128 a[212:215], v9 offset:54272
    ds_read_b128 a[216:219], v9 offset:55296
    s_add_u32 m0, s56, 70656
    s_add_u32 s55, s68, 21632
    buffer_load_dwordx4 v14, s[32:35], s55 offen lds
    v_mfma_f32_16x16x32_bf16 v[56:59], v[44:47], a[56:59], v[56:59]
    ds_read_b128 a[220:223], v9 offset:56320
    v_mfma_f32_16x16x32_bf16 v[60:63], v[44:47], a[60:63], v[60:63]
    ds_read_b64_tr_b16 v[44:45], v10 offset:28672
    ds_read_b64_tr_b16 v[46:47], v10 offset:30720
    ds_read_b128 a[224:227], v9 offset:57344
    ds_read_b128 a[228:231], v9 offset:58368
    s_waitcnt lgkmcnt(15)
    v_mfma_f32_16x16x32_bf16 v[48:51], v[32:35], a[64:67], v[48:51]
    ds_read_b128 a[232:235], v9 offset:59392
    ds_read_b128 a[236:239], v9 offset:60416
    v_mfma_f32_16x16x32_bf16 v[52:55], v[32:35], a[68:71], v[52:55]
    ds_read_b128 a[240:243], v9 offset:61440
    s_add_u32 m0, s56, 71680
    s_add_u32 s55, s68, 28800
    buffer_load_dwordx4 v14, s[32:35], s55 offen lds
    v_mfma_f32_16x16x32_bf16 v[56:59], v[32:35], a[72:75], v[56:59]
    ds_read_b128 a[244:247], v9 offset:62464
    ds_read_b128 a[248:251], v9 offset:63488
    v_mfma_f32_16x16x32_bf16 v[60:63], v[32:35], a[76:79], v[60:63]
    ds_read_b128 a[252:255], v9 offset:64512
    v_mfma_f32_16x16x32_bf16 v[48:51], v[36:39], a[80:83], v[48:51]
    v_mfma_f32_16x16x32_bf16 v[52:55], v[36:39], a[84:87], v[52:55]
    s_add_u32 m0, s56, 72704
    s_add_u32 s55, s68, 35968
    buffer_load_dwordx4 v14, s[32:35], s55 offen lds
    v_mfma_f32_16x16x32_bf16 v[56:59], v[36:39], a[88:91], v[56:59]
    v_mfma_f32_16x16x32_bf16 v[60:63], v[36:39], a[92:95], v[60:63]
    s_waitcnt lgkmcnt(0)
    s_waitcnt vmcnt(6)
    s_barrier
    ds_read_b64_tr_b16 v[32:33], v10 offset:32768
    ds_read_b64_tr_b16 v[34:35], v10 offset:34816
    ds_read_b64_tr_b16 v[36:37], v10 offset:36864
    ds_read_b64_tr_b16 v[38:39], v10 offset:38912
    v_mfma_f32_16x16x32_bf16 v[48:51], v[40:43], a[96:99], v[48:51]
    v_mfma_f32_16x16x32_bf16 v[52:55], v[40:43], a[100:103], v[52:55]
    s_add_u32 m0, s56, 73728
    s_add_u32 s55, s68, 43136
    buffer_load_dwordx4 v14, s[32:35], s55 offen lds
    v_mfma_f32_16x16x32_bf16 v[56:59], v[40:43], a[104:107], v[56:59]
    v_mfma_f32_16x16x32_bf16 v[60:63], v[40:43], a[108:111], v[60:63]
    ds_read_b64_tr_b16 v[40:41], v10 offset:40960
    ds_read_b64_tr_b16 v[42:43], v10 offset:43008
    v_mfma_f32_16x16x32_bf16 v[48:51], v[44:47], a[112:115], v[48:51]
    v_mfma_f32_16x16x32_bf16 v[52:55], v[44:47], a[116:119], v[52:55]
    s_add_u32 m0, s56, 74752
    s_add_u32 s55, s68, 50304
    buffer_load_dwordx4 v14, s[32:35], s55 offen lds
    v_mfma_f32_16x16x32_bf16 v[56:59], v[44:47], a[120:123], v[56:59]
    v_mfma_f32_16x16x32_bf16 v[60:63], v[44:47], a[124:127], v[60:63]
    ds_read_b64_tr_b16 v[44:45], v10 offset:45056
    ds_read_b64_tr_b16 v[46:47], v10 offset:47104
    s_waitcnt lgkmcnt(6)
    v_mfma_f32_16x16x32_bf16 v[48:51], v[32:35], a[128:131], v[48:51]
    v_mfma_f32_16x16x32_bf16 v[52:55], v[32:35], a[132:135], v[52:55]
    s_add_u32 m0, s56, 100352
    s_add_u32 s55, s68, 229504
    buffer_load_dwordx4 v14, s[32:35], s55 offen lds
    v_mfma_f32_16x16x32_bf16 v[56:59], v[32:35], a[136:139], v[56:59]
    v_mfma_f32_16x16x32_bf16 v[60:63], v[32:35], a[140:143], v[60:63]
    ds_read_b64_tr_b16 v[32:33], v10 offset:49152
    ds_read_b64_tr_b16 v[34:35], v10 offset:51200
    s_waitcnt lgkmcnt(6)
    v_mfma_f32_16x16x32_bf16 v[48:51], v[36:39], a[144:147], v[48:51]
    v_mfma_f32_16x16x32_bf16 v[52:55], v[36:39], a[148:151], v[52:55]
    s_add_u32 m0, s56, 101376
    s_add_u32 s55, s68, 236672
    buffer_load_dwordx4 v14, s[32:35], s55 offen lds
    v_mfma_f32_16x16x32_bf16 v[56:59], v[36:39], a[152:155], v[56:59]
    v_mfma_f32_16x16x32_bf16 v[60:63], v[36:39], a[156:159], v[60:63]
    ds_read_b64_tr_b16 v[36:37], v10 offset:53248
    ds_read_b64_tr_b16 v[38:39], v10 offset:55296
    s_waitcnt lgkmcnt(6)
    v_mfma_f32_16x16x32_bf16 v[48:51], v[40:43], a[160:163], v[48:51]
    v_mfma_f32_16x16x32_bf16 v[52:55], v[40:43], a[164:167], v[52:55]
    s_add_u32 m0, s56, 102400
    s_add_u32 s55, s68, 243840
    buffer_load_dwordx4 v14, s[32:35], s55 offen lds
    v_mfma_f32_16x16x32_bf16 v[56:59], v[40:43], a[168:171], v[56:59]
    v_mfma_f32_16x16x32_bf16 v[60:63], v[40:43], a[172:175], v[60:63]
    ds_read_b64_tr_b16 v[40:41], v10 offset:57344
    ds_read_b64_tr_b16 v[42:43], v10 offset:59392
    s_waitcnt lgkmcnt(6)
    v_mfma_f32_16x16x32_bf16 v[48:51], v[44:47], a[176:179], v[48:51]
    v_mfma_f32_16x16x32_bf16 v[52:55], v[44:47], a[180:183], v[52:55]
    s_add_u32 m0, s56, 103424
    s_add_u32 s55, s68, 251008
    buffer_load_dwordx4 v14, s[32:35], s55 offen lds
    v_mfma_f32_16x16x32_bf16 v[56:59], v[44:47], a[184:187], v[56:59]
    v_mfma_f32_16x16x32_bf16 v[60:63], v[44:47], a[188:191], v[60:63]
    ds_read_b64_tr_b16 v[44:45], v10 offset:61440
    ds_read_b64_tr_b16 v[46:47], v10 offset:63488
    s_waitcnt lgkmcnt(6)
    v_mfma_f32_16x16x32_bf16 v[48:51], v[32:35], a[192:195], v[48:51]
    v_mfma_f32_16x16x32_bf16 v[52:55], v[32:35], a[196:199], v[52:55]
    s_add_u32 m0, s56, 104448
    s_add_u32 s55, s68, 258176
    buffer_load_dwordx4 v14, s[32:35], s55 offen lds
    v_mfma_f32_16x16x32_bf16 v[56:59], v[32:35], a[200:203], v[56:59]
    v_mfma_f32_16x16x32_bf16 v[60:63], v[32:35], a[204:207], v[60:63]
    s_waitcnt lgkmcnt(4)
    v_mfma_f32_16x16x32_bf16 v[48:51], v[36:39], a[208:211], v[48:51]
    v_mfma_f32_16x16x32_bf16 v[52:55], v[36:39], a[212:215], v[52:55]
    s_add_u32 m0, s56, 105472
    s_add_u32 s55, s68, 265344
    buffer_load_dwordx4 v14, s[32:35], s55 offen lds
    v_mfma_f32_16x16x32_bf16 v[56:59], v[36:39], a[216:219], v[56:59]
    v_mfma_f32_16x16x32_bf16 v[60:63], v[36:39], a[220:223], v[60:63]
    s_waitcnt lgkmcnt(0)
    s_waitcnt vmcnt(6)
    s_barrier
    ds_read_b64_tr_b16 v[32:33], v11 offset:0
    ds_read_b64_tr_b16 v[34:35], v11 offset:2048
    ds_read_b64_tr_b16 v[36:37], v11 offset:4096
    ds_read_b64_tr_b16 v[38:39], v11 offset:6144
    v_mfma_f32_16x16x32_bf16 v[48:51], v[40:43], a[224:227], v[48:51]
    v_mfma_f32_16x16x32_bf16 v[52:55], v[40:43], a[228:231], v[52:55]
    s_add_u32 m0, s56, 106496
    s_add_u32 s55, s68, 272512
    buffer_load_dwordx4 v14, s[32:35], s55 offen lds
    v_mfma_f32_16x16x32_bf16 v[56:59], v[40:43], a[232:235], v[56:59]
    v_mfma_f32_16x16x32_bf16 v[60:63], v[40:43], a[236:239], v[60:63]
    ds_read_b64_tr_b16 v[40:41], v11 offset:8192
    ds_read_b64_tr_b16 v[42:43], v11 offset:10240
    v_mfma_f32_16x16x32_bf16 v[48:51], v[44:47], a[240:243], v[48:51]
    v_mfma_f32_16x16x32_bf16 v[52:55], v[44:47], a[244:247], v[52:55]
    s_add_u32 m0, s56, 107520
    s_add_u32 s55, s68, 279680
    buffer_load_dwordx4 v14, s[32:35], s55 offen lds
    v_mfma_f32_16x16x32_bf16 v[56:59], v[44:47], a[248:251], v[56:59]
    v_mfma_f32_16x16x32_bf16 v[60:63], v[44:47], a[252:255], v[60:63]
    ds_read_b64_tr_b16 v[44:45], v11 offset:12288
    ds_read_b64_tr_b16 v[46:47], v11 offset:14336
    s_waitcnt lgkmcnt(6)
    v_mfma_f32_16x16x32_bf16 v[64:67], v[32:35], a[0:3], 0
    v_mfma_f32_16x16x32_bf16 v[68:71], v[32:35], a[4:7], 0
    s_add_u32 m0, s56, 0
    s_add_u32 s55, s68, 256
    buffer_load_dwordx4 v14, s[32:35], s55 offen lds
    v_mfma_f32_16x16x32_bf16 v[72:75], v[32:35], a[8:11], 0
    v_mfma_f32_16x16x32_bf16 v[76:79], v[32:35], a[12:15], 0
    ds_read_b64_tr_b16 v[32:33], v11 offset:16384
    ds_read_b64_tr_b16 v[34:35], v11 offset:18432
    s_waitcnt lgkmcnt(6)
    v_mfma_f32_16x16x32_bf16 v[64:67], v[36:39], a[16:19], v[64:67]
    v_mfma_f32_16x16x32_bf16 v[68:71], v[36:39], a[20:23], v[68:71]
    s_add_u32 m0, s56, 1024
    s_add_u32 s55, s68, 7424
    buffer_load_dwordx4 v14, s[32:35], s55 offen lds
    v_mfma_f32_16x16x32_bf16 v[72:75], v[36:39], a[24:27], v[72:75]
    v_mfma_f32_16x16x32_bf16 v[76:79], v[36:39], a[28:31], v[76:79]
    ds_read_b64_tr_b16 v[36:37], v11 offset:20480
    ds_read_b64_tr_b16 v[38:39], v11 offset:22528
    s_waitcnt lgkmcnt(6)
    v_mfma_f32_16x16x32_bf16 v[64:67], v[40:43], a[32:35], v[64:67]
    s_mov_b32 s54, 0
    v_mfma_f32_16x16x32_bf16 v[68:71], v[40:43], a[36:39], v[68:71]
    v_cvt_pk_bf16_f32 v80, v48, v49
    s_add_u32 m0, s56, 2048
    s_add_u32 s55, s68, 14592
    buffer_load_dwordx4 v14, s[32:35], s55 offen lds
    v_mfma_f32_16x16x32_bf16 v[72:75], v[40:43], a[40:43], v[72:75]
    v_cvt_pk_bf16_f32 v81, v50, v51
    v_mfma_f32_16x16x32_bf16 v[76:79], v[40:43], a[44:47], v[76:79]
    ds_read_b64_tr_b16 v[40:41], v11 offset:24576
    ds_read_b64_tr_b16 v[42:43], v11 offset:26624
    v_cvt_pk_bf16_f32 v82, v52, v53
    s_waitcnt lgkmcnt(6)
    v_mfma_f32_16x16x32_bf16 v[64:67], v[44:47], a[48:51], v[64:67]
    v_cvt_pk_bf16_f32 v83, v54, v55
    v_mfma_f32_16x16x32_bf16 v[68:71], v[44:47], a[52:55], v[68:71]
    buffer_store_dwordx4 v[80:83], v12, s[40:43], s54 offen offset:0 sc0 sc1
    s_add_u32 m0, s56, 3072
    s_add_u32 s55, s68, 21760
    buffer_load_dwordx4 v14, s[32:35], s55 offen lds
    v_mfma_f32_16x16x32_bf16 v[72:75], v[44:47], a[56:59], v[72:75]
    v_cvt_pk_bf16_f32 v84, v56, v57
    v_mfma_f32_16x16x32_bf16 v[76:79], v[44:47], a[60:63], v[76:79]
    ds_read_b64_tr_b16 v[44:45], v11 offset:28672
    ds_read_b64_tr_b16 v[46:47], v11 offset:30720
    v_cvt_pk_bf16_f32 v85, v58, v59
    s_waitcnt lgkmcnt(6)
    v_mfma_f32_16x16x32_bf16 v[64:67], v[32:35], a[64:67], v[64:67]
    v_cvt_pk_bf16_f32 v86, v60, v61
    v_mfma_f32_16x16x32_bf16 v[68:71], v[32:35], a[68:71], v[68:71]
    v_cvt_pk_bf16_f32 v87, v62, v63
    s_add_u32 m0, s56, 4096
    s_add_u32 s55, s68, 28928
    buffer_load_dwordx4 v14, s[32:35], s55 offen lds
    v_mfma_f32_16x16x32_bf16 v[72:75], v[32:35], a[72:75], v[72:75]
    buffer_store_dwordx4 v[84:87], v12, s[40:43], s54 offen offset:1024 sc0 sc1
    v_mfma_f32_16x16x32_bf16 v[76:79], v[32:35], a[76:79], v[76:79]
    s_waitcnt lgkmcnt(4)
    v_mfma_f32_16x16x32_bf16 v[64:67], v[36:39], a[80:83], v[64:67]
    v_mfma_f32_16x16x32_bf16 v[68:71], v[36:39], a[84:87], v[68:71]
    s_add_u32 m0, s56, 5120
    s_add_u32 s55, s68, 36096
    buffer_load_dwordx4 v14, s[32:35], s55 offen lds
    v_mfma_f32_16x16x32_bf16 v[72:75], v[36:39], a[88:91], v[72:75]
    v_mfma_f32_16x16x32_bf16 v[76:79], v[36:39], a[92:95], v[76:79]
    s_waitcnt lgkmcnt(0)
    s_waitcnt vmcnt(8)
    s_barrier
    ds_read_b64_tr_b16 v[32:33], v11 offset:32768
    ds_read_b64_tr_b16 v[34:35], v11 offset:34816
    ds_read_b64_tr_b16 v[36:37], v11 offset:36864
    ds_read_b64_tr_b16 v[38:39], v11 offset:38912
    v_mfma_f32_16x16x32_bf16 v[64:67], v[40:43], a[96:99], v[64:67]
    v_mfma_f32_16x16x32_bf16 v[68:71], v[40:43], a[100:103], v[68:71]
    s_add_u32 m0, s56, 6144
    s_add_u32 s55, s68, 43264
    buffer_load_dwordx4 v14, s[32:35], s55 offen lds
    v_mfma_f32_16x16x32_bf16 v[72:75], v[40:43], a[104:107], v[72:75]
    v_mfma_f32_16x16x32_bf16 v[76:79], v[40:43], a[108:111], v[76:79]
    ds_read_b64_tr_b16 v[40:41], v11 offset:40960
    ds_read_b64_tr_b16 v[42:43], v11 offset:43008
    v_mfma_f32_16x16x32_bf16 v[64:67], v[44:47], a[112:115], v[64:67]
    v_mfma_f32_16x16x32_bf16 v[68:71], v[44:47], a[116:119], v[68:71]
    s_add_u32 m0, s56, 7168
    s_add_u32 s55, s68, 50432
    buffer_load_dwordx4 v14, s[32:35], s55 offen lds
    v_mfma_f32_16x16x32_bf16 v[72:75], v[44:47], a[120:123], v[72:75]
    v_mfma_f32_16x16x32_bf16 v[76:79], v[44:47], a[124:127], v[76:79]
    ds_read_b64_tr_b16 v[44:45], v11 offset:45056
    ds_read_b64_tr_b16 v[46:47], v11 offset:47104
    s_waitcnt lgkmcnt(6)
    v_mfma_f32_16x16x32_bf16 v[64:67], v[32:35], a[128:131], v[64:67]
    v_mfma_f32_16x16x32_bf16 v[68:71], v[32:35], a[132:135], v[68:71]
    s_add_u32 m0, s56, 32768
    s_add_u32 s55, s68, 229632
    buffer_load_dwordx4 v14, s[32:35], s55 offen lds
    v_mfma_f32_16x16x32_bf16 v[72:75], v[32:35], a[136:139], v[72:75]
    v_mfma_f32_16x16x32_bf16 v[76:79], v[32:35], a[140:143], v[76:79]
    ds_read_b64_tr_b16 v[32:33], v11 offset:49152
    ds_read_b64_tr_b16 v[34:35], v11 offset:51200
    s_waitcnt lgkmcnt(6)
    v_mfma_f32_16x16x32_bf16 v[64:67], v[36:39], a[144:147], v[64:67]
    v_mfma_f32_16x16x32_bf16 v[68:71], v[36:39], a[148:151], v[68:71]
    s_add_u32 m0, s56, 33792
    s_add_u32 s55, s68, 236800
    buffer_load_dwordx4 v14, s[32:35], s55 offen lds
    v_mfma_f32_16x16x32_bf16 v[72:75], v[36:39], a[152:155], v[72:75]
    v_mfma_f32_16x16x32_bf16 v[76:79], v[36:39], a[156:159], v[76:79]
    ds_read_b64_tr_b16 v[36:37], v11 offset:53248
    ds_read_b64_tr_b16 v[38:39], v11 offset:55296
    s_waitcnt lgkmcnt(6)
    v_mfma_f32_16x16x32_bf16 v[64:67], v[40:43], a[160:163], v[64:67]
    v_mfma_f32_16x16x32_bf16 v[68:71], v[40:43], a[164:167], v[68:71]
    s_add_u32 m0, s56, 34816
    s_add_u32 s55, s68, 243968
    buffer_load_dwordx4 v14, s[32:35], s55 offen lds
    v_mfma_f32_16x16x32_bf16 v[72:75], v[40:43], a[168:171], v[72:75]
    v_mfma_f32_16x16x32_bf16 v[76:79], v[40:43], a[172:175], v[76:79]
    ds_read_b64_tr_b16 v[40:41], v11 offset:57344
    ds_read_b64_tr_b16 v[42:43], v11 offset:59392
    s_waitcnt lgkmcnt(6)
    v_mfma_f32_16x16x32_bf16 v[64:67], v[44:47], a[176:179], v[64:67]
    v_mfma_f32_16x16x32_bf16 v[68:71], v[44:47], a[180:183], v[68:71]
    s_add_u32 m0, s56, 35840
    s_add_u32 s55, s68, 251136
    buffer_load_dwordx4 v14, s[32:35], s55 offen lds
    v_mfma_f32_16x16x32_bf16 v[72:75], v[44:47], a[184:187], v[72:75]
    v_mfma_f32_16x16x32_bf16 v[76:79], v[44:47], a[188:191], v[76:79]
    ds_read_b64_tr_b16 v[44:45], v11 offset:61440
    ds_read_b64_tr_b16 v[46:47], v11 offset:63488
    s_waitcnt lgkmcnt(6)
    v_mfma_f32_16x16x32_bf16 v[64:67], v[32:35], a[192:195], v[64:67]
    v_mfma_f32_16x16x32_bf16 v[68:71], v[32:35], a[196:199], v[68:71]
    s_add_u32 m0, s56, 36864
    s_add_u32 s55, s68, 258304
    buffer_load_dwordx4 v14, s[32:35], s55 offen lds
    v_mfma_f32_16x16x32_bf16 v[72:75], v[32:35], a[200:203], v[72:75]
    v_mfma_f32_16x16x32_bf16 v[76:79], v[32:35], a[204:207], v[76:79]
    s_waitcnt lgkmcnt(4)
    v_mfma_f32_16x16x32_bf16 v[64:67], v[36:39], a[208:211], v[64:67]
    v_mfma_f32_16x16x32_bf16 v[68:71], v[36:39], a[212:215], v[68:71]
    s_add_u32 m0, s56, 37888
    s_add_u32 s55, s68, 265472
    buffer_load_dwordx4 v14, s[32:35], s55 offen lds
    v_mfma_f32_16x16x32_bf16 v[72:75], v[36:39], a[216:219], v[72:75]
    v_mfma_f32_16x16x32_bf16 v[76:79], v[36:39], a[220:223], v[76:79]
    s_waitcnt lgkmcnt(0)
    s_waitcnt vmcnt(6)
    s_barrier
    ds_read_b64_tr_b16 v[32:33], v10 offset:0
    ds_read_b64_tr_b16 v[34:35], v10 offset:2048
    ds_read_b64_tr_b16 v[36:37], v10 offset:4096
    ds_read_b64_tr_b16 v[38:39], v10 offset:6144
    v_mfma_f32_16x16x32_bf16 v[64:67], v[40:43], a[224:227], v[64:67]
    v_mfma_f32_16x16x32_bf16 v[68:71], v[40:43], a[228:231], v[68:71]
    s_add_u32 m0, s56, 38912
    s_add_u32 s55, s68, 272640
    buffer_load_dwordx4 v14, s[32:35], s55 offen lds
    v_mfma_f32_16x16x32_bf16 v[72:75], v[40:43], a[232:235], v[72:75]
    v_mfma_f32_16x16x32_bf16 v[76:79], v[40:43], a[236:239], v[76:79]
    ds_read_b64_tr_b16 v[40:41], v10 offset:8192
    ds_read_b64_tr_b16 v[42:43], v10 offset:10240
    v_mfma_f32_16x16x32_bf16 v[64:67], v[44:47], a[240:243], v[64:67]
    v_mfma_f32_16x16x32_bf16 v[68:71], v[44:47], a[244:247], v[68:71]
    s_add_u32 m0, s56, 39936
    s_add_u32 s55, s68, 279808
    buffer_load_dwordx4 v14, s[32:35], s55 offen lds
    v_mfma_f32_16x16x32_bf16 v[72:75], v[44:47], a[248:251], v[72:75]
    v_mfma_f32_16x16x32_bf16 v[76:79], v[44:47], a[252:255], v[76:79]
    ds_read_b64_tr_b16 v[44:45], v10 offset:12288
    ds_read_b64_tr_b16 v[46:47], v10 offset:14336
    s_waitcnt lgkmcnt(6)
    v_mfma_f32_16x16x32_bf16 v[48:51], v[32:35], a[0:3], 0
    v_mfma_f32_16x16x32_bf16 v[52:55], v[32:35], a[4:7], 0
    s_add_u32 m0, s56, 67584
    s_add_u32 s55, s68, 384
    buffer_load_dwordx4 v14, s[32:35], s55 offen lds
    v_mfma_f32_16x16x32_bf16 v[56:59], v[32:35], a[8:11], 0
    v_mfma_f32_16x16x32_bf16 v[60:63], v[32:35], a[12:15], 0
    ds_read_b64_tr_b16 v[32:33], v10 offset:16384
    ds_read_b64_tr_b16 v[34:35], v10 offset:18432
    s_waitcnt lgkmcnt(6)
    v_mfma_f32_16x16x32_bf16 v[48:51], v[36:39], a[16:19], v[48:51]
    v_mfma_f32_16x16x32_bf16 v[52:55], v[36:39], a[20:23], v[52:55]
    s_add_u32 m0, s56, 68608
    s_add_u32 s55, s68, 7552
    buffer_load_dwordx4 v14, s[32:35], s55 offen lds
    v_mfma_f32_16x16x32_bf16 v[56:59], v[36:39], a[24:27], v[56:59]
    v_mfma_f32_16x16x32_bf16 v[60:63], v[36:39], a[28:31], v[60:63]
    ds_read_b64_tr_b16 v[36:37], v10 offset:20480
    ds_read_b64_tr_b16 v[38:39], v10 offset:22528
    s_waitcnt lgkmcnt(6)
    v_mfma_f32_16x16x32_bf16 v[48:51], v[40:43], a[32:35], v[48:51]
    s_mov_b32 s54, 8192
    v_mfma_f32_16x16x32_bf16 v[52:55], v[40:43], a[36:39], v[52:55]
    v_cvt_pk_bf16_f32 v80, v64, v65
    s_add_u32 m0, s56, 69632
    s_add_u32 s55, s68, 14720
    buffer_load_dwordx4 v14, s[32:35], s55 offen lds
    v_mfma_f32_16x16x32_bf16 v[56:59], v[40:43], a[40:43], v[56:59]
    v_cvt_pk_bf16_f32 v81, v66, v67
    v_mfma_f32_16x16x32_bf16 v[60:63], v[40:43], a[44:47], v[60:63]
    ds_read_b64_tr_b16 v[40:41], v10 offset:24576
    ds_read_b64_tr_b16 v[42:43], v10 offset:26624
    v_cvt_pk_bf16_f32 v82, v68, v69
    s_waitcnt lgkmcnt(6)
    v_mfma_f32_16x16x32_bf16 v[48:51], v[44:47], a[48:51], v[48:51]
    v_cvt_pk_bf16_f32 v83, v70, v71
    v_mfma_f32_16x16x32_bf16 v[52:55], v[44:47], a[52:55], v[52:55]
    buffer_store_dwordx4 v[80:83], v12, s[40:43], s54 offen offset:0 sc0 sc1
    s_add_u32 m0, s56, 70656
    s_add_u32 s55, s68, 21888
    buffer_load_dwordx4 v14, s[32:35], s55 offen lds
    v_mfma_f32_16x16x32_bf16 v[56:59], v[44:47], a[56:59], v[56:59]
    v_cvt_pk_bf16_f32 v84, v72, v73
    v_mfma_f32_16x16x32_bf16 v[60:63], v[44:47], a[60:63], v[60:63]
    ds_read_b64_tr_b16 v[44:45], v10 offset:28672
    ds_read_b64_tr_b16 v[46:47], v10 offset:30720
    v_cvt_pk_bf16_f32 v85, v74, v75
    s_waitcnt lgkmcnt(6)
    v_mfma_f32_16x16x32_bf16 v[48:51], v[32:35], a[64:67], v[48:51]
    v_cvt_pk_bf16_f32 v86, v76, v77
    v_mfma_f32_16x16x32_bf16 v[52:55], v[32:35], a[68:71], v[52:55]
    v_cvt_pk_bf16_f32 v87, v78, v79
    s_add_u32 m0, s56, 71680
    s_add_u32 s55, s68, 29056
    buffer_load_dwordx4 v14, s[32:35], s55 offen lds
    v_mfma_f32_16x16x32_bf16 v[56:59], v[32:35], a[72:75], v[56:59]
    buffer_store_dwordx4 v[84:87], v12, s[40:43], s54 offen offset:1024 sc0 sc1
    v_mfma_f32_16x16x32_bf16 v[60:63], v[32:35], a[76:79], v[60:63]
    s_waitcnt lgkmcnt(4)
    v_mfma_f32_16x16x32_bf16 v[48:51], v[36:39], a[80:83], v[48:51]
    v_mfma_f32_16x16x32_bf16 v[52:55], v[36:39], a[84:87], v[52:55]
    s_add_u32 m0, s56, 72704
    s_add_u32 s55, s68, 36224
    buffer_load_dwordx4 v14, s[32:35], s55 offen lds
    v_mfma_f32_16x16x32_bf16 v[56:59], v[36:39], a[88:91], v[56:59]
    v_mfma_f32_16x16x32_bf16 v[60:63], v[36:39], a[92:95], v[60:63]
    s_waitcnt lgkmcnt(0)
    s_waitcnt vmcnt(8)
    s_barrier
    ds_read_b64_tr_b16 v[32:33], v10 offset:32768
    ds_read_b64_tr_b16 v[34:35], v10 offset:34816
    ds_read_b64_tr_b16 v[36:37], v10 offset:36864
    ds_read_b64_tr_b16 v[38:39], v10 offset:38912
    v_mfma_f32_16x16x32_bf16 v[48:51], v[40:43], a[96:99], v[48:51]
    v_mfma_f32_16x16x32_bf16 v[52:55], v[40:43], a[100:103], v[52:55]
    s_add_u32 m0, s56, 73728
    s_add_u32 s55, s68, 43392
    buffer_load_dwordx4 v14, s[32:35], s55 offen lds
    v_mfma_f32_16x16x32_bf16 v[56:59], v[40:43], a[104:107], v[56:59]
    v_mfma_f32_16x16x32_bf16 v[60:63], v[40:43], a[108:111], v[60:63]
    ds_read_b64_tr_b16 v[40:41], v10 offset:40960
    ds_read_b64_tr_b16 v[42:43], v10 offset:43008
    v_mfma_f32_16x16x32_bf16 v[48:51], v[44:47], a[112:115], v[48:51]
    v_mfma_f32_16x16x32_bf16 v[52:55], v[44:47], a[116:119], v[52:55]
    s_add_u32 m0, s56, 74752
    s_add_u32 s55, s68, 50560
    buffer_load_dwordx4 v14, s[32:35], s55 offen lds
    v_mfma_f32_16x16x32_bf16 v[56:59], v[44:47], a[120:123], v[56:59]
    v_mfma_f32_16x16x32_bf16 v[60:63], v[44:47], a[124:127], v[60:63]
    ds_read_b64_tr_b16 v[44:45], v10 offset:45056
    ds_read_b64_tr_b16 v[46:47], v10 offset:47104
    s_waitcnt lgkmcnt(6)
    v_mfma_f32_16x16x32_bf16 v[48:51], v[32:35], a[128:131], v[48:51]
    v_mfma_f32_16x16x32_bf16 v[52:55], v[32:35], a[132:135], v[52:55]
    s_add_u32 m0, s56, 100352
    s_add_u32 s55, s68, 229760
    buffer_load_dwordx4 v14, s[32:35], s55 offen lds
    v_mfma_f32_16x16x32_bf16 v[56:59], v[32:35], a[136:139], v[56:59]
    v_mfma_f32_16x16x32_bf16 v[60:63], v[32:35], a[140:143], v[60:63]
    ds_read_b64_tr_b16 v[32:33], v10 offset:49152
    ds_read_b64_tr_b16 v[34:35], v10 offset:51200
    s_waitcnt lgkmcnt(6)
    v_mfma_f32_16x16x32_bf16 v[48:51], v[36:39], a[144:147], v[48:51]
    v_mfma_f32_16x16x32_bf16 v[52:55], v[36:39], a[148:151], v[52:55]
    s_add_u32 m0, s56, 101376
    s_add_u32 s55, s68, 236928
    buffer_load_dwordx4 v14, s[32:35], s55 offen lds
    v_mfma_f32_16x16x32_bf16 v[56:59], v[36:39], a[152:155], v[56:59]
    v_mfma_f32_16x16x32_bf16 v[60:63], v[36:39], a[156:159], v[60:63]
    ds_read_b64_tr_b16 v[36:37], v10 offset:53248
    ds_read_b64_tr_b16 v[38:39], v10 offset:55296
    s_waitcnt lgkmcnt(6)
    v_mfma_f32_16x16x32_bf16 v[48:51], v[40:43], a[160:163], v[48:51]
    v_mfma_f32_16x16x32_bf16 v[52:55], v[40:43], a[164:167], v[52:55]
    s_add_u32 m0, s56, 102400
    s_add_u32 s55, s68, 244096
    buffer_load_dwordx4 v14, s[32:35], s55 offen lds
    v_mfma_f32_16x16x32_bf16 v[56:59], v[40:43], a[168:171], v[56:59]
    v_mfma_f32_16x16x32_bf16 v[60:63], v[40:43], a[172:175], v[60:63]
    ds_read_b64_tr_b16 v[40:41], v10 offset:57344
    ds_read_b64_tr_b16 v[42:43], v10 offset:59392
    s_waitcnt lgkmcnt(6)
    v_mfma_f32_16x16x32_bf16 v[48:51], v[44:47], a[176:179], v[48:51]
    v_mfma_f32_16x16x32_bf16 v[52:55], v[44:47], a[180:183], v[52:55]
    s_add_u32 m0, s56, 103424
    s_add_u32 s55, s68, 251264
    buffer_load_dwordx4 v14, s[32:35], s55 offen lds
    v_mfma_f32_16x16x32_bf16 v[56:59], v[44:47], a[184:187], v[56:59]
    v_mfma_f32_16x16x32_bf16 v[60:63], v[44:47], a[188:191], v[60:63]
    ds_read_b64_tr_b16 v[44:45], v10 offset:61440
    ds_read_b64_tr_b16 v[46:47], v10 offset:63488
    s_waitcnt lgkmcnt(6)
    v_mfma_f32_16x16x32_bf16 v[48:51], v[32:35], a[192:195], v[48:51]
    v_mfma_f32_16x16x32_bf16 v[52:55], v[32:35], a[196:199], v[52:55]
    s_add_u32 m0, s56, 104448
    s_add_u32 s55, s68, 258432
    buffer_load_dwordx4 v14, s[32:35], s55 offen lds
    v_mfma_f32_16x16x32_bf16 v[56:59], v[32:35], a[200:203], v[56:59]
    v_mfma_f32_16x16x32_bf16 v[60:63], v[32:35], a[204:207], v[60:63]
    s_waitcnt lgkmcnt(4)
    v_mfma_f32_16x16x32_bf16 v[48:51], v[36:39], a[208:211], v[48:51]
    v_mfma_f32_16x16x32_bf16 v[52:55], v[36:39], a[212:215], v[52:55]
    s_add_u32 m0, s56, 105472
    s_add_u32 s55, s68, 265600
    buffer_load_dwordx4 v14, s[32:35], s55 offen lds
    v_mfma_f32_16x16x32_bf16 v[56:59], v[36:39], a[216:219], v[56:59]
    v_mfma_f32_16x16x32_bf16 v[60:63], v[36:39], a[220:223], v[60:63]
    s_waitcnt lgkmcnt(0)
    s_waitcnt vmcnt(6)
    s_barrier
    ds_read_b64_tr_b16 v[32:33], v11 offset:0
    ds_read_b64_tr_b16 v[34:35], v11 offset:2048
    ds_read_b64_tr_b16 v[36:37], v11 offset:4096
    ds_read_b64_tr_b16 v[38:39], v11 offset:6144
    v_mfma_f32_16x16x32_bf16 v[48:51], v[40:43], a[224:227], v[48:51]
    v_mfma_f32_16x16x32_bf16 v[52:55], v[40:43], a[228:231], v[52:55]
    s_add_u32 m0, s56, 106496
    s_add_u32 s55, s68, 272768
    buffer_load_dwordx4 v14, s[32:35], s55 offen lds
    v_mfma_f32_16x16x32_bf16 v[56:59], v[40:43], a[232:235], v[56:59]
    v_mfma_f32_16x16x32_bf16 v[60:63], v[40:43], a[236:239], v[60:63]
    ds_read_b64_tr_b16 v[40:41], v11 offset:8192
    ds_read_b64_tr_b16 v[42:43], v11 offset:10240
    v_mfma_f32_16x16x32_bf16 v[48:51], v[44:47], a[240:243], v[48:51]
    v_mfma_f32_16x16x32_bf16 v[52:55], v[44:47], a[244:247], v[52:55]
    s_add_u32 m0, s56, 107520
    s_add_u32 s55, s68, 279936
    buffer_load_dwordx4 v14, s[32:35], s55 offen lds
    v_mfma_f32_16x16x32_bf16 v[56:59], v[44:47], a[248:251], v[56:59]
    v_mfma_f32_16x16x32_bf16 v[60:63], v[44:47], a[252:255], v[60:63]
    ds_read_b64_tr_b16 v[44:45], v11 offset:12288
    ds_read_b64_tr_b16 v[46:47], v11 offset:14336
    s_waitcnt lgkmcnt(6)
    v_mfma_f32_16x16x32_bf16 v[64:67], v[32:35], a[0:3], 0
    v_mfma_f32_16x16x32_bf16 v[68:71], v[32:35], a[4:7], 0
    s_add_u32 m0, s56, 0
    s_add_u32 s55, s68, 512
    buffer_load_dwordx4 v14, s[32:35], s55 offen lds
    v_mfma_f32_16x16x32_bf16 v[72:75], v[32:35], a[8:11], 0
    v_mfma_f32_16x16x32_bf16 v[76:79], v[32:35], a[12:15], 0
    ds_read_b64_tr_b16 v[32:33], v11 offset:16384
    ds_read_b64_tr_b16 v[34:35], v11 offset:18432
    s_waitcnt lgkmcnt(6)
    v_mfma_f32_16x16x32_bf16 v[64:67], v[36:39], a[16:19], v[64:67]
    v_mfma_f32_16x16x32_bf16 v[68:71], v[36:39], a[20:23], v[68:71]
    s_add_u32 m0, s56, 1024
    s_add_u32 s55, s68, 7680
    buffer_load_dwordx4 v14, s[32:35], s55 offen lds
    v_mfma_f32_16x16x32_bf16 v[72:75], v[36:39], a[24:27], v[72:75]
    v_mfma_f32_16x16x32_bf16 v[76:79], v[36:39], a[28:31], v[76:79]
    ds_read_b64_tr_b16 v[36:37], v11 offset:20480
    ds_read_b64_tr_b16 v[38:39], v11 offset:22528
    s_waitcnt lgkmcnt(6)
    v_mfma_f32_16x16x32_bf16 v[64:67], v[40:43], a[32:35], v[64:67]
    s_mov_b32 s54, 16384
    v_mfma_f32_16x16x32_bf16 v[68:71], v[40:43], a[36:39], v[68:71]
    v_cvt_pk_bf16_f32 v80, v48, v49
    s_add_u32 m0, s56, 2048
    s_add_u32 s55, s68, 14848
    buffer_load_dwordx4 v14, s[32:35], s55 offen lds
    v_mfma_f32_16x16x32_bf16 v[72:75], v[40:43], a[40:43], v[72:75]
    v_cvt_pk_bf16_f32 v81, v50, v51
    v_mfma_f32_16x16x32_bf16 v[76:79], v[40:43], a[44:47], v[76:79]
    ds_read_b64_tr_b16 v[40:41], v11 offset:24576
    ds_read_b64_tr_b16 v[42:43], v11 offset:26624
    v_cvt_pk_bf16_f32 v82, v52, v53
    s_waitcnt lgkmcnt(6)
    v_mfma_f32_16x16x32_bf16 v[64:67], v[44:47], a[48:51], v[64:67]
    v_cvt_pk_bf16_f32 v83, v54, v55
    v_mfma_f32_16x16x32_bf16 v[68:71], v[44:47], a[52:55], v[68:71]
    buffer_store_dwordx4 v[80:83], v12, s[40:43], s54 offen offset:0 sc0 sc1
    s_add_u32 m0, s56, 3072
    s_add_u32 s55, s68, 22016
    buffer_load_dwordx4 v14, s[32:35], s55 offen lds
    v_mfma_f32_16x16x32_bf16 v[72:75], v[44:47], a[56:59], v[72:75]
    v_cvt_pk_bf16_f32 v84, v56, v57
    v_mfma_f32_16x16x32_bf16 v[76:79], v[44:47], a[60:63], v[76:79]
    ds_read_b64_tr_b16 v[44:45], v11 offset:28672
    ds_read_b64_tr_b16 v[46:47], v11 offset:30720
    v_cvt_pk_bf16_f32 v85, v58, v59
    s_waitcnt lgkmcnt(6)
    v_mfma_f32_16x16x32_bf16 v[64:67], v[32:35], a[64:67], v[64:67]
    v_cvt_pk_bf16_f32 v86, v60, v61
    v_mfma_f32_16x16x32_bf16 v[68:71], v[32:35], a[68:71], v[68:71]
    v_cvt_pk_bf16_f32 v87, v62, v63
    s_add_u32 m0, s56, 4096
    s_add_u32 s55, s68, 29184
    buffer_load_dwordx4 v14, s[32:35], s55 offen lds
    v_mfma_f32_16x16x32_bf16 v[72:75], v[32:35], a[72:75], v[72:75]
    buffer_store_dwordx4 v[84:87], v12, s[40:43], s54 offen offset:1024 sc0 sc1
    v_mfma_f32_16x16x32_bf16 v[76:79], v[32:35], a[76:79], v[76:79]
    s_waitcnt lgkmcnt(4)
    v_mfma_f32_16x16x32_bf16 v[64:67], v[36:39], a[80:83], v[64:67]
    v_mfma_f32_16x16x32_bf16 v[68:71], v[36:39], a[84:87], v[68:71]
    s_add_u32 m0, s56, 5120
    s_add_u32 s55, s68, 36352
    buffer_load_dwordx4 v14, s[32:35], s55 offen lds
    v_mfma_f32_16x16x32_bf16 v[72:75], v[36:39], a[88:91], v[72:75]
    v_mfma_f32_16x16x32_bf16 v[76:79], v[36:39], a[92:95], v[76:79]
    s_waitcnt lgkmcnt(0)
    s_waitcnt vmcnt(8)
    s_barrier
    ds_read_b64_tr_b16 v[32:33], v11 offset:32768
    ds_read_b64_tr_b16 v[34:35], v11 offset:34816
    ds_read_b64_tr_b16 v[36:37], v11 offset:36864
    ds_read_b64_tr_b16 v[38:39], v11 offset:38912
    v_mfma_f32_16x16x32_bf16 v[64:67], v[40:43], a[96:99], v[64:67]
    v_mfma_f32_16x16x32_bf16 v[68:71], v[40:43], a[100:103], v[68:71]
    s_add_u32 m0, s56, 6144
    s_add_u32 s55, s68, 43520
    buffer_load_dwordx4 v14, s[32:35], s55 offen lds
    v_mfma_f32_16x16x32_bf16 v[72:75], v[40:43], a[104:107], v[72:75]
    v_mfma_f32_16x16x32_bf16 v[76:79], v[40:43], a[108:111], v[76:79]
    ds_read_b64_tr_b16 v[40:41], v11 offset:40960
    ds_read_b64_tr_b16 v[42:43], v11 offset:43008
    v_mfma_f32_16x16x32_bf16 v[64:67], v[44:47], a[112:115], v[64:67]
    v_mfma_f32_16x16x32_bf16 v[68:71], v[44:47], a[116:119], v[68:71]
    s_add_u32 m0, s56, 7168
    s_add_u32 s55, s68, 50688
    buffer_load_dwordx4 v14, s[32:35], s55 offen lds
    v_mfma_f32_16x16x32_bf16 v[72:75], v[44:47], a[120:123], v[72:75]
    v_mfma_f32_16x16x32_bf16 v[76:79], v[44:47], a[124:127], v[76:79]
    ds_read_b64_tr_b16 v[44:45], v11 offset:45056
    ds_read_b64_tr_b16 v[46:47], v11 offset:47104
    s_waitcnt lgkmcnt(6)
    v_mfma_f32_16x16x32_bf16 v[64:67], v[32:35], a[128:131], v[64:67]
    v_mfma_f32_16x16x32_bf16 v[68:71], v[32:35], a[132:135], v[68:71]
    s_add_u32 m0, s56, 32768
    s_add_u32 s55, s68, 229888
    buffer_load_dwordx4 v14, s[32:35], s55 offen lds
    v_mfma_f32_16x16x32_bf16 v[72:75], v[32:35], a[136:139], v[72:75]
    v_mfma_f32_16x16x32_bf16 v[76:79], v[32:35], a[140:143], v[76:79]
    ds_read_b64_tr_b16 v[32:33], v11 offset:49152
    ds_read_b64_tr_b16 v[34:35], v11 offset:51200
    s_waitcnt lgkmcnt(6)
    v_mfma_f32_16x16x32_bf16 v[64:67], v[36:39], a[144:147], v[64:67]
    v_mfma_f32_16x16x32_bf16 v[68:71], v[36:39], a[148:151], v[68:71]
    s_add_u32 m0, s56, 33792
    s_add_u32 s55, s68, 237056
    buffer_load_dwordx4 v14, s[32:35], s55 offen lds
    v_mfma_f32_16x16x32_bf16 v[72:75], v[36:39], a[152:155], v[72:75]
    v_mfma_f32_16x16x32_bf16 v[76:79], v[36:39], a[156:159], v[76:79]
    ds_read_b64_tr_b16 v[36:37], v11 offset:53248
    ds_read_b64_tr_b16 v[38:39], v11 offset:55296
    s_waitcnt lgkmcnt(6)
    v_mfma_f32_16x16x32_bf16 v[64:67], v[40:43], a[160:163], v[64:67]
    v_mfma_f32_16x16x32_bf16 v[68:71], v[40:43], a[164:167], v[68:71]
    s_add_u32 m0, s56, 34816
    s_add_u32 s55, s68, 244224
    buffer_load_dwordx4 v14, s[32:35], s55 offen lds
    v_mfma_f32_16x16x32_bf16 v[72:75], v[40:43], a[168:171], v[72:75]
    v_mfma_f32_16x16x32_bf16 v[76:79], v[40:43], a[172:175], v[76:79]
    ds_read_b64_tr_b16 v[40:41], v11 offset:57344
    ds_read_b64_tr_b16 v[42:43], v11 offset:59392
    s_waitcnt lgkmcnt(6)
    v_mfma_f32_16x16x32_bf16 v[64:67], v[44:47], a[176:179], v[64:67]
    v_mfma_f32_16x16x32_bf16 v[68:71], v[44:47], a[180:183], v[68:71]
    s_add_u32 m0, s56, 35840
    s_add_u32 s55, s68, 251392
    buffer_load_dwordx4 v14, s[32:35], s55 offen lds
    v_mfma_f32_16x16x32_bf16 v[72:75], v[44:47], a[184:187], v[72:75]
    v_mfma_f32_16x16x32_bf16 v[76:79], v[44:47], a[188:191], v[76:79]
    ds_read_b64_tr_b16 v[44:45], v11 offset:61440
    ds_read_b64_tr_b16 v[46:47], v11 offset:63488
    s_waitcnt lgkmcnt(6)
    v_mfma_f32_16x16x32_bf16 v[64:67], v[32:35], a[192:195], v[64:67]
    v_mfma_f32_16x16x32_bf16 v[68:71], v[32:35], a[196:199], v[68:71]
    s_add_u32 m0, s56, 36864
    s_add_u32 s55, s68, 258560
    buffer_load_dwordx4 v14, s[32:35], s55 offen lds
    v_mfma_f32_16x16x32_bf16 v[72:75], v[32:35], a[200:203], v[72:75]
    v_mfma_f32_16x16x32_bf16 v[76:79], v[32:35], a[204:207], v[76:79]
    s_waitcnt lgkmcnt(4)
    v_mfma_f32_16x16x32_bf16 v[64:67], v[36:39], a[208:211], v[64:67]
    v_mfma_f32_16x16x32_bf16 v[68:71], v[36:39], a[212:215], v[68:71]
    s_add_u32 m0, s56, 37888
    s_add_u32 s55, s68, 265728
    buffer_load_dwordx4 v14, s[32:35], s55 offen lds
    v_mfma_f32_16x16x32_bf16 v[72:75], v[36:39], a[216:219], v[72:75]
    v_mfma_f32_16x16x32_bf16 v[76:79], v[36:39], a[220:223], v[76:79]
    s_waitcnt lgkmcnt(0)
    s_waitcnt vmcnt(6)
    s_barrier
    ds_read_b64_tr_b16 v[32:33], v10 offset:0
    ds_read_b64_tr_b16 v[34:35], v10 offset:2048
    ds_read_b64_tr_b16 v[36:37], v10 offset:4096
    ds_read_b64_tr_b16 v[38:39], v10 offset:6144
    v_mfma_f32_16x16x32_bf16 v[64:67], v[40:43], a[224:227], v[64:67]
    v_mfma_f32_16x16x32_bf16 v[68:71], v[40:43], a[228:231], v[68:71]
    s_add_u32 m0, s56, 38912
    s_add_u32 s55, s68, 272896
    buffer_load_dwordx4 v14, s[32:35], s55 offen lds
    v_mfma_f32_16x16x32_bf16 v[72:75], v[40:43], a[232:235], v[72:75]
    v_mfma_f32_16x16x32_bf16 v[76:79], v[40:43], a[236:239], v[76:79]
    ds_read_b64_tr_b16 v[40:41], v10 offset:8192
    ds_read_b64_tr_b16 v[42:43], v10 offset:10240
    v_mfma_f32_16x16x32_bf16 v[64:67], v[44:47], a[240:243], v[64:67]
    v_mfma_f32_16x16x32_bf16 v[68:71], v[44:47], a[244:247], v[68:71]
    s_add_u32 m0, s56, 39936
    s_add_u32 s55, s68, 280064
    buffer_load_dwordx4 v14, s[32:35], s55 offen lds
    v_mfma_f32_16x16x32_bf16 v[72:75], v[44:47], a[248:251], v[72:75]
    v_mfma_f32_16x16x32_bf16 v[76:79], v[44:47], a[252:255], v[76:79]
    ds_read_b64_tr_b16 v[44:45], v10 offset:12288
    ds_read_b64_tr_b16 v[46:47], v10 offset:14336
    s_waitcnt lgkmcnt(6)
    v_mfma_f32_16x16x32_bf16 v[48:51], v[32:35], a[0:3], 0
    v_mfma_f32_16x16x32_bf16 v[52:55], v[32:35], a[4:7], 0
    s_add_u32 m0, s56, 67584
    s_add_u32 s55, s68, 640
    buffer_load_dwordx4 v14, s[32:35], s55 offen lds
    v_mfma_f32_16x16x32_bf16 v[56:59], v[32:35], a[8:11], 0
    v_mfma_f32_16x16x32_bf16 v[60:63], v[32:35], a[12:15], 0
    ds_read_b64_tr_b16 v[32:33], v10 offset:16384
    ds_read_b64_tr_b16 v[34:35], v10 offset:18432
    s_waitcnt lgkmcnt(6)
    v_mfma_f32_16x16x32_bf16 v[48:51], v[36:39], a[16:19], v[48:51]
    v_mfma_f32_16x16x32_bf16 v[52:55], v[36:39], a[20:23], v[52:55]
    s_add_u32 m0, s56, 68608
    s_add_u32 s55, s68, 7808
    buffer_load_dwordx4 v14, s[32:35], s55 offen lds
    v_mfma_f32_16x16x32_bf16 v[56:59], v[36:39], a[24:27], v[56:59]
    v_mfma_f32_16x16x32_bf16 v[60:63], v[36:39], a[28:31], v[60:63]
    ds_read_b64_tr_b16 v[36:37], v10 offset:20480
    ds_read_b64_tr_b16 v[38:39], v10 offset:22528
    s_waitcnt lgkmcnt(6)
    v_mfma_f32_16x16x32_bf16 v[48:51], v[40:43], a[32:35], v[48:51]
    s_mov_b32 s54, 24576
    v_mfma_f32_16x16x32_bf16 v[52:55], v[40:43], a[36:39], v[52:55]
    v_cvt_pk_bf16_f32 v80, v64, v65
    s_add_u32 m0, s56, 69632
    s_add_u32 s55, s68, 14976
    buffer_load_dwordx4 v14, s[32:35], s55 offen lds
    v_mfma_f32_16x16x32_bf16 v[56:59], v[40:43], a[40:43], v[56:59]
    v_cvt_pk_bf16_f32 v81, v66, v67
    v_mfma_f32_16x16x32_bf16 v[60:63], v[40:43], a[44:47], v[60:63]
    ds_read_b64_tr_b16 v[40:41], v10 offset:24576
    ds_read_b64_tr_b16 v[42:43], v10 offset:26624
    v_cvt_pk_bf16_f32 v82, v68, v69
    s_waitcnt lgkmcnt(6)
    v_mfma_f32_16x16x32_bf16 v[48:51], v[44:47], a[48:51], v[48:51]
    v_cvt_pk_bf16_f32 v83, v70, v71
    v_mfma_f32_16x16x32_bf16 v[52:55], v[44:47], a[52:55], v[52:55]
    buffer_store_dwordx4 v[80:83], v12, s[40:43], s54 offen offset:0 sc0 sc1
    s_add_u32 m0, s56, 70656
    s_add_u32 s55, s68, 22144
    buffer_load_dwordx4 v14, s[32:35], s55 offen lds
    v_mfma_f32_16x16x32_bf16 v[56:59], v[44:47], a[56:59], v[56:59]
    v_cvt_pk_bf16_f32 v84, v72, v73
    v_mfma_f32_16x16x32_bf16 v[60:63], v[44:47], a[60:63], v[60:63]
    ds_read_b64_tr_b16 v[44:45], v10 offset:28672
    ds_read_b64_tr_b16 v[46:47], v10 offset:30720
    v_cvt_pk_bf16_f32 v85, v74, v75
    s_waitcnt lgkmcnt(6)
    v_mfma_f32_16x16x32_bf16 v[48:51], v[32:35], a[64:67], v[48:51]
    v_cvt_pk_bf16_f32 v86, v76, v77
    v_mfma_f32_16x16x32_bf16 v[52:55], v[32:35], a[68:71], v[52:55]
    v_cvt_pk_bf16_f32 v87, v78, v79
    s_add_u32 m0, s56, 71680
    s_add_u32 s55, s68, 29312
    buffer_load_dwordx4 v14, s[32:35], s55 offen lds
    v_mfma_f32_16x16x32_bf16 v[56:59], v[32:35], a[72:75], v[56:59]
    buffer_store_dwordx4 v[84:87], v12, s[40:43], s54 offen offset:1024 sc0 sc1
    v_mfma_f32_16x16x32_bf16 v[60:63], v[32:35], a[76:79], v[60:63]
    s_waitcnt lgkmcnt(4)
    v_mfma_f32_16x16x32_bf16 v[48:51], v[36:39], a[80:83], v[48:51]
    v_mfma_f32_16x16x32_bf16 v[52:55], v[36:39], a[84:87], v[52:55]
    s_add_u32 m0, s56, 72704
    s_add_u32 s55, s68, 36480
    buffer_load_dwordx4 v14, s[32:35], s55 offen lds
    v_mfma_f32_16x16x32_bf16 v[56:59], v[36:39], a[88:91], v[56:59]
    v_mfma_f32_16x16x32_bf16 v[60:63], v[36:39], a[92:95], v[60:63]
    s_waitcnt lgkmcnt(0)
    s_waitcnt vmcnt(8)
    s_barrier
    ds_read_b64_tr_b16 v[32:33], v10 offset:32768
    ds_read_b64_tr_b16 v[34:35], v10 offset:34816
    ds_read_b64_tr_b16 v[36:37], v10 offset:36864
    ds_read_b64_tr_b16 v[38:39], v10 offset:38912
    v_mfma_f32_16x16x32_bf16 v[48:51], v[40:43], a[96:99], v[48:51]
    v_mfma_f32_16x16x32_bf16 v[52:55], v[40:43], a[100:103], v[52:55]
    s_add_u32 m0, s56, 73728
    s_add_u32 s55, s68, 43648
    buffer_load_dwordx4 v14, s[32:35], s55 offen lds
    v_mfma_f32_16x16x32_bf16 v[56:59], v[40:43], a[104:107], v[56:59]
    v_mfma_f32_16x16x32_bf16 v[60:63], v[40:43], a[108:111], v[60:63]
    ds_read_b64_tr_b16 v[40:41], v10 offset:40960
    ds_read_b64_tr_b16 v[42:43], v10 offset:43008
    v_mfma_f32_16x16x32_bf16 v[48:51], v[44:47], a[112:115], v[48:51]
    v_mfma_f32_16x16x32_bf16 v[52:55], v[44:47], a[116:119], v[52:55]
    s_add_u32 m0, s56, 74752
    s_add_u32 s55, s68, 50816
    buffer_load_dwordx4 v14, s[32:35], s55 offen lds
    v_mfma_f32_16x16x32_bf16 v[56:59], v[44:47], a[120:123], v[56:59]
    v_mfma_f32_16x16x32_bf16 v[60:63], v[44:47], a[124:127], v[60:63]
    ds_read_b64_tr_b16 v[44:45], v10 offset:45056
    ds_read_b64_tr_b16 v[46:47], v10 offset:47104
    s_waitcnt lgkmcnt(6)
    v_mfma_f32_16x16x32_bf16 v[48:51], v[32:35], a[128:131], v[48:51]
    v_mfma_f32_16x16x32_bf16 v[52:55], v[32:35], a[132:135], v[52:55]
    s_add_u32 m0, s56, 100352
    s_add_u32 s55, s68, 230016
    buffer_load_dwordx4 v14, s[32:35], s55 offen lds
    v_mfma_f32_16x16x32_bf16 v[56:59], v[32:35], a[136:139], v[56:59]
    v_mfma_f32_16x16x32_bf16 v[60:63], v[32:35], a[140:143], v[60:63]
    ds_read_b64_tr_b16 v[32:33], v10 offset:49152
    ds_read_b64_tr_b16 v[34:35], v10 offset:51200
    s_waitcnt lgkmcnt(6)
    v_mfma_f32_16x16x32_bf16 v[48:51], v[36:39], a[144:147], v[48:51]
    v_mfma_f32_16x16x32_bf16 v[52:55], v[36:39], a[148:151], v[52:55]
    s_add_u32 m0, s56, 101376
    s_add_u32 s55, s68, 237184
    buffer_load_dwordx4 v14, s[32:35], s55 offen lds
    v_mfma_f32_16x16x32_bf16 v[56:59], v[36:39], a[152:155], v[56:59]
    v_mfma_f32_16x16x32_bf16 v[60:63], v[36:39], a[156:159], v[60:63]
    ds_read_b64_tr_b16 v[36:37], v10 offset:53248
    ds_read_b64_tr_b16 v[38:39], v10 offset:55296
    s_waitcnt lgkmcnt(6)
    v_mfma_f32_16x16x32_bf16 v[48:51], v[40:43], a[160:163], v[48:51]
    v_mfma_f32_16x16x32_bf16 v[52:55], v[40:43], a[164:167], v[52:55]
    s_add_u32 m0, s56, 102400
    s_add_u32 s55, s68, 244352
    buffer_load_dwordx4 v14, s[32:35], s55 offen lds
    v_mfma_f32_16x16x32_bf16 v[56:59], v[40:43], a[168:171], v[56:59]
    v_mfma_f32_16x16x32_bf16 v[60:63], v[40:43], a[172:175], v[60:63]
    ds_read_b64_tr_b16 v[40:41], v10 offset:57344
    ds_read_b64_tr_b16 v[42:43], v10 offset:59392
    s_waitcnt lgkmcnt(6)
    v_mfma_f32_16x16x32_bf16 v[48:51], v[44:47], a[176:179], v[48:51]
    v_mfma_f32_16x16x32_bf16 v[52:55], v[44:47], a[180:183], v[52:55]
    s_add_u32 m0, s56, 103424
    s_add_u32 s55, s68, 251520
    buffer_load_dwordx4 v14, s[32:35], s55 offen lds
    v_mfma_f32_16x16x32_bf16 v[56:59], v[44:47], a[184:187], v[56:59]
    v_mfma_f32_16x16x32_bf16 v[60:63], v[44:47], a[188:191], v[60:63]
    ds_read_b64_tr_b16 v[44:45], v10 offset:61440
    ds_read_b64_tr_b16 v[46:47], v10 offset:63488
    s_waitcnt lgkmcnt(6)
    v_mfma_f32_16x16x32_bf16 v[48:51], v[32:35], a[192:195], v[48:51]
    v_mfma_f32_16x16x32_bf16 v[52:55], v[32:35], a[196:199], v[52:55]
    s_add_u32 m0, s56, 104448
    s_add_u32 s55, s68, 258688
    buffer_load_dwordx4 v14, s[32:35], s55 offen lds
    v_mfma_f32_16x16x32_bf16 v[56:59], v[32:35], a[200:203], v[56:59]
    v_mfma_f32_16x16x32_bf16 v[60:63], v[32:35], a[204:207], v[60:63]
    s_waitcnt lgkmcnt(4)
    v_mfma_f32_16x16x32_bf16 v[48:51], v[36:39], a[208:211], v[48:51]
    v_mfma_f32_16x16x32_bf16 v[52:55], v[36:39], a[212:215], v[52:55]
    s_add_u32 m0, s56, 105472
    s_add_u32 s55, s68, 265856
    buffer_load_dwordx4 v14, s[32:35], s55 offen lds
    v_mfma_f32_16x16x32_bf16 v[56:59], v[36:39], a[216:219], v[56:59]
    v_mfma_f32_16x16x32_bf16 v[60:63], v[36:39], a[220:223], v[60:63]
    s_waitcnt lgkmcnt(0)
    s_waitcnt vmcnt(6)
    s_barrier
    ds_read_b64_tr_b16 v[32:33], v11 offset:0
    ds_read_b64_tr_b16 v[34:35], v11 offset:2048
    ds_read_b64_tr_b16 v[36:37], v11 offset:4096
    ds_read_b64_tr_b16 v[38:39], v11 offset:6144
    v_mfma_f32_16x16x32_bf16 v[48:51], v[40:43], a[224:227], v[48:51]
    v_mfma_f32_16x16x32_bf16 v[52:55], v[40:43], a[228:231], v[52:55]
    s_add_u32 m0, s56, 106496
    s_add_u32 s55, s68, 273024
    buffer_load_dwordx4 v14, s[32:35], s55 offen lds
    v_mfma_f32_16x16x32_bf16 v[56:59], v[40:43], a[232:235], v[56:59]
    v_mfma_f32_16x16x32_bf16 v[60:63], v[40:43], a[236:239], v[60:63]
    ds_read_b64_tr_b16 v[40:41], v11 offset:8192
    ds_read_b64_tr_b16 v[42:43], v11 offset:10240
    v_mfma_f32_16x16x32_bf16 v[48:51], v[44:47], a[240:243], v[48:51]
    v_mfma_f32_16x16x32_bf16 v[52:55], v[44:47], a[244:247], v[52:55]
    s_add_u32 m0, s56, 107520
    s_add_u32 s55, s68, 280192
    buffer_load_dwordx4 v14, s[32:35], s55 offen lds
    v_mfma_f32_16x16x32_bf16 v[56:59], v[44:47], a[248:251], v[56:59]
    v_mfma_f32_16x16x32_bf16 v[60:63], v[44:47], a[252:255], v[60:63]
    ds_read_b64_tr_b16 v[44:45], v11 offset:12288
    ds_read_b64_tr_b16 v[46:47], v11 offset:14336
    s_waitcnt lgkmcnt(6)
    v_mfma_f32_16x16x32_bf16 v[64:67], v[32:35], a[0:3], 0
    v_mfma_f32_16x16x32_bf16 v[68:71], v[32:35], a[4:7], 0
    s_add_u32 m0, s56, 0
    s_add_u32 s55, s68, 768
    buffer_load_dwordx4 v14, s[32:35], s55 offen lds
    v_mfma_f32_16x16x32_bf16 v[72:75], v[32:35], a[8:11], 0
    v_mfma_f32_16x16x32_bf16 v[76:79], v[32:35], a[12:15], 0
    ds_read_b64_tr_b16 v[32:33], v11 offset:16384
    ds_read_b64_tr_b16 v[34:35], v11 offset:18432
    s_waitcnt lgkmcnt(6)
    v_mfma_f32_16x16x32_bf16 v[64:67], v[36:39], a[16:19], v[64:67]
    v_mfma_f32_16x16x32_bf16 v[68:71], v[36:39], a[20:23], v[68:71]
    s_add_u32 m0, s56, 1024
    s_add_u32 s55, s68, 7936
    buffer_load_dwordx4 v14, s[32:35], s55 offen lds
    v_mfma_f32_16x16x32_bf16 v[72:75], v[36:39], a[24:27], v[72:75]
    v_mfma_f32_16x16x32_bf16 v[76:79], v[36:39], a[28:31], v[76:79]
    ds_read_b64_tr_b16 v[36:37], v11 offset:20480
    ds_read_b64_tr_b16 v[38:39], v11 offset:22528
    s_waitcnt lgkmcnt(6)
    v_mfma_f32_16x16x32_bf16 v[64:67], v[40:43], a[32:35], v[64:67]
    s_mov_b32 s54, 32768
    v_mfma_f32_16x16x32_bf16 v[68:71], v[40:43], a[36:39], v[68:71]
    v_cvt_pk_bf16_f32 v80, v48, v49
    s_add_u32 m0, s56, 2048
    s_add_u32 s55, s68, 15104
    buffer_load_dwordx4 v14, s[32:35], s55 offen lds
    v_mfma_f32_16x16x32_bf16 v[72:75], v[40:43], a[40:43], v[72:75]
    v_cvt_pk_bf16_f32 v81, v50, v51
    v_mfma_f32_16x16x32_bf16 v[76:79], v[40:43], a[44:47], v[76:79]
    ds_read_b64_tr_b16 v[40:41], v11 offset:24576
    ds_read_b64_tr_b16 v[42:43], v11 offset:26624
    v_cvt_pk_bf16_f32 v82, v52, v53
    s_waitcnt lgkmcnt(6)
    v_mfma_f32_16x16x32_bf16 v[64:67], v[44:47], a[48:51], v[64:67]
    v_cvt_pk_bf16_f32 v83, v54, v55
    v_mfma_f32_16x16x32_bf16 v[68:71], v[44:47], a[52:55], v[68:71]
    buffer_store_dwordx4 v[80:83], v12, s[40:43], s54 offen offset:0 sc0 sc1
    s_add_u32 m0, s56, 3072
    s_add_u32 s55, s68, 22272
    buffer_load_dwordx4 v14, s[32:35], s55 offen lds
    v_mfma_f32_16x16x32_bf16 v[72:75], v[44:47], a[56:59], v[72:75]
    v_cvt_pk_bf16_f32 v84, v56, v57
    v_mfma_f32_16x16x32_bf16 v[76:79], v[44:47], a[60:63], v[76:79]
    ds_read_b64_tr_b16 v[44:45], v11 offset:28672
    ds_read_b64_tr_b16 v[46:47], v11 offset:30720
    v_cvt_pk_bf16_f32 v85, v58, v59
    s_waitcnt lgkmcnt(6)
    v_mfma_f32_16x16x32_bf16 v[64:67], v[32:35], a[64:67], v[64:67]
    v_cvt_pk_bf16_f32 v86, v60, v61
    v_mfma_f32_16x16x32_bf16 v[68:71], v[32:35], a[68:71], v[68:71]
    v_cvt_pk_bf16_f32 v87, v62, v63
    s_add_u32 m0, s56, 4096
    s_add_u32 s55, s68, 29440
    buffer_load_dwordx4 v14, s[32:35], s55 offen lds
    v_mfma_f32_16x16x32_bf16 v[72:75], v[32:35], a[72:75], v[72:75]
    buffer_store_dwordx4 v[84:87], v12, s[40:43], s54 offen offset:1024 sc0 sc1
    v_mfma_f32_16x16x32_bf16 v[76:79], v[32:35], a[76:79], v[76:79]
    s_waitcnt lgkmcnt(4)
    v_mfma_f32_16x16x32_bf16 v[64:67], v[36:39], a[80:83], v[64:67]
    v_mfma_f32_16x16x32_bf16 v[68:71], v[36:39], a[84:87], v[68:71]
    s_add_u32 m0, s56, 5120
    s_add_u32 s55, s68, 36608
    buffer_load_dwordx4 v14, s[32:35], s55 offen lds
    v_mfma_f32_16x16x32_bf16 v[72:75], v[36:39], a[88:91], v[72:75]
    v_mfma_f32_16x16x32_bf16 v[76:79], v[36:39], a[92:95], v[76:79]
    s_waitcnt lgkmcnt(0)
    s_waitcnt vmcnt(8)
    s_barrier
    ds_read_b64_tr_b16 v[32:33], v11 offset:32768
    ds_read_b64_tr_b16 v[34:35], v11 offset:34816
    ds_read_b64_tr_b16 v[36:37], v11 offset:36864
    ds_read_b64_tr_b16 v[38:39], v11 offset:38912
    v_mfma_f32_16x16x32_bf16 v[64:67], v[40:43], a[96:99], v[64:67]
    v_mfma_f32_16x16x32_bf16 v[68:71], v[40:43], a[100:103], v[68:71]
    s_add_u32 m0, s56, 6144
    s_add_u32 s55, s68, 43776
    buffer_load_dwordx4 v14, s[32:35], s55 offen lds
    v_mfma_f32_16x16x32_bf16 v[72:75], v[40:43], a[104:107], v[72:75]
    v_mfma_f32_16x16x32_bf16 v[76:79], v[40:43], a[108:111], v[76:79]
    ds_read_b64_tr_b16 v[40:41], v11 offset:40960
    ds_read_b64_tr_b16 v[42:43], v11 offset:43008
    v_mfma_f32_16x16x32_bf16 v[64:67], v[44:47], a[112:115], v[64:67]
    v_mfma_f32_16x16x32_bf16 v[68:71], v[44:47], a[116:119], v[68:71]
    s_add_u32 m0, s56, 7168
    s_add_u32 s55, s68, 50944
    buffer_load_dwordx4 v14, s[32:35], s55 offen lds
    v_mfma_f32_16x16x32_bf16 v[72:75], v[44:47], a[120:123], v[72:75]
    v_mfma_f32_16x16x32_bf16 v[76:79], v[44:47], a[124:127], v[76:79]
    ds_read_b64_tr_b16 v[44:45], v11 offset:45056
    ds_read_b64_tr_b16 v[46:47], v11 offset:47104
    s_waitcnt lgkmcnt(6)
    v_mfma_f32_16x16x32_bf16 v[64:67], v[32:35], a[128:131], v[64:67]
    v_mfma_f32_16x16x32_bf16 v[68:71], v[32:35], a[132:135], v[68:71]
    s_add_u32 m0, s56, 32768
    s_add_u32 s55, s68, 230144
    buffer_load_dwordx4 v14, s[32:35], s55 offen lds
    v_mfma_f32_16x16x32_bf16 v[72:75], v[32:35], a[136:139], v[72:75]
    v_mfma_f32_16x16x32_bf16 v[76:79], v[32:35], a[140:143], v[76:79]
    ds_read_b64_tr_b16 v[32:33], v11 offset:49152
    ds_read_b64_tr_b16 v[34:35], v11 offset:51200
    s_waitcnt lgkmcnt(6)
    v_mfma_f32_16x16x32_bf16 v[64:67], v[36:39], a[144:147], v[64:67]
    v_mfma_f32_16x16x32_bf16 v[68:71], v[36:39], a[148:151], v[68:71]
    s_add_u32 m0, s56, 33792
    s_add_u32 s55, s68, 237312
    buffer_load_dwordx4 v14, s[32:35], s55 offen lds
    v_mfma_f32_16x16x32_bf16 v[72:75], v[36:39], a[152:155], v[72:75]
    v_mfma_f32_16x16x32_bf16 v[76:79], v[36:39], a[156:159], v[76:79]
    ds_read_b64_tr_b16 v[36:37], v11 offset:53248
    ds_read_b64_tr_b16 v[38:39], v11 offset:55296
    s_waitcnt lgkmcnt(6)
    v_mfma_f32_16x16x32_bf16 v[64:67], v[40:43], a[160:163], v[64:67]
    v_mfma_f32_16x16x32_bf16 v[68:71], v[40:43], a[164:167], v[68:71]
    s_add_u32 m0, s56, 34816
    s_add_u32 s55, s68, 244480
    buffer_load_dwordx4 v14, s[32:35], s55 offen lds
    v_mfma_f32_16x16x32_bf16 v[72:75], v[40:43], a[168:171], v[72:75]
    v_mfma_f32_16x16x32_bf16 v[76:79], v[40:43], a[172:175], v[76:79]
    ds_read_b64_tr_b16 v[40:41], v11 offset:57344
    ds_read_b64_tr_b16 v[42:43], v11 offset:59392
    s_waitcnt lgkmcnt(6)
    v_mfma_f32_16x16x32_bf16 v[64:67], v[44:47], a[176:179], v[64:67]
    v_mfma_f32_16x16x32_bf16 v[68:71], v[44:47], a[180:183], v[68:71]
    s_add_u32 m0, s56, 35840
    s_add_u32 s55, s68, 251648
    buffer_load_dwordx4 v14, s[32:35], s55 offen lds
    v_mfma_f32_16x16x32_bf16 v[72:75], v[44:47], a[184:187], v[72:75]
    v_mfma_f32_16x16x32_bf16 v[76:79], v[44:47], a[188:191], v[76:79]
    ds_read_b64_tr_b16 v[44:45], v11 offset:61440
    ds_read_b64_tr_b16 v[46:47], v11 offset:63488
    s_waitcnt lgkmcnt(6)
    v_mfma_f32_16x16x32_bf16 v[64:67], v[32:35], a[192:195], v[64:67]
    v_mfma_f32_16x16x32_bf16 v[68:71], v[32:35], a[196:199], v[68:71]
    s_add_u32 m0, s56, 36864
    s_add_u32 s55, s68, 258816
    buffer_load_dwordx4 v14, s[32:35], s55 offen lds
    v_mfma_f32_16x16x32_bf16 v[72:75], v[32:35], a[200:203], v[72:75]
    v_mfma_f32_16x16x32_bf16 v[76:79], v[32:35], a[204:207], v[76:79]
    s_waitcnt lgkmcnt(4)
    v_mfma_f32_16x16x32_bf16 v[64:67], v[36:39], a[208:211], v[64:67]
    v_mfma_f32_16x16x32_bf16 v[68:71], v[36:39], a[212:215], v[68:71]
    s_add_u32 m0, s56, 37888
    s_add_u32 s55, s68, 265984
    buffer_load_dwordx4 v14, s[32:35], s55 offen lds
    v_mfma_f32_16x16x32_bf16 v[72:75], v[36:39], a[216:219], v[72:75]
    v_mfma_f32_16x16x32_bf16 v[76:79], v[36:39], a[220:223], v[76:79]
    s_waitcnt lgkmcnt(0)
    s_waitcnt vmcnt(6)
    s_barrier
    ds_read_b64_tr_b16 v[32:33], v10 offset:0
    ds_read_b64_tr_b16 v[34:35], v10 offset:2048
    ds_read_b64_tr_b16 v[36:37], v10 offset:4096
    ds_read_b64_tr_b16 v[38:39], v10 offset:6144
    v_mfma_f32_16x16x32_bf16 v[64:67], v[40:43], a[224:227], v[64:67]
    v_mfma_f32_16x16x32_bf16 v[68:71], v[40:43], a[228:231], v[68:71]
    s_add_u32 m0, s56, 38912
    s_add_u32 s55, s68, 273152
    buffer_load_dwordx4 v14, s[32:35], s55 offen lds
    v_mfma_f32_16x16x32_bf16 v[72:75], v[40:43], a[232:235], v[72:75]
    v_mfma_f32_16x16x32_bf16 v[76:79], v[40:43], a[236:239], v[76:79]
    ds_read_b64_tr_b16 v[40:41], v10 offset:8192
    ds_read_b64_tr_b16 v[42:43], v10 offset:10240
    v_mfma_f32_16x16x32_bf16 v[64:67], v[44:47], a[240:243], v[64:67]
    v_mfma_f32_16x16x32_bf16 v[68:71], v[44:47], a[244:247], v[68:71]
    s_add_u32 m0, s56, 39936
    s_add_u32 s55, s68, 280320
    buffer_load_dwordx4 v14, s[32:35], s55 offen lds
    v_mfma_f32_16x16x32_bf16 v[72:75], v[44:47], a[248:251], v[72:75]
    v_mfma_f32_16x16x32_bf16 v[76:79], v[44:47], a[252:255], v[76:79]
    ds_read_b64_tr_b16 v[44:45], v10 offset:12288
    ds_read_b64_tr_b16 v[46:47], v10 offset:14336
    s_waitcnt lgkmcnt(6)
    v_mfma_f32_16x16x32_bf16 v[48:51], v[32:35], a[0:3], 0
    v_mfma_f32_16x16x32_bf16 v[52:55], v[32:35], a[4:7], 0
    v_mfma_f32_16x16x32_bf16 v[56:59], v[32:35], a[8:11], 0
    v_mfma_f32_16x16x32_bf16 v[60:63], v[32:35], a[12:15], 0
    ds_read_b64_tr_b16 v[32:33], v10 offset:16384
    ds_read_b64_tr_b16 v[34:35], v10 offset:18432
    s_waitcnt lgkmcnt(6)
    v_mfma_f32_16x16x32_bf16 v[48:51], v[36:39], a[16:19], v[48:51]
    v_mfma_f32_16x16x32_bf16 v[52:55], v[36:39], a[20:23], v[52:55]
    v_mfma_f32_16x16x32_bf16 v[56:59], v[36:39], a[24:27], v[56:59]
    v_mfma_f32_16x16x32_bf16 v[60:63], v[36:39], a[28:31], v[60:63]
    ds_read_b64_tr_b16 v[36:37], v10 offset:20480
    ds_read_b64_tr_b16 v[38:39], v10 offset:22528
    s_waitcnt lgkmcnt(6)
    v_mfma_f32_16x16x32_bf16 v[48:51], v[40:43], a[32:35], v[48:51]
    s_mov_b32 s54, 40960
    v_mfma_f32_16x16x32_bf16 v[52:55], v[40:43], a[36:39], v[52:55]
    v_cvt_pk_bf16_f32 v80, v64, v65
    v_mfma_f32_16x16x32_bf16 v[56:59], v[40:43], a[40:43], v[56:59]
    v_cvt_pk_bf16_f32 v81, v66, v67
    v_mfma_f32_16x16x32_bf16 v[60:63], v[40:43], a[44:47], v[60:63]
    ds_read_b64_tr_b16 v[40:41], v10 offset:24576
    ds_read_b64_tr_b16 v[42:43], v10 offset:26624
    v_cvt_pk_bf16_f32 v82, v68, v69
    s_waitcnt lgkmcnt(6)
    v_mfma_f32_16x16x32_bf16 v[48:51], v[44:47], a[48:51], v[48:51]
    v_cvt_pk_bf16_f32 v83, v70, v71
    v_mfma_f32_16x16x32_bf16 v[52:55], v[44:47], a[52:55], v[52:55]
    buffer_store_dwordx4 v[80:83], v12, s[40:43], s54 offen offset:0 sc0 sc1
    v_mfma_f32_16x16x32_bf16 v[56:59], v[44:47], a[56:59], v[56:59]
    v_cvt_pk_bf16_f32 v84, v72, v73
    v_mfma_f32_16x16x32_bf16 v[60:63], v[44:47], a[60:63], v[60:63]
    ds_read_b64_tr_b16 v[44:45], v10 offset:28672
    ds_read_b64_tr_b16 v[46:47], v10 offset:30720
    v_cvt_pk_bf16_f32 v85, v74, v75
    s_waitcnt lgkmcnt(6)
    v_mfma_f32_16x16x32_bf16 v[48:51], v[32:35], a[64:67], v[48:51]
    v_cvt_pk_bf16_f32 v86, v76, v77
    v_mfma_f32_16x16x32_bf16 v[52:55], v[32:35], a[68:71], v[52:55]
    v_cvt_pk_bf16_f32 v87, v78, v79
    v_mfma_f32_16x16x32_bf16 v[56:59], v[32:35], a[72:75], v[56:59]
    buffer_store_dwordx4 v[84:87], v12, s[40:43], s54 offen offset:1024 sc0 sc1
    v_mfma_f32_16x16x32_bf16 v[60:63], v[32:35], a[76:79], v[60:63]
    s_waitcnt lgkmcnt(4)
    v_mfma_f32_16x16x32_bf16 v[48:51], v[36:39], a[80:83], v[48:51]
    v_mfma_f32_16x16x32_bf16 v[52:55], v[36:39], a[84:87], v[52:55]
    v_mfma_f32_16x16x32_bf16 v[56:59], v[36:39], a[88:91], v[56:59]
    v_mfma_f32_16x16x32_bf16 v[60:63], v[36:39], a[92:95], v[60:63]
    s_waitcnt lgkmcnt(0)
    s_waitcnt vmcnt(2)
    s_barrier
    ds_read_b64_tr_b16 v[32:33], v10 offset:32768
    ds_read_b64_tr_b16 v[34:35], v10 offset:34816
    ds_read_b64_tr_b16 v[36:37], v10 offset:36864
    ds_read_b64_tr_b16 v[38:39], v10 offset:38912
    v_mfma_f32_16x16x32_bf16 v[48:51], v[40:43], a[96:99], v[48:51]
    v_mfma_f32_16x16x32_bf16 v[52:55], v[40:43], a[100:103], v[52:55]
    v_mfma_f32_16x16x32_bf16 v[56:59], v[40:43], a[104:107], v[56:59]
    v_mfma_f32_16x16x32_bf16 v[60:63], v[40:43], a[108:111], v[60:63]
    ds_read_b64_tr_b16 v[40:41], v10 offset:40960
    ds_read_b64_tr_b16 v[42:43], v10 offset:43008
    v_mfma_f32_16x16x32_bf16 v[48:51], v[44:47], a[112:115], v[48:51]
    v_mfma_f32_16x16x32_bf16 v[52:55], v[44:47], a[116:119], v[52:55]
    v_mfma_f32_16x16x32_bf16 v[56:59], v[44:47], a[120:123], v[56:59]
    v_mfma_f32_16x16x32_bf16 v[60:63], v[44:47], a[124:127], v[60:63]
    ds_read_b64_tr_b16 v[44:45], v10 offset:45056
    ds_read_b64_tr_b16 v[46:47], v10 offset:47104
    s_waitcnt lgkmcnt(6)
    v_mfma_f32_16x16x32_bf16 v[48:51], v[32:35], a[128:131], v[48:51]
    v_mfma_f32_16x16x32_bf16 v[52:55], v[32:35], a[132:135], v[52:55]
    v_mfma_f32_16x16x32_bf16 v[56:59], v[32:35], a[136:139], v[56:59]
    v_mfma_f32_16x16x32_bf16 v[60:63], v[32:35], a[140:143], v[60:63]
    ds_read_b64_tr_b16 v[32:33], v10 offset:49152
    ds_read_b64_tr_b16 v[34:35], v10 offset:51200
    s_waitcnt lgkmcnt(6)
    v_mfma_f32_16x16x32_bf16 v[48:51], v[36:39], a[144:147], v[48:51]
    v_mfma_f32_16x16x32_bf16 v[52:55], v[36:39], a[148:151], v[52:55]
    v_mfma_f32_16x16x32_bf16 v[56:59], v[36:39], a[152:155], v[56:59]
    v_mfma_f32_16x16x32_bf16 v[60:63], v[36:39], a[156:159], v[60:63]
    ds_read_b64_tr_b16 v[36:37], v10 offset:53248
    ds_read_b64_tr_b16 v[38:39], v10 offset:55296
    s_waitcnt lgkmcnt(6)
    v_mfma_f32_16x16x32_bf16 v[48:51], v[40:43], a[160:163], v[48:51]
    v_mfma_f32_16x16x32_bf16 v[52:55], v[40:43], a[164:167], v[52:55]
    v_mfma_f32_16x16x32_bf16 v[56:59], v[40:43], a[168:171], v[56:59]
    v_mfma_f32_16x16x32_bf16 v[60:63], v[40:43], a[172:175], v[60:63]
    ds_read_b64_tr_b16 v[40:41], v10 offset:57344
    ds_read_b64_tr_b16 v[42:43], v10 offset:59392
    s_waitcnt lgkmcnt(6)
    v_mfma_f32_16x16x32_bf16 v[48:51], v[44:47], a[176:179], v[48:51]
    v_mfma_f32_16x16x32_bf16 v[52:55], v[44:47], a[180:183], v[52:55]
    v_mfma_f32_16x16x32_bf16 v[56:59], v[44:47], a[184:187], v[56:59]
    v_mfma_f32_16x16x32_bf16 v[60:63], v[44:47], a[188:191], v[60:63]
    ds_read_b64_tr_b16 v[44:45], v10 offset:61440
    ds_read_b64_tr_b16 v[46:47], v10 offset:63488
    s_waitcnt lgkmcnt(6)
    v_mfma_f32_16x16x32_bf16 v[48:51], v[32:35], a[192:195], v[48:51]
    v_mfma_f32_16x16x32_bf16 v[52:55], v[32:35], a[196:199], v[52:55]
    v_mfma_f32_16x16x32_bf16 v[56:59], v[32:35], a[200:203], v[56:59]
    v_mfma_f32_16x16x32_bf16 v[60:63], v[32:35], a[204:207], v[60:63]
    s_waitcnt lgkmcnt(4)
    v_mfma_f32_16x16x32_bf16 v[48:51], v[36:39], a[208:211], v[48:51]
    v_mfma_f32_16x16x32_bf16 v[52:55], v[36:39], a[212:215], v[52:55]
    v_mfma_f32_16x16x32_bf16 v[56:59], v[36:39], a[216:219], v[56:59]
    v_mfma_f32_16x16x32_bf16 v[60:63], v[36:39], a[220:223], v[60:63]
    s_waitcnt lgkmcnt(2)
    v_mfma_f32_16x16x32_bf16 v[48:51], v[40:43], a[224:227], v[48:51]
    v_mfma_f32_16x16x32_bf16 v[52:55], v[40:43], a[228:231], v[52:55]
    v_mfma_f32_16x16x32_bf16 v[56:59], v[40:43], a[232:235], v[56:59]
    v_mfma_f32_16x16x32_bf16 v[60:63], v[40:43], a[236:239], v[60:63]
    s_waitcnt lgkmcnt(0)
    v_mfma_f32_16x16x32_bf16 v[48:51], v[44:47], a[240:243], v[48:51]
    v_mfma_f32_16x16x32_bf16 v[52:55], v[44:47], a[244:247], v[52:55]
    v_mfma_f32_16x16x32_bf16 v[56:59], v[44:47], a[248:251], v[56:59]
    v_mfma_f32_16x16x32_bf16 v[60:63], v[44:47], a[252:255], v[60:63]
    s_nop 7
    s_mov_b32 s54, 49152
    v_cvt_pk_bf16_f32 v80, v48, v49
    v_cvt_pk_bf16_f32 v81, v50, v51
    v_cvt_pk_bf16_f32 v82, v52, v53
    v_cvt_pk_bf16_f32 v83, v54, v55
    buffer_store_dwordx4 v[80:83], v12, s[40:43], s54 offen offset:0 sc0 sc1
    v_cvt_pk_bf16_f32 v84, v56, v57
    v_cvt_pk_bf16_f32 v85, v58, v59
    v_cvt_pk_bf16_f32 v86, v60, v61
    v_cvt_pk_bf16_f32 v87, v62, v63
    buffer_store_dwordx4 v[84:87], v12, s[40:43], s54 offen offset:1024 sc0 sc1
K2_end:
    s_endpgm
K2_rare0:
    s_nop 7
    s_nop 7
    s_mov_b32 s53, 0x42900000
    v_max3_f32 v13, v96, v97, v98
    v_max3_f32 v13, v13, v99, v112
    v_max3_f32 v13, v13, v113, v114
    v_max_f32 v13, v13, v115
    v_mov_b32 v15, v13
    s_nop 1
    v_permlane16_swap_b32 v13, v15
    s_nop 1
    v_max_f32 v13, v13, v15
    v_mov_b32 v15, v13
    s_nop 1
    v_permlane32_swap_b32 v13, v15
    s_nop 1
    v_max_f32 v13, v13, v15
    v_add_f32 v13, s53, v13
    v_max_f32 v13, 0, v13
    v_ceil_f32 v13, v13
    v_sub_f32 v48, v48, v13
    v_sub_f32 v49, v49, v13
    v_sub_f32 v50, v50, v13
    v_sub_f32 v51, v51, v13
    v_sub_f32 v96, v96, v13
    v_sub_f32 v97, v97, v13
    v_sub_f32 v98, v98, v13
    v_sub_f32 v99, v99, v13
    v_sub_f32 v112, v112, v13
    v_sub_f32 v113, v113, v13
    v_sub_f32 v114, v114, v13
    v_sub_f32 v115, v115, v13
    v_exp_f32 v24, -v13
    s_nop 0
    v_mul_f32 v16, v16, v24
    v_mul_f32 v128, v128, v24
    v_mul_f32 v129, v129, v24
    v_mul_f32 v130, v130, v24
    v_mul_f32 v131, v131, v24
    v_mul_f32 v136, v136, v24
    v_mul_f32 v137, v137, v24
    v_mul_f32 v138, v138, v24
    v_mul_f32 v139, v139, v24
    v_mul_f32 v144, v144, v24
    v_mul_f32 v145, v145, v24
    v_mul_f32 v146, v146, v24
    v_mul_f32 v147, v147, v24
    v_mul_f32 v152, v152, v24
    v_mul_f32 v153, v153, v24
    v_mul_f32 v154, v154, v24
    v_mul_f32 v155, v155, v24
    v_mul_f32 v160, v160, v24
    v_mul_f32 v161, v161, v24
    v_mul_f32 v162, v162, v24
    v_mul_f32 v163, v163, v24
    v_mul_f32 v168, v168, v24
    v_mul_f32 v169, v169, v24
    v_mul_f32 v170, v170, v24
    v_mul_f32 v171, v171, v24
    v_mul_f32 v176, v176, v24
    v_mul_f32 v177, v177, v24
    v_mul_f32 v178, v178, v24
    v_mul_f32 v179, v179, v24
    v_mul_f32 v184, v184, v24
    v_mul_f32 v185, v185, v24
    v_mul_f32 v186, v186, v24
    v_mul_f32 v187, v187, v24
    v_mul_f32 v192, v192, v24
    v_mul_f32 v193, v193, v24
    v_mul_f32 v194, v194, v24
    v_mul_f32 v195, v195, v24
    v_mul_f32 v200, v200, v24
    v_mul_f32 v201, v201, v24
    v_mul_f32 v202, v202, v24
    v_mul_f32 v203, v203, v24
    v_mul_f32 v208, v208, v24
    v_mul_f32 v209, v209, v24
    v_mul_f32 v210, v210, v24
    v_mul_f32 v211, v211, v24
    v_mul_f32 v216, v216, v24
    v_mul_f32 v217, v217, v24
    v_mul_f32 v218, v218, v24
    v_mul_f32 v219, v219, v24
    v_mul_f32 v224, v224, v24
    v_mul_f32 v225, v225, v24
    v_mul_f32 v226, v226, v24
    v_mul_f32 v227, v227, v24
    v_mul_f32 v232, v232, v24
    v_mul_f32 v233, v233, v24
    v_mul_f32 v234, v234, v24
    v_mul_f32 v235, v235, v24
    v_mul_f32 v240, v240, v24
    v_mul_f32 v241, v241, v24
    v_mul_f32 v242, v242, v24
    v_mul_f32 v243, v243, v24
    v_mul_f32 v248, v248, v24
    v_mul_f32 v249, v249, v24
    v_mul_f32 v250, v250, v24
    v_mul_f32 v251, v251, v24
    v_max3_f32 v13, v100, v101, v102
    v_max3_f32 v13, v13, v103, v116
    v_max3_f32 v13, v13, v117, v118
    v_max_f32 v13, v13, v119
    v_mov_b32 v15, v13
    s_nop 1
    v_permlane16_swap_b32 v13, v15
    s_nop 1
    v_max_f32 v13, v13, v15
    v_mov_b32 v15, v13
    s_nop 1
    v_permlane32_swap_b32 v13, v15
    s_nop 1
    v_max_f32 v13, v13, v15
    v_add_f32 v13, s53, v13
    v_max_f32 v13, 0, v13
    v_ceil_f32 v13, v13
    v_sub_f32 v52, v52, v13
    v_sub_f32 v53, v53, v13
    v_sub_f32 v54, v54, v13
    v_sub_f32 v55, v55, v13
    v_sub_f32 v100, v100, v13
    v_sub_f32 v101, v101, v13
    v_sub_f32 v102, v102, v13
    v_sub_f32 v103, v103, v13
    v_sub_f32 v116, v116, v13
    v_sub_f32 v117, v117, v13
    v_sub_f32 v118, v118, v13
    v_sub_f32 v119, v119, v13
    v_exp_f32 v24, -v13
    s_nop 0
    v_mul_f32 v17, v17, v24
    v_mul_f32 v132, v132, v24
    v_mul_f32 v133, v133, v24
    v_mul_f32 v134, v134, v24
    v_mul_f32 v135, v135, v24
    v_mul_f32 v140, v140, v24
    v_mul_f32 v141, v141, v24
    v_mul_f32 v142, v142, v24
    v_mul_f32 v143, v143, v24
    v_mul_f32 v148, v148, v24
    v_mul_f32 v149, v149, v24
    v_mul_f32 v150, v150, v24
    v_mul_f32 v151, v151, v24
    v_mul_f32 v156, v156, v24
    v_mul_f32 v157, v157, v24
    v_mul_f32 v158, v158, v24
    v_mul_f32 v159, v159, v24
    v_mul_f32 v164, v164, v24
    v_mul_f32 v165, v165, v24
    v_mul_f32 v166, v166, v24
    v_mul_f32 v167, v167, v24
    v_mul_f32 v172, v172, v24
    v_mul_f32 v173, v173, v24
    v_mul_f32 v174, v174, v24
    v_mul_f32 v175, v175, v24
    v_mul_f32 v180, v180, v24
    v_mul_f32 v181, v181, v24
    v_mul_f32 v182, v182, v24
    v_mul_f32 v183, v183, v24
    v_mul_f32 v188, v188, v24
    v_mul_f32 v189, v189, v24
    v_mul_f32 v190, v190, v24
    v_mul_f32 v191, v191, v24
    v_mul_f32 v196, v196, v24
    v_mul_f32 v197, v197, v24
    v_mul_f32 v198, v198, v24
    v_mul_f32 v199, v199, v24
    v_mul_f32 v204, v204, v24
    v_mul_f32 v205, v205, v24
    v_mul_f32 v206, v206, v24
    v_mul_f32 v207, v207, v24
    v_mul_f32 v212, v212, v24
    v_mul_f32 v213, v213, v24
    v_mul_f32 v214, v214, v24
    v_mul_f32 v215, v215, v24
    v_mul_f32 v220, v220, v24
    v_mul_f32 v221, v221, v24
    v_mul_f32 v222, v222, v24
    v_mul_f32 v223, v223, v24
    v_mul_f32 v228, v228, v24
    v_mul_f32 v229, v229, v24
    v_mul_f32 v230, v230, v24
    v_mul_f32 v231, v231, v24
    v_mul_f32 v236, v236, v24
    v_mul_f32 v237, v237, v24
    v_mul_f32 v238, v238, v24
    v_mul_f32 v239, v239, v24
    v_mul_f32 v244, v244, v24
    v_mul_f32 v245, v245, v24
    v_mul_f32 v246, v246, v24
    v_mul_f32 v247, v247, v24
    v_mul_f32 v252, v252, v24
    v_mul_f32 v253, v253, v24
    v_mul_f32 v254, v254, v24
    v_mul_f32 v255, v255, v24
    v_max3_f32 v13, v104, v105, v106
    v_max3_f32 v13, v13, v107, v120
    v_max3_f32 v13, v13, v121, v122
    v_max_f32 v13, v13, v123
    v_mov_b32 v15, v13
    s_nop 1
    v_permlane16_swap_b32 v13, v15
    s_nop 1
    v_max_f32 v13, v13, v15
    v_mov_b32 v15, v13
    s_nop 1
    v_permlane32_swap_b32 v13, v15
    s_nop 1
    v_max_f32 v13, v13, v15
    v_add_f32 v13, s53, v13
    v_max_f32 v13, 0, v13
    v_ceil_f32 v13, v13
    v_sub_f32 v56, v56, v13
    v_sub_f32 v57, v57, v13
    v_sub_f32 v58, v58, v13
    v_sub_f32 v59, v59, v13
    v_sub_f32 v104, v104, v13
    v_sub_f32 v105, v105, v13
    v_sub_f32 v106, v106, v13
    v_sub_f32 v107, v107, v13
    v_sub_f32 v120, v120, v13
    v_sub_f32 v121, v121, v13
    v_sub_f32 v122, v122, v13
    v_sub_f32 v123, v123, v13
    v_exp_f32 v24, -v13
    s_nop 0
    v_mul_f32 v18, v18, v24
    v_accvgpr_read_b32 v25, a0
    v_accvgpr_read_b32 v26, a1
    v_accvgpr_read_b32 v27, a2
    v_accvgpr_read_b32 v28, a3
    v_mul_f32 v25, v25, v24
    v_mul_f32 v26, v26, v24
    v_mul_f32 v27, v27, v24
    v_mul_f32 v28, v28, v24
    v_accvgpr_write_b32 a0, v25
    v_accvgpr_write_b32 a1, v26
    v_accvgpr_write_b32 a2, v27
    v_accvgpr_write_b32 a3, v28
    v_accvgpr_read_b32 v25, a8
    v_accvgpr_read_b32 v26, a9
    v_accvgpr_read_b32 v27, a10
    v_accvgpr_read_b32 v28, a11
    v_mul_f32 v25, v25, v24
    v_mul_f32 v26, v26, v24
    v_mul_f32 v27, v27, v24
    v_mul_f32 v28, v28, v24
    v_accvgpr_write_b32 a8, v25
    v_accvgpr_write_b32 a9, v26
    v_accvgpr_write_b32 a10, v27
    v_accvgpr_write_b32 a11, v28
    v_accvgpr_read_b32 v25, a16
    v_accvgpr_read_b32 v26, a17
    v_accvgpr_read_b32 v27, a18
    v_accvgpr_read_b32 v28, a19
    v_mul_f32 v25, v25, v24
    v_mul_f32 v26, v26, v24
    v_mul_f32 v27, v27, v24
    v_mul_f32 v28, v28, v24
    v_accvgpr_write_b32 a16, v25
    v_accvgpr_write_b32 a17, v26
    v_accvgpr_write_b32 a18, v27
    v_accvgpr_write_b32 a19, v28
    v_accvgpr_read_b32 v25, a24
    v_accvgpr_read_b32 v26, a25
    v_accvgpr_read_b32 v27, a26
    v_accvgpr_read_b32 v28, a27
    v_mul_f32 v25, v25, v24
    v_mul_f32 v26, v26, v24
    v_mul_f32 v27, v27, v24
    v_mul_f32 v28, v28, v24
    v_accvgpr_write_b32 a24, v25
    v_accvgpr_write_b32 a25, v26
    v_accvgpr_write_b32 a26, v27
    v_accvgpr_write_b32 a27, v28
    v_accvgpr_read_b32 v25, a32
    v_accvgpr_read_b32 v26, a33
    v_accvgpr_read_b32 v27, a34
    v_accvgpr_read_b32 v28, a35
    v_mul_f32 v25, v25, v24
    v_mul_f32 v26, v26, v24
    v_mul_f32 v27, v27, v24
    v_mul_f32 v28, v28, v24
    v_accvgpr_write_b32 a32, v25
    v_accvgpr_write_b32 a33, v26
    v_accvgpr_write_b32 a34, v27
    v_accvgpr_write_b32 a35, v28
    v_accvgpr_read_b32 v25, a40
    v_accvgpr_read_b32 v26, a41
    v_accvgpr_read_b32 v27, a42
    v_accvgpr_read_b32 v28, a43
    v_mul_f32 v25, v25, v24
    v_mul_f32 v26, v26, v24
    v_mul_f32 v27, v27, v24
    v_mul_f32 v28, v28, v24
    v_accvgpr_write_b32 a40, v25
    v_accvgpr_write_b32 a41, v26
    v_accvgpr_write_b32 a42, v27
    v_accvgpr_write_b32 a43, v28
    v_accvgpr_read_b32 v25, a48
    v_accvgpr_read_b32 v26, a49
    v_accvgpr_read_b32 v27, a50
    v_accvgpr_read_b32 v28, a51
    v_mul_f32 v25, v25, v24
    v_mul_f32 v26, v26, v24
    v_mul_f32 v27, v27, v24
    v_mul_f32 v28, v28, v24
    v_accvgpr_write_b32 a48, v25
    v_accvgpr_write_b32 a49, v26
    v_accvgpr_write_b32 a50, v27
    v_accvgpr_write_b32 a51, v28
    v_accvgpr_read_b32 v25, a56
    v_accvgpr_read_b32 v26, a57
    v_accvgpr_read_b32 v27, a58
    v_accvgpr_read_b32 v28, a59
    v_mul_f32 v25, v25, v24
    v_mul_f32 v26, v26, v24
    v_mul_f32 v27, v27, v24
    v_mul_f32 v28, v28, v24
    v_accvgpr_write_b32 a56, v25
    v_accvgpr_write_b32 a57, v26
    v_accvgpr_write_b32 a58, v27
    v_accvgpr_write_b32 a59, v28
    v_accvgpr_read_b32 v25, a64
    v_accvgpr_read_b32 v26, a65
    v_accvgpr_read_b32 v27, a66
    v_accvgpr_read_b32 v28, a67
    v_mul_f32 v25, v25, v24
    v_mul_f32 v26, v26, v24
    v_mul_f32 v27, v27, v24
    v_mul_f32 v28, v28, v24
    v_accvgpr_write_b32 a64, v25
    v_accvgpr_write_b32 a65, v26
    v_accvgpr_write_b32 a66, v27
    v_accvgpr_write_b32 a67, v28
    v_accvgpr_read_b32 v25, a72
    v_accvgpr_read_b32 v26, a73
    v_accvgpr_read_b32 v27, a74
    v_accvgpr_read_b32 v28, a75
    v_mul_f32 v25, v25, v24
    v_mul_f32 v26, v26, v24
    v_mul_f32 v27, v27, v24
    v_mul_f32 v28, v28, v24
    v_accvgpr_write_b32 a72, v25
    v_accvgpr_write_b32 a73, v26
    v_accvgpr_write_b32 a74, v27
    v_accvgpr_write_b32 a75, v28
    v_accvgpr_read_b32 v25, a80
    v_accvgpr_read_b32 v26, a81
    v_accvgpr_read_b32 v27, a82
    v_accvgpr_read_b32 v28, a83
    v_mul_f32 v25, v25, v24
    v_mul_f32 v26, v26, v24
    v_mul_f32 v27, v27, v24
    v_mul_f32 v28, v28, v24
    v_accvgpr_write_b32 a80, v25
    v_accvgpr_write_b32 a81, v26
    v_accvgpr_write_b32 a82, v27
    v_accvgpr_write_b32 a83, v28
    v_accvgpr_read_b32 v25, a88
    v_accvgpr_read_b32 v26, a89
    v_accvgpr_read_b32 v27, a90
    v_accvgpr_read_b32 v28, a91
    v_mul_f32 v25, v25, v24
    v_mul_f32 v26, v26, v24
    v_mul_f32 v27, v27, v24
    v_mul_f32 v28, v28, v24
    v_accvgpr_write_b32 a88, v25
    v_accvgpr_write_b32 a89, v26
    v_accvgpr_write_b32 a90, v27
    v_accvgpr_write_b32 a91, v28
    v_accvgpr_read_b32 v25, a96
    v_accvgpr_read_b32 v26, a97
    v_accvgpr_read_b32 v27, a98
    v_accvgpr_read_b32 v28, a99
    v_mul_f32 v25, v25, v24
    v_mul_f32 v26, v26, v24
    v_mul_f32 v27, v27, v24
    v_mul_f32 v28, v28, v24
    v_accvgpr_write_b32 a96, v25
    v_accvgpr_write_b32 a97, v26
    v_accvgpr_write_b32 a98, v27
    v_accvgpr_write_b32 a99, v28
    v_accvgpr_read_b32 v25, a104
    v_accvgpr_read_b32 v26, a105
    v_accvgpr_read_b32 v27, a106
    v_accvgpr_read_b32 v28, a107
    v_mul_f32 v25, v25, v24
    v_mul_f32 v26, v26, v24
    v_mul_f32 v27, v27, v24
    v_mul_f32 v28, v28, v24
    v_accvgpr_write_b32 a104, v25
    v_accvgpr_write_b32 a105, v26
    v_accvgpr_write_b32 a106, v27
    v_accvgpr_write_b32 a107, v28
    v_accvgpr_read_b32 v25, a112
    v_accvgpr_read_b32 v26, a113
    v_accvgpr_read_b32 v27, a114
    v_accvgpr_read_b32 v28, a115
    v_mul_f32 v25, v25, v24
    v_mul_f32 v26, v26, v24
    v_mul_f32 v27, v27, v24
    v_mul_f32 v28, v28, v24
    v_accvgpr_write_b32 a112, v25
    v_accvgpr_write_b32 a113, v26
    v_accvgpr_write_b32 a114, v27
    v_accvgpr_write_b32 a115, v28
    v_accvgpr_read_b32 v25, a120
    v_accvgpr_read_b32 v26, a121
    v_accvgpr_read_b32 v27, a122
    v_accvgpr_read_b32 v28, a123
    v_mul_f32 v25, v25, v24
    v_mul_f32 v26, v26, v24
    v_mul_f32 v27, v27, v24
    v_mul_f32 v28, v28, v24
    v_accvgpr_write_b32 a120, v25
    v_accvgpr_write_b32 a121, v26
    v_accvgpr_write_b32 a122, v27
    v_accvgpr_write_b32 a123, v28
    v_max3_f32 v13, v108, v109, v110
    v_max3_f32 v13, v13, v111, v124
    v_max3_f32 v13, v13, v125, v126
    v_max_f32 v13, v13, v127
    v_mov_b32 v15, v13
    s_nop 1
    v_permlane16_swap_b32 v13, v15
    s_nop 1
    v_max_f32 v13, v13, v15
    v_mov_b32 v15, v13
    s_nop 1
    v_permlane32_swap_b32 v13, v15
    s_nop 1
    v_max_f32 v13, v13, v15
    v_add_f32 v13, s53, v13
    v_max_f32 v13, 0, v13
    v_ceil_f32 v13, v13
    v_sub_f32 v60, v60, v13
    v_sub_f32 v61, v61, v13
    v_sub_f32 v62, v62, v13
    v_sub_f32 v63, v63, v13
    v_sub_f32 v108, v108, v13
    v_sub_f32 v109, v109, v13
    v_sub_f32 v110, v110, v13
    v_sub_f32 v111, v111, v13
    v_sub_f32 v124, v124, v13
    v_sub_f32 v125, v125, v13
    v_sub_f32 v126, v126, v13
    v_sub_f32 v127, v127, v13
    v_exp_f32 v24, -v13
    s_nop 0
    v_mul_f32 v19, v19, v24
    v_accvgpr_read_b32 v25, a4
    v_accvgpr_read_b32 v26, a5
    v_accvgpr_read_b32 v27, a6
    v_accvgpr_read_b32 v28, a7
    v_mul_f32 v25, v25, v24
    v_mul_f32 v26, v26, v24
    v_mul_f32 v27, v27, v24
    v_mul_f32 v28, v28, v24
    v_accvgpr_write_b32 a4, v25
    v_accvgpr_write_b32 a5, v26
    v_accvgpr_write_b32 a6, v27
    v_accvgpr_write_b32 a7, v28
    v_accvgpr_read_b32 v25, a12
    v_accvgpr_read_b32 v26, a13
    v_accvgpr_read_b32 v27, a14
    v_accvgpr_read_b32 v28, a15
    v_mul_f32 v25, v25, v24
    v_mul_f32 v26, v26, v24
    v_mul_f32 v27, v27, v24
    v_mul_f32 v28, v28, v24
    v_accvgpr_write_b32 a12, v25
    v_accvgpr_write_b32 a13, v26
    v_accvgpr_write_b32 a14, v27
    v_accvgpr_write_b32 a15, v28
    v_accvgpr_read_b32 v25, a20
    v_accvgpr_read_b32 v26, a21
    v_accvgpr_read_b32 v27, a22
    v_accvgpr_read_b32 v28, a23
    v_mul_f32 v25, v25, v24
    v_mul_f32 v26, v26, v24
    v_mul_f32 v27, v27, v24
    v_mul_f32 v28, v28, v24
    v_accvgpr_write_b32 a20, v25
    v_accvgpr_write_b32 a21, v26
    v_accvgpr_write_b32 a22, v27
    v_accvgpr_write_b32 a23, v28
    v_accvgpr_read_b32 v25, a28
    v_accvgpr_read_b32 v26, a29
    v_accvgpr_read_b32 v27, a30
    v_accvgpr_read_b32 v28, a31
    v_mul_f32 v25, v25, v24
    v_mul_f32 v26, v26, v24
    v_mul_f32 v27, v27, v24
    v_mul_f32 v28, v28, v24
    v_accvgpr_write_b32 a28, v25
    v_accvgpr_write_b32 a29, v26
    v_accvgpr_write_b32 a30, v27
    v_accvgpr_write_b32 a31, v28
    v_accvgpr_read_b32 v25, a36
    v_accvgpr_read_b32 v26, a37
    v_accvgpr_read_b32 v27, a38
    v_accvgpr_read_b32 v28, a39
    v_mul_f32 v25, v25, v24
    v_mul_f32 v26, v26, v24
    v_mul_f32 v27, v27, v24
    v_mul_f32 v28, v28, v24
    v_accvgpr_write_b32 a36, v25
    v_accvgpr_write_b32 a37, v26
    v_accvgpr_write_b32 a38, v27
    v_accvgpr_write_b32 a39, v28
    v_accvgpr_read_b32 v25, a44
    v_accvgpr_read_b32 v26, a45
    v_accvgpr_read_b32 v27, a46
    v_accvgpr_read_b32 v28, a47
    v_mul_f32 v25, v25, v24
    v_mul_f32 v26, v26, v24
    v_mul_f32 v27, v27, v24
    v_mul_f32 v28, v28, v24
    v_accvgpr_write_b32 a44, v25
    v_accvgpr_write_b32 a45, v26
    v_accvgpr_write_b32 a46, v27
    v_accvgpr_write_b32 a47, v28
    v_accvgpr_read_b32 v25, a52
    v_accvgpr_read_b32 v26, a53
    v_accvgpr_read_b32 v27, a54
    v_accvgpr_read_b32 v28, a55
    v_mul_f32 v25, v25, v24
    v_mul_f32 v26, v26, v24
    v_mul_f32 v27, v27, v24
    v_mul_f32 v28, v28, v24
    v_accvgpr_write_b32 a52, v25
    v_accvgpr_write_b32 a53, v26
    v_accvgpr_write_b32 a54, v27
    v_accvgpr_write_b32 a55, v28
    v_accvgpr_read_b32 v25, a60
    v_accvgpr_read_b32 v26, a61
    v_accvgpr_read_b32 v27, a62
    v_accvgpr_read_b32 v28, a63
    v_mul_f32 v25, v25, v24
    v_mul_f32 v26, v26, v24
    v_mul_f32 v27, v27, v24
    v_mul_f32 v28, v28, v24
    v_accvgpr_write_b32 a60, v25
    v_accvgpr_write_b32 a61, v26
    v_accvgpr_write_b32 a62, v27
    v_accvgpr_write_b32 a63, v28
    v_accvgpr_read_b32 v25, a68
    v_accvgpr_read_b32 v26, a69
    v_accvgpr_read_b32 v27, a70
    v_accvgpr_read_b32 v28, a71
    v_mul_f32 v25, v25, v24
    v_mul_f32 v26, v26, v24
    v_mul_f32 v27, v27, v24
    v_mul_f32 v28, v28, v24
    v_accvgpr_write_b32 a68, v25
    v_accvgpr_write_b32 a69, v26
    v_accvgpr_write_b32 a70, v27
    v_accvgpr_write_b32 a71, v28
    v_accvgpr_read_b32 v25, a76
    v_accvgpr_read_b32 v26, a77
    v_accvgpr_read_b32 v27, a78
    v_accvgpr_read_b32 v28, a79
    v_mul_f32 v25, v25, v24
    v_mul_f32 v26, v26, v24
    v_mul_f32 v27, v27, v24
    v_mul_f32 v28, v28, v24
    v_accvgpr_write_b32 a76, v25
    v_accvgpr_write_b32 a77, v26
    v_accvgpr_write_b32 a78, v27
    v_accvgpr_write_b32 a79, v28
    v_accvgpr_read_b32 v25, a84
    v_accvgpr_read_b32 v26, a85
    v_accvgpr_read_b32 v27, a86
    v_accvgpr_read_b32 v28, a87
    v_mul_f32 v25, v25, v24
    v_mul_f32 v26, v26, v24
    v_mul_f32 v27, v27, v24
    v_mul_f32 v28, v28, v24
    v_accvgpr_write_b32 a84, v25
    v_accvgpr_write_b32 a85, v26
    v_accvgpr_write_b32 a86, v27
    v_accvgpr_write_b32 a87, v28
    v_accvgpr_read_b32 v25, a92
    v_accvgpr_read_b32 v26, a93
    v_accvgpr_read_b32 v27, a94
    v_accvgpr_read_b32 v28, a95
    v_mul_f32 v25, v25, v24
    v_mul_f32 v26, v26, v24
    v_mul_f32 v27, v27, v24
    v_mul_f32 v28, v28, v24
    v_accvgpr_write_b32 a92, v25
    v_accvgpr_write_b32 a93, v26
    v_accvgpr_write_b32 a94, v27
    v_accvgpr_write_b32 a95, v28
    v_accvgpr_read_b32 v25, a100
    v_accvgpr_read_b32 v26, a101
    v_accvgpr_read_b32 v27, a102
    v_accvgpr_read_b32 v28, a103
    v_mul_f32 v25, v25, v24
    v_mul_f32 v26, v26, v24
    v_mul_f32 v27, v27, v24
    v_mul_f32 v28, v28, v24
    v_accvgpr_write_b32 a100, v25
    v_accvgpr_write_b32 a101, v26
    v_accvgpr_write_b32 a102, v27
    v_accvgpr_write_b32 a103, v28
    v_accvgpr_read_b32 v25, a108
    v_accvgpr_read_b32 v26, a109
    v_accvgpr_read_b32 v27, a110
    v_accvgpr_read_b32 v28, a111
    v_mul_f32 v25, v25, v24
    v_mul_f32 v26, v26, v24
    v_mul_f32 v27, v27, v24
    v_mul_f32 v28, v28, v24
    v_accvgpr_write_b32 a108, v25
    v_accvgpr_write_b32 a109, v26
    v_accvgpr_write_b32 a110, v27
    v_accvgpr_write_b32 a111, v28
    v_accvgpr_read_b32 v25, a116
    v_accvgpr_read_b32 v26, a117
    v_accvgpr_read_b32 v27, a118
    v_accvgpr_read_b32 v28, a119
    v_mul_f32 v25, v25, v24
    v_mul_f32 v26, v26, v24
    v_mul_f32 v27, v27, v24
    v_mul_f32 v28, v28, v24
    v_accvgpr_write_b32 a116, v25
    v_accvgpr_write_b32 a117, v26
    v_accvgpr_write_b32 a118, v27
    v_accvgpr_write_b32 a119, v28
    v_accvgpr_read_b32 v25, a124
    v_accvgpr_read_b32 v26, a125
    v_accvgpr_read_b32 v27, a126
    v_accvgpr_read_b32 v28, a127
    v_mul_f32 v25, v25, v24
    v_mul_f32 v26, v26, v24
    v_mul_f32 v27, v27, v24
    v_mul_f32 v28, v28, v24
    v_accvgpr_write_b32 a124, v25
    v_accvgpr_write_b32 a125, v26
    v_accvgpr_write_b32 a126, v27
    v_accvgpr_write_b32 a127, v28
    v_exp_f32 v24, v96
    v_exp_f32 v25, v97
    v_exp_f32 v26, v98
    v_exp_f32 v27, v99
    v_exp_f32 v28, v112
    v_exp_f32 v29, v113
    v_exp_f32 v30, v114
    v_exp_f32 v31, v115
    s_nop 0
    v_add_f32 v20, v24, v25
    v_add_f32 v20, v20, v26
    v_add_f32 v20, v20, v27
    v_add_f32 v20, v20, v28
    v_add_f32 v20, v20, v29
    v_add_f32 v20, v20, v30
    v_add_f32 v20, v20, v31
    v_cvt_pk_bf16_f32 v64, v24, v25
    v_cvt_pk_bf16_f32 v65, v26, v27
    v_cvt_pk_bf16_f32 v66, v28, v29
    v_cvt_pk_bf16_f32 v67, v30, v31
    v_exp_f32 v24, v100
    v_exp_f32 v25, v101
    v_exp_f32 v26, v102
    v_exp_f32 v27, v103
    v_exp_f32 v28, v116
    v_exp_f32 v29, v117
    v_exp_f32 v30, v118
    v_exp_f32 v31, v119
    s_nop 0
    v_add_f32 v21, v24, v25
    v_add_f32 v21, v21, v26
    v_add_f32 v21, v21, v27
    v_add_f32 v21, v21, v28
    v_add_f32 v21, v21, v29
    v_add_f32 v21, v21, v30
    v_add_f32 v21, v21, v31
    v_cvt_pk_bf16_f32 v68, v24, v25
    v_cvt_pk_bf16_f32 v69, v26, v27
    v_cvt_pk_bf16_f32 v70, v28, v29
    v_cvt_pk_bf16_f32 v71, v30, v31
    v_exp_f32 v24, v104
    v_exp_f32 v25, v105
    v_exp_f32 v26, v106
    v_exp_f32 v27, v107
    v_exp_f32 v28, v120
    v_exp_f32 v29, v121
    v_exp_f32 v30, v122
    v_exp_f32 v31, v123
    s_nop 0
    v_add_f32 v22, v24, v25
    v_add_f32 v22, v22, v26
    v_add_f32 v22, v22, v27
    v_add_f32 v22, v22, v28
    v_add_f32 v22, v22, v29
    v_add_f32 v22, v22, v30
    v_add_f32 v22, v22, v31
    v_cvt_pk_bf16_f32 v72, v24, v25
    v_cvt_pk_bf16_f32 v73, v26, v27
    v_cvt_pk_bf16_f32 v74, v28, v29
    v_cvt_pk_bf16_f32 v75, v30, v31
    v_exp_f32 v24, v108
    v_exp_f32 v25, v109
    v_exp_f32 v26, v110
    v_exp_f32 v27, v111
    v_exp_f32 v28, v124
    v_exp_f32 v29, v125
    v_exp_f32 v30, v126
    v_exp_f32 v31, v127
    s_nop 0
    v_add_f32 v23, v24, v25
    v_add_f32 v23, v23, v26
    v_add_f32 v23, v23, v27
    v_add_f32 v23, v23, v28
    v_add_f32 v23, v23, v29
    v_add_f32 v23, v23, v30
    v_add_f32 v23, v23, v31
    v_cvt_pk_bf16_f32 v76, v24, v25
    v_cvt_pk_bf16_f32 v77, v26, v27
    v_cvt_pk_bf16_f32 v78, v28, v29
    v_cvt_pk_bf16_f32 v79, v30, v31
    s_nop 1
    s_cmp_eq_u32 s66, 1
    s_cbranch_scc1 K2_ret1
    s_endpgm
K2_rare1:
    s_nop 7
    s_nop 7
    s_mov_b32 s53, 0x42900000
    v_max3_f32 v13, v96, v97, v98
    v_max3_f32 v13, v13, v99, v112
    v_max3_f32 v13, v13, v113, v114
    v_max_f32 v13, v13, v115
    v_mov_b32 v15, v13
    s_nop 1
    v_permlane16_swap_b32 v13, v15
    s_nop 1
    v_max_f32 v13, v13, v15
    v_mov_b32 v15, v13
    s_nop 1
    v_permlane32_swap_b32 v13, v15
    s_nop 1
    v_max_f32 v13, v13, v15
    v_add_f32 v13, s53, v13
    v_max_f32 v13, 0, v13
    v_ceil_f32 v13, v13
    v_sub_f32 v48, v48, v13
    v_sub_f32 v49, v49, v13
    v_sub_f32 v50, v50, v13
    v_sub_f32 v51, v51, v13
    v_sub_f32 v96, v96, v13
    v_sub_f32 v97, v97, v13
    v_sub_f32 v98, v98, v13
    v_sub_f32 v99, v99, v13
    v_sub_f32 v112, v112, v13
    v_sub_f32 v113, v113, v13
    v_sub_f32 v114, v114, v13
    v_sub_f32 v115, v115, v13
    v_exp_f32 v24, -v13
    s_nop 0
    v_mul_f32 v16, v16, v24
    v_mul_f32 v128, v128, v24
    v_mul_f32 v129, v129, v24
    v_mul_f32 v130, v130, v24
    v_mul_f32 v131, v131, v24
    v_mul_f32 v136, v136, v24
    v_mul_f32 v137, v137, v24
    v_mul_f32 v138, v138, v24
    v_mul_f32 v139, v139, v24
    v_mul_f32 v144, v144, v24
    v_mul_f32 v145, v145, v24
    v_mul_f32 v146, v146, v24
    v_mul_f32 v147, v147, v24
    v_mul_f32 v152, v152, v24
    v_mul_f32 v153, v153, v24
    v_mul_f32 v154, v154, v24
    v_mul_f32 v155, v155, v24
    v_mul_f32 v160, v160, v24
    v_mul_f32 v161, v161, v24
    v_mul_f32 v162, v162, v24
    v_mul_f32 v163, v163, v24
    v_mul_f32 v168, v168, v24
    v_mul_f32 v169, v169, v24
    v_mul_f32 v170, v170, v24
    v_mul_f32 v171, v171, v24
    v_mul_f32 v176, v176, v24
    v_mul_f32 v177, v177, v24
    v_mul_f32 v178, v178, v24
    v_mul_f32 v179, v179, v24
    v_mul_f32 v184, v184, v24
    v_mul_f32 v185, v185, v24
    v_mul_f32 v186, v186, v24
    v_mul_f32 v187, v187, v24
    v_mul_f32 v192, v192, v24
    v_mul_f32 v193, v193, v24
    v_mul_f32 v194, v194, v24
    v_mul_f32 v195, v195, v24
    v_mul_f32 v200, v200, v24
    v_mul_f32 v201, v201, v24
    v_mul_f32 v202, v202, v24
    v_mul_f32 v203, v203, v24
    v_mul_f32 v208, v208, v24
    v_mul_f32 v209, v209, v24
    v_mul_f32 v210, v210, v24
    v_mul_f32 v211, v211, v24
    v_mul_f32 v216, v216, v24
    v_mul_f32 v217, v217, v24
    v_mul_f32 v218, v218, v24
    v_mul_f32 v219, v219, v24
    v_mul_f32 v224, v224, v24
    v_mul_f32 v225, v225, v24
    v_mul_f32 v226, v226, v24
    v_mul_f32 v227, v227, v24
    v_mul_f32 v232, v232, v24
    v_mul_f32 v233, v233, v24
    v_mul_f32 v234, v234, v24
    v_mul_f32 v235, v235, v24
    v_mul_f32 v240, v240, v24
    v_mul_f32 v241, v241, v24
    v_mul_f32 v242, v242, v24
    v_mul_f32 v243, v243, v24
    v_mul_f32 v248, v248, v24
    v_mul_f32 v249, v249, v24
    v_mul_f32 v250, v250, v24
    v_mul_f32 v251, v251, v24
    v_max3_f32 v13, v100, v101, v102
    v_max3_f32 v13, v13, v103, v116
    v_max3_f32 v13, v13, v117, v118
    v_max_f32 v13, v13, v119
    v_mov_b32 v15, v13
    s_nop 1
    v_permlane16_swap_b32 v13, v15
    s_nop 1
    v_max_f32 v13, v13, v15
    v_mov_b32 v15, v13
    s_nop 1
    v_permlane32_swap_b32 v13, v15
    s_nop 1
    v_max_f32 v13, v13, v15
    v_add_f32 v13, s53, v13
    v_max_f32 v13, 0, v13
    v_ceil_f32 v13, v13
    v_sub_f32 v52, v52, v13
    v_sub_f32 v53, v53, v13
    v_sub_f32 v54, v54, v13
    v_sub_f32 v55, v55, v13
    v_sub_f32 v100, v100, v13
    v_sub_f32 v101, v101, v13
    v_sub_f32 v102, v102, v13
    v_sub_f32 v103, v103, v13
    v_sub_f32 v116, v116, v13
    v_sub_f32 v117, v117, v13
    v_sub_f32 v118, v118, v13
    v_sub_f32 v119, v119, v13
    v_exp_f32 v24, -v13
    s_nop 0
    v_mul_f32 v17, v17, v24
    v_mul_f32 v132, v132, v24
    v_mul_f32 v133, v133, v24
    v_mul_f32 v134, v134, v24
    v_mul_f32 v135, v135, v24
    v_mul_f32 v140, v140, v24
    v_mul_f32 v141, v141, v24
    v_mul_f32 v142, v142, v24
    v_mul_f32 v143, v143, v24
    v_mul_f32 v148, v148, v24
    v_mul_f32 v149, v149, v24
    v_mul_f32 v150, v150, v24
    v_mul_f32 v151, v151, v24
    v_mul_f32 v156, v156, v24
    v_mul_f32 v157, v157, v24
    v_mul_f32 v158, v158, v24
    v_mul_f32 v159, v159, v24
    v_mul_f32 v164, v164, v24
    v_mul_f32 v165, v165, v24
    v_mul_f32 v166, v166, v24
    v_mul_f32 v167, v167, v24
    v_mul_f32 v172, v172, v24
    v_mul_f32 v173, v173, v24
    v_mul_f32 v174, v174, v24
    v_mul_f32 v175, v175, v24
    v_mul_f32 v180, v180, v24
    v_mul_f32 v181, v181, v24
    v_mul_f32 v182, v182, v24
    v_mul_f32 v183, v183, v24
    v_mul_f32 v188, v188, v24
    v_mul_f32 v189, v189, v24
    v_mul_f32 v190, v190, v24
    v_mul_f32 v191, v191, v24
    v_mul_f32 v196, v196, v24
    v_mul_f32 v197, v197, v24
    v_mul_f32 v198, v198, v24
    v_mul_f32 v199, v199, v24
    v_mul_f32 v204, v204, v24
    v_mul_f32 v205, v205, v24
    v_mul_f32 v206, v206, v24
    v_mul_f32 v207, v207, v24
    v_mul_f32 v212, v212, v24
    v_mul_f32 v213, v213, v24
    v_mul_f32 v214, v214, v24
    v_mul_f32 v215, v215, v24
    v_mul_f32 v220, v220, v24
    v_mul_f32 v221, v221, v24
    v_mul_f32 v222, v222, v24
    v_mul_f32 v223, v223, v24
    v_mul_f32 v228, v228, v24
    v_mul_f32 v229, v229, v24
    v_mul_f32 v230, v230, v24
    v_mul_f32 v231, v231, v24
    v_mul_f32 v236, v236, v24
    v_mul_f32 v237, v237, v24
    v_mul_f32 v238, v238, v24
    v_mul_f32 v239, v239, v24
    v_mul_f32 v244, v244, v24
    v_mul_f32 v245, v245, v24
    v_mul_f32 v246, v246, v24
    v_mul_f32 v247, v247, v24
    v_mul_f32 v252, v252, v24
    v_mul_f32 v253, v253, v24
    v_mul_f32 v254, v254, v24
    v_mul_f32 v255, v255, v24
    v_max3_f32 v13, v104, v105, v106
    v_max3_f32 v13, v13, v107, v120
    v_max3_f32 v13, v13, v121, v122
    v_max_f32 v13, v13, v123
    v_mov_b32 v15, v13
    s_nop 1
    v_permlane16_swap_b32 v13, v15
    s_nop 1
    v_max_f32 v13, v13, v15
    v_mov_b32 v15, v13
    s_nop 1
    v_permlane32_swap_b32 v13, v15
    s_nop 1
    v_max_f32 v13, v13, v15
    v_add_f32 v13, s53, v13
    v_max_f32 v13, 0, v13
    v_ceil_f32 v13, v13
    v_sub_f32 v56, v56, v13
    v_sub_f32 v57, v57, v13
    v_sub_f32 v58, v58, v13
    v_sub_f32 v59, v59, v13
    v_sub_f32 v104, v104, v13
    v_sub_f32 v105, v105, v13
    v_sub_f32 v106, v106, v13
    v_sub_f32 v107, v107, v13
    v_sub_f32 v120, v120, v13
    v_sub_f32 v121, v121, v13
    v_sub_f32 v122, v122, v13
    v_sub_f32 v123, v123, v13
    v_exp_f32 v24, -v13
    s_nop 0
    v_mul_f32 v18, v18, v24
    v_accvgpr_read_b32 v25, a0
    v_accvgpr_read_b32 v26, a1
    v_accvgpr_read_b32 v27, a2
    v_accvgpr_read_b32 v28, a3
    v_mul_f32 v25, v25, v24
    v_mul_f32 v26, v26, v24
    v_mul_f32 v27, v27, v24
    v_mul_f32 v28, v28, v24
    v_accvgpr_write_b32 a0, v25
    v_accvgpr_write_b32 a1, v26
    v_accvgpr_write_b32 a2, v27
    v_accvgpr_write_b32 a3, v28
    v_accvgpr_read_b32 v25, a8
    v_accvgpr_read_b32 v26, a9
    v_accvgpr_read_b32 v27, a10
    v_accvgpr_read_b32 v28, a11
    v_mul_f32 v25, v25, v24
    v_mul_f32 v26, v26, v24
    v_mul_f32 v27, v27, v24
    v_mul_f32 v28, v28, v24
    v_accvgpr_write_b32 a8, v25
    v_accvgpr_write_b32 a9, v26
    v_accvgpr_write_b32 a10, v27
    v_accvgpr_write_b32 a11, v28
    v_accvgpr_read_b32 v25, a16
    v_accvgpr_read_b32 v26, a17
    v_accvgpr_read_b32 v27, a18
    v_accvgpr_read_b32 v28, a19
    v_mul_f32 v25, v25, v24
    v_mul_f32 v26, v26, v24
    v_mul_f32 v27, v27, v24
    v_mul_f32 v28, v28, v24
    v_accvgpr_write_b32 a16, v25
    v_accvgpr_write_b32 a17, v26
    v_accvgpr_write_b32 a18, v27
    v_accvgpr_write_b32 a19, v28
    v_accvgpr_read_b32 v25, a24
    v_accvgpr_read_b32 v26, a25
    v_accvgpr_read_b32 v27, a26
    v_accvgpr_read_b32 v28, a27
    v_mul_f32 v25, v25, v24
    v_mul_f32 v26, v26, v24
    v_mul_f32 v27, v27, v24
    v_mul_f32 v28, v28, v24
    v_accvgpr_write_b32 a24, v25
    v_accvgpr_write_b32 a25, v26
    v_accvgpr_write_b32 a26, v27
    v_accvgpr_write_b32 a27, v28
    v_accvgpr_read_b32 v25, a32
    v_accvgpr_read_b32 v26, a33
    v_accvgpr_read_b32 v27, a34
    v_accvgpr_read_b32 v28, a35
    v_mul_f32 v25, v25, v24
    v_mul_f32 v26, v26, v24
    v_mul_f32 v27, v27, v24
    v_mul_f32 v28, v28, v24
    v_accvgpr_write_b32 a32, v25
    v_accvgpr_write_b32 a33, v26
    v_accvgpr_write_b32 a34, v27
    v_accvgpr_write_b32 a35, v28
    v_accvgpr_read_b32 v25, a40
    v_accvgpr_read_b32 v26, a41
    v_accvgpr_read_b32 v27, a42
    v_accvgpr_read_b32 v28, a43
    v_mul_f32 v25, v25, v24
    v_mul_f32 v26, v26, v24
    v_mul_f32 v27, v27, v24
    v_mul_f32 v28, v28, v24
    v_accvgpr_write_b32 a40, v25
    v_accvgpr_write_b32 a41, v26
    v_accvgpr_write_b32 a42, v27
    v_accvgpr_write_b32 a43, v28
    v_accvgpr_read_b32 v25, a48
    v_accvgpr_read_b32 v26, a49
    v_accvgpr_read_b32 v27, a50
    v_accvgpr_read_b32 v28, a51
    v_mul_f32 v25, v25, v24
    v_mul_f32 v26, v26, v24
    v_mul_f32 v27, v27, v24
    v_mul_f32 v28, v28, v24
    v_accvgpr_write_b32 a48, v25
    v_accvgpr_write_b32 a49, v26
    v_accvgpr_write_b32 a50, v27
    v_accvgpr_write_b32 a51, v28
    v_accvgpr_read_b32 v25, a56
    v_accvgpr_read_b32 v26, a57
    v_accvgpr_read_b32 v27, a58
    v_accvgpr_read_b32 v28, a59
    v_mul_f32 v25, v25, v24
    v_mul_f32 v26, v26, v24
    v_mul_f32 v27, v27, v24
    v_mul_f32 v28, v28, v24
    v_accvgpr_write_b32 a56, v25
    v_accvgpr_write_b32 a57, v26
    v_accvgpr_write_b32 a58, v27
    v_accvgpr_write_b32 a59, v28
    v_accvgpr_read_b32 v25, a64
    v_accvgpr_read_b32 v26, a65
    v_accvgpr_read_b32 v27, a66
    v_accvgpr_read_b32 v28, a67
    v_mul_f32 v25, v25, v24
    v_mul_f32 v26, v26, v24
    v_mul_f32 v27, v27, v24
    v_mul_f32 v28, v28, v24
    v_accvgpr_write_b32 a64, v25
    v_accvgpr_write_b32 a65, v26
    v_accvgpr_write_b32 a66, v27
    v_accvgpr_write_b32 a67, v28
    v_accvgpr_read_b32 v25, a72
    v_accvgpr_read_b32 v26, a73
    v_accvgpr_read_b32 v27, a74
    v_accvgpr_read_b32 v28, a75
    v_mul_f32 v25, v25, v24
    v_mul_f32 v26, v26, v24
    v_mul_f32 v27, v27, v24
    v_mul_f32 v28, v28, v24
    v_accvgpr_write_b32 a72, v25
    v_accvgpr_write_b32 a73, v26
    v_accvgpr_write_b32 a74, v27
    v_accvgpr_write_b32 a75, v28
    v_accvgpr_read_b32 v25, a80
    v_accvgpr_read_b32 v26, a81
    v_accvgpr_read_b32 v27, a82
    v_accvgpr_read_b32 v28, a83
    v_mul_f32 v25, v25, v24
    v_mul_f32 v26, v26, v24
    v_mul_f32 v27, v27, v24
    v_mul_f32 v28, v28, v24
    v_accvgpr_write_b32 a80, v25
    v_accvgpr_write_b32 a81, v26
    v_accvgpr_write_b32 a82, v27
    v_accvgpr_write_b32 a83, v28
    v_accvgpr_read_b32 v25, a88
    v_accvgpr_read_b32 v26, a89
    v_accvgpr_read_b32 v27, a90
    v_accvgpr_read_b32 v28, a91
    v_mul_f32 v25, v25, v24
    v_mul_f32 v26, v26, v24
    v_mul_f32 v27, v27, v24
    v_mul_f32 v28, v28, v24
    v_accvgpr_write_b32 a88, v25
    v_accvgpr_write_b32 a89, v26
    v_accvgpr_write_b32 a90, v27
    v_accvgpr_write_b32 a91, v28
    v_accvgpr_read_b32 v25, a96
    v_accvgpr_read_b32 v26, a97
    v_accvgpr_read_b32 v27, a98
    v_accvgpr_read_b32 v28, a99
    v_mul_f32 v25, v25, v24
    v_mul_f32 v26, v26, v24
    v_mul_f32 v27, v27, v24
    v_mul_f32 v28, v28, v24
    v_accvgpr_write_b32 a96, v25
    v_accvgpr_write_b32 a97, v26
    v_accvgpr_write_b32 a98, v27
    v_accvgpr_write_b32 a99, v28
    v_accvgpr_read_b32 v25, a104
    v_accvgpr_read_b32 v26, a105
    v_accvgpr_read_b32 v27, a106
    v_accvgpr_read_b32 v28, a107
    v_mul_f32 v25, v25, v24
    v_mul_f32 v26, v26, v24
    v_mul_f32 v27, v27, v24
    v_mul_f32 v28, v28, v24
    v_accvgpr_write_b32 a104, v25
    v_accvgpr_write_b32 a105, v26
    v_accvgpr_write_b32 a106, v27
    v_accvgpr_write_b32 a107, v28
    v_accvgpr_read_b32 v25, a112
    v_accvgpr_read_b32 v26, a113
    v_accvgpr_read_b32 v27, a114
    v_accvgpr_read_b32 v28, a115
    v_mul_f32 v25, v25, v24
    v_mul_f32 v26, v26, v24
    v_mul_f32 v27, v27, v24
    v_mul_f32 v28, v28, v24
    v_accvgpr_write_b32 a112, v25
    v_accvgpr_write_b32 a113, v26
    v_accvgpr_write_b32 a114, v27
    v_accvgpr_write_b32 a115, v28
    v_accvgpr_read_b32 v25, a120
    v_accvgpr_read_b32 v26, a121
    v_accvgpr_read_b32 v27, a122
    v_accvgpr_read_b32 v28, a123
    v_mul_f32 v25, v25, v24
    v_mul_f32 v26, v26, v24
    v_mul_f32 v27, v27, v24
    v_mul_f32 v28, v28, v24
    v_accvgpr_write_b32 a120, v25
    v_accvgpr_write_b32 a121, v26
    v_accvgpr_write_b32 a122, v27
    v_accvgpr_write_b32 a123, v28
    v_max3_f32 v13, v108, v109, v110
    v_max3_f32 v13, v13, v111, v124
    v_max3_f32 v13, v13, v125, v126
    v_max_f32 v13, v13, v127
    v_mov_b32 v15, v13
    s_nop 1
    v_permlane16_swap_b32 v13, v15
    s_nop 1
    v_max_f32 v13, v13, v15
    v_mov_b32 v15, v13
    s_nop 1
    v_permlane32_swap_b32 v13, v15
    s_nop 1
    v_max_f32 v13, v13, v15
    v_add_f32 v13, s53, v13
    v_max_f32 v13, 0, v13
    v_ceil_f32 v13, v13
    v_sub_f32 v60, v60, v13
    v_sub_f32 v61, v61, v13
    v_sub_f32 v62, v62, v13
    v_sub_f32 v63, v63, v13
    v_sub_f32 v108, v108, v13
    v_sub_f32 v109, v109, v13
    v_sub_f32 v110, v110, v13
    v_sub_f32 v111, v111, v13
    v_sub_f32 v124, v124, v13
    v_sub_f32 v125, v125, v13
    v_sub_f32 v126, v126, v13
    v_sub_f32 v127, v127, v13
    v_exp_f32 v24, -v13
    s_nop 0
    v_mul_f32 v19, v19, v24
    v_accvgpr_read_b32 v25, a4
    v_accvgpr_read_b32 v26, a5
    v_accvgpr_read_b32 v27, a6
    v_accvgpr_read_b32 v28, a7
    v_mul_f32 v25, v25, v24
    v_mul_f32 v26, v26, v24
    v_mul_f32 v27, v27, v24
    v_mul_f32 v28, v28, v24
    v_accvgpr_write_b32 a4, v25
    v_accvgpr_write_b32 a5, v26
    v_accvgpr_write_b32 a6, v27
    v_accvgpr_write_b32 a7, v28
    v_accvgpr_read_b32 v25, a12
    v_accvgpr_read_b32 v26, a13
    v_accvgpr_read_b32 v27, a14
    v_accvgpr_read_b32 v28, a15
    v_mul_f32 v25, v25, v24
    v_mul_f32 v26, v26, v24
    v_mul_f32 v27, v27, v24
    v_mul_f32 v28, v28, v24
    v_accvgpr_write_b32 a12, v25
    v_accvgpr_write_b32 a13, v26
    v_accvgpr_write_b32 a14, v27
    v_accvgpr_write_b32 a15, v28
    v_accvgpr_read_b32 v25, a20
    v_accvgpr_read_b32 v26, a21
    v_accvgpr_read_b32 v27, a22
    v_accvgpr_read_b32 v28, a23
    v_mul_f32 v25, v25, v24
    v_mul_f32 v26, v26, v24
    v_mul_f32 v27, v27, v24
    v_mul_f32 v28, v28, v24
    v_accvgpr_write_b32 a20, v25
    v_accvgpr_write_b32 a21, v26
    v_accvgpr_write_b32 a22, v27
    v_accvgpr_write_b32 a23, v28
    v_accvgpr_read_b32 v25, a28
    v_accvgpr_read_b32 v26, a29
    v_accvgpr_read_b32 v27, a30
    v_accvgpr_read_b32 v28, a31
    v_mul_f32 v25, v25, v24
    v_mul_f32 v26, v26, v24
    v_mul_f32 v27, v27, v24
    v_mul_f32 v28, v28, v24
    v_accvgpr_write_b32 a28, v25
    v_accvgpr_write_b32 a29, v26
    v_accvgpr_write_b32 a30, v27
    v_accvgpr_write_b32 a31, v28
    v_accvgpr_read_b32 v25, a36
    v_accvgpr_read_b32 v26, a37
    v_accvgpr_read_b32 v27, a38
    v_accvgpr_read_b32 v28, a39
    v_mul_f32 v25, v25, v24
    v_mul_f32 v26, v26, v24
    v_mul_f32 v27, v27, v24
    v_mul_f32 v28, v28, v24
    v_accvgpr_write_b32 a36, v25
    v_accvgpr_write_b32 a37, v26
    v_accvgpr_write_b32 a38, v27
    v_accvgpr_write_b32 a39, v28
    v_accvgpr_read_b32 v25, a44
    v_accvgpr_read_b32 v26, a45
    v_accvgpr_read_b32 v27, a46
    v_accvgpr_read_b32 v28, a47
    v_mul_f32 v25, v25, v24
    v_mul_f32 v26, v26, v24
    v_mul_f32 v27, v27, v24
    v_mul_f32 v28, v28, v24
    v_accvgpr_write_b32 a44, v25
    v_accvgpr_write_b32 a45, v26
    v_accvgpr_write_b32 a46, v27
    v_accvgpr_write_b32 a47, v28
    v_accvgpr_read_b32 v25, a52
    v_accvgpr_read_b32 v26, a53
    v_accvgpr_read_b32 v27, a54
    v_accvgpr_read_b32 v28, a55
    v_mul_f32 v25, v25, v24
    v_mul_f32 v26, v26, v24
    v_mul_f32 v27, v27, v24
    v_mul_f32 v28, v28, v24
    v_accvgpr_write_b32 a52, v25
    v_accvgpr_write_b32 a53, v26
    v_accvgpr_write_b32 a54, v27
    v_accvgpr_write_b32 a55, v28
    v_accvgpr_read_b32 v25, a60
    v_accvgpr_read_b32 v26, a61
    v_accvgpr_read_b32 v27, a62
    v_accvgpr_read_b32 v28, a63
    v_mul_f32 v25, v25, v24
    v_mul_f32 v26, v26, v24
    v_mul_f32 v27, v27, v24
    v_mul_f32 v28, v28, v24
    v_accvgpr_write_b32 a60, v25
    v_accvgpr_write_b32 a61, v26
    v_accvgpr_write_b32 a62, v27
    v_accvgpr_write_b32 a63, v28
    v_accvgpr_read_b32 v25, a68
    v_accvgpr_read_b32 v26, a69
    v_accvgpr_read_b32 v27, a70
    v_accvgpr_read_b32 v28, a71
    v_mul_f32 v25, v25, v24
    v_mul_f32 v26, v26, v24
    v_mul_f32 v27, v27, v24
    v_mul_f32 v28, v28, v24
    v_accvgpr_write_b32 a68, v25
    v_accvgpr_write_b32 a69, v26
    v_accvgpr_write_b32 a70, v27
    v_accvgpr_write_b32 a71, v28
    v_accvgpr_read_b32 v25, a76
    v_accvgpr_read_b32 v26, a77
    v_accvgpr_read_b32 v27, a78
    v_accvgpr_read_b32 v28, a79
    v_mul_f32 v25, v25, v24
    v_mul_f32 v26, v26, v24
    v_mul_f32 v27, v27, v24
    v_mul_f32 v28, v28, v24
    v_accvgpr_write_b32 a76, v25
    v_accvgpr_write_b32 a77, v26
    v_accvgpr_write_b32 a78, v27
    v_accvgpr_write_b32 a79, v28
    v_accvgpr_read_b32 v25, a84
    v_accvgpr_read_b32 v26, a85
    v_accvgpr_read_b32 v27, a86
    v_accvgpr_read_b32 v28, a87
    v_mul_f32 v25, v25, v24
    v_mul_f32 v26, v26, v24
    v_mul_f32 v27, v27, v24
    v_mul_f32 v28, v28, v24
    v_accvgpr_write_b32 a84, v25
    v_accvgpr_write_b32 a85, v26
    v_accvgpr_write_b32 a86, v27
    v_accvgpr_write_b32 a87, v28
    v_accvgpr_read_b32 v25, a92
    v_accvgpr_read_b32 v26, a93
    v_accvgpr_read_b32 v27, a94
    v_accvgpr_read_b32 v28, a95
    v_mul_f32 v25, v25, v24
    v_mul_f32 v26, v26, v24
    v_mul_f32 v27, v27, v24
    v_mul_f32 v28, v28, v24
    v_accvgpr_write_b32 a92, v25
    v_accvgpr_write_b32 a93, v26
    v_accvgpr_write_b32 a94, v27
    v_accvgpr_write_b32 a95, v28
    v_accvgpr_read_b32 v25, a100
    v_accvgpr_read_b32 v26, a101
    v_accvgpr_read_b32 v27, a102
    v_accvgpr_read_b32 v28, a103
    v_mul_f32 v25, v25, v24
    v_mul_f32 v26, v26, v24
    v_mul_f32 v27, v27, v24
    v_mul_f32 v28, v28, v24
    v_accvgpr_write_b32 a100, v25
    v_accvgpr_write_b32 a101, v26
    v_accvgpr_write_b32 a102, v27
    v_accvgpr_write_b32 a103, v28
    v_accvgpr_read_b32 v25, a108
    v_accvgpr_read_b32 v26, a109
    v_accvgpr_read_b32 v27, a110
    v_accvgpr_read_b32 v28, a111
    v_mul_f32 v25, v25, v24
    v_mul_f32 v26, v26, v24
    v_mul_f32 v27, v27, v24
    v_mul_f32 v28, v28, v24
    v_accvgpr_write_b32 a108, v25
    v_accvgpr_write_b32 a109, v26
    v_accvgpr_write_b32 a110, v27
    v_accvgpr_write_b32 a111, v28
    v_accvgpr_read_b32 v25, a116
    v_accvgpr_read_b32 v26, a117
    v_accvgpr_read_b32 v27, a118
    v_accvgpr_read_b32 v28, a119
    v_mul_f32 v25, v25, v24
    v_mul_f32 v26, v26, v24
    v_mul_f32 v27, v27, v24
    v_mul_f32 v28, v28, v24
    v_accvgpr_write_b32 a116, v25
    v_accvgpr_write_b32 a117, v26
    v_accvgpr_write_b32 a118, v27
    v_accvgpr_write_b32 a119, v28
    v_accvgpr_read_b32 v25, a124
    v_accvgpr_read_b32 v26, a125
    v_accvgpr_read_b32 v27, a126
    v_accvgpr_read_b32 v28, a127
    v_mul_f32 v25, v25, v24
    v_mul_f32 v26, v26, v24
    v_mul_f32 v27, v27, v24
    v_mul_f32 v28, v28, v24
    v_accvgpr_write_b32 a124, v25
    v_accvgpr_write_b32 a125, v26
    v_accvgpr_write_b32 a126, v27
    v_accvgpr_write_b32 a127, v28
    v_exp_f32 v24, v96
    v_exp_f32 v25, v97
    v_exp_f32 v26, v98
    v_exp_f32 v27, v99
    v_exp_f32 v28, v112
    v_exp_f32 v29, v113
    v_exp_f32 v30, v114
    v_exp_f32 v31, v115
    s_nop 0
    v_add_f32 v20, v24, v25
    v_add_f32 v20, v20, v26
    v_add_f32 v20, v20, v27
    v_add_f32 v20, v20, v28
    v_add_f32 v20, v20, v29
    v_add_f32 v20, v20, v30
    v_add_f32 v20, v20, v31
    v_cvt_pk_bf16_f32 v80, v24, v25
    v_cvt_pk_bf16_f32 v81, v26, v27
    v_cvt_pk_bf16_f32 v82, v28, v29
    v_cvt_pk_bf16_f32 v83, v30, v31
    v_exp_f32 v24, v100
    v_exp_f32 v25, v101
    v_exp_f32 v26, v102
    v_exp_f32 v27, v103
    v_exp_f32 v28, v116
    v_exp_f32 v29, v117
    v_exp_f32 v30, v118
    v_exp_f32 v31, v119
    s_nop 0
    v_add_f32 v21, v24, v25
    v_add_f32 v21, v21, v26
    v_add_f32 v21, v21, v27
    v_add_f32 v21, v21, v28
    v_add_f32 v21, v21, v29
    v_add_f32 v21, v21, v30
    v_add_f32 v21, v21, v31
    v_cvt_pk_bf16_f32 v84, v24, v25
    v_cvt_pk_bf16_f32 v85, v26, v27
    v_cvt_pk_bf16_f32 v86, v28, v29
    v_cvt_pk_bf16_f32 v87, v30, v31
    v_exp_f32 v24, v104
    v_exp_f32 v25, v105
    v_exp_f32 v26, v106
    v_exp_f32 v27, v107
    v_exp_f32 v28, v120
    v_exp_f32 v29, v121
    v_exp_f32 v30, v122
    v_exp_f32 v31, v123
    s_nop 0
    v_add_f32 v22, v24, v25
    v_add_f32 v22, v22, v26
    v_add_f32 v22, v22, v27
    v_add_f32 v22, v22, v28
    v_add_f32 v22, v22, v29
    v_add_f32 v22, v22, v30
    v_add_f32 v22, v22, v31
    v_cvt_pk_bf16_f32 v88, v24, v25
    v_cvt_pk_bf16_f32 v89, v26, v27
    v_cvt_pk_bf16_f32 v90, v28, v29
    v_cvt_pk_bf16_f32 v91, v30, v31
    v_exp_f32 v24, v108
    v_exp_f32 v25, v109
    v_exp_f32 v26, v110
    v_exp_f32 v27, v111
    v_exp_f32 v28, v124
    v_exp_f32 v29, v125
    v_exp_f32 v30, v126
    v_exp_f32 v31, v127
    s_nop 0
    v_add_f32 v23, v24, v25
    v_add_f32 v23, v23, v26
    v_add_f32 v23, v23, v27
    v_add_f32 v23, v23, v28
    v_add_f32 v23, v23, v29
    v_add_f32 v23, v23, v30
    v_add_f32 v23, v23, v31
    v_cvt_pk_bf16_f32 v92, v24, v25
    v_cvt_pk_bf16_f32 v93, v26, v27
    v_cvt_pk_bf16_f32 v94, v28, v29
    v_cvt_pk_bf16_f32 v95, v30, v31
    s_nop 1
    s_cmp_eq_u32 s66, 0
    s_cbranch_scc1 K2_ret0
    s_cmp_eq_u32 s66, 2
    s_cbranch_scc1 K2_ret2
    s_endpgm
.section .rodata,"a"
.p2align 6
.amdhsa_kernel k2_attn_kernel
  .amdhsa_next_free_vgpr 512
  .amdhsa_next_free_sgpr 102
  .amdhsa_accum_offset 256
  .amdhsa_group_segment_fixed_size 0
  .amdhsa_kernarg_size 104
  .amdhsa_user_sgpr_count 2
  .amdhsa_user_sgpr_kernarg_segment_ptr 1
  .amdhsa_system_sgpr_workgroup_id_x 1
.end_amdhsa_kernel
.text
.globl k34_tail_kernel
.p2align 8
.type k34_tail_kernel,@function
k34_tail_kernel:
    s_cmp_ge_u32 s2, 256
    s_cbranch_scc1 K5_end
    s_load_dwordx2 s[6:7], s[0:1], 0
    s_load_dwordx2 s[8:9], s[0:1], 96
    s_load_dwordx4 s[12:15], s[0:1], 80
    v_and_b32 v1, 63, v0
    v_lshrrev_b32 v6, 6, v0
    v_and_b32 v2, 15, v0
    v_lshrrev_b32 v3, 4, v1
    v_readfirstlane_b32 s40, v6
    s_lshr_b32 s51, s2, 3
    s_and_b32 s50, s2, 7
    s_lshr_b32 s43, s51, 3
    s_lshl_b32 s43, s43, 3
    s_or_b32 s50, s50, s43
    s_lshr_b32 s43, s51, 2
    s_and_b32 s43, s43, 1
    s_lshl_b32 s41, s50, 1
    s_or_b32 s41, s41, s43
    s_and_b32 s42, s51, 3
    s_mov_b32 s47, 0xffff0000
    v_lshlrev_b32 v6, 4, v1
    s_lshl_b32 s43, s43, 10
    s_mul_i32 s44, s50, 458752
    s_add_u32 s43, s43, s44
    s_lshl_b32 s44, s40, 13
    s_add_u32 s43, s43, s44
    v_add_u32 v7, s43, v6
    s_mul_i32 s48, s42, 28
    s_lshl_b32 s43, s40, 2
    s_add_u32 s48, s48, s43
    s_mul_i32 s48, s48, 14336
    s_mul_i32 s49, s40, 16384
    s_waitcnt lgkmcnt(0)
    s_mov_b32 s24, s8
    s_and_b32 s25, s9, 0xffff
    s_mov_b32 s26, 10752
    s_mov_b32 s27, 0x00020000
    s_add_u32 s4, s8, 1048576
    s_addc_u32 s5, s9, 0
    s_mov_b32 s20, s4
    s_and_b32 s21, s5, 0xffff
    s_mov_b32 s22, 14680064
    s_mov_b32 s23, 0x00020000
    s_mov_b32 s60, s8
    s_and_b32 s61, s9, 0xffff
    s_mov_b32 s62, 131072
    s_mov_b32 s63, 0x00020000
    s_load_dword s68, s[8:9], 49152
    s_cmp_eq_u32 s40, 7
    s_cbranch_scc1 K5_helper
    s_mov_b32 s43, 0
    buffer_load_dwordx4 v[128:131], v7, s[20:23], s43 offen offset:0
    buffer_load_dwordx4 v[132:135], v7, s[20:23], s43 offen offset:2048
    s_add_u32 s44, s43, 4096
    buffer_load_dwordx4 v[136:139], v7, s[20:23], s44 offen offset:0
    buffer_load_dwordx4 v[140:143], v7, s[20:23], s44 offen offset:2048
    s_add_u32 s43, s43, 57344
    buffer_load_dwordx4 v[144:147], v7, s[20:23], s43 offen offset:0
    buffer_load_dwordx4 v[148:151], v7, s[20:23], s43 offen offset:2048
    s_add_u32 s44, s43, 4096
    buffer_load_dwordx4 v[152:155], v7, s[20:23], s44 offen offset:0
    buffer_load_dwordx4 v[156:159], v7, s[20:23], s44 offen offset:2048
    s_add_u32 s43, s43, 57344
    buffer_load_dwordx4 v[160:163], v7, s[20:23], s43 offen offset:0
    buffer_load_dwordx4 v[164:167], v7, s[20:23], s43 offen offset:2048
    s_add_u32 s44, s43, 4096
    buffer_load_dwordx4 v[168:171], v7, s[20:23], s44 offen offset:0
    buffer_load_dwordx4 v[172:175], v7, s[20:23], s44 offen offset:2048
    s_add_u32 s43, s43, 57344
    buffer_load_dwordx4 v[176:179], v7, s[20:23], s43 offen offset:0
    buffer_load_dwordx4 v[180:183], v7, s[20:23], s43 offen offset:2048
    s_add_u32 s44, s43, 4096
    buffer_load_dwordx4 v[184:187], v7, s[20:23], s44 offen offset:0
    buffer_load_dwordx4 v[188:191], v7, s[20:23], s44 offen offset:2048
    s_add_u32 s43, s43, 57344
    buffer_load_dwordx4 v[192:195], v7, s[20:23], s43 offen offset:0
    buffer_load_dwordx4 v[196:199], v7, s[20:23], s43 offen offset:2048
    s_add_u32 s44, s43, 4096
    buffer_load_dwordx4 v[200:203], v7, s[20:23], s44 offen offset:0
    buffer_load_dwordx4 v[204:207], v7, s[20:23], s44 offen offset:2048
    s_add_u32 s43, s43, 57344
    buffer_load_dwordx4 v[208:211], v7, s[20:23], s43 offen offset:0
    buffer_load_dwordx4 v[212:215], v7, s[20:23], s43 offen offset:2048
    s_add_u32 s44, s43, 4096
    buffer_load_dwordx4 v[216:219], v7, s[20:23], s44 offen offset:0
    buffer_load_dwordx4 v[220:223], v7, s[20:23], s44 offen offset:2048
    s_add_u32 s43, s43, 57344
    buffer_load_dwordx4 v[224:227], v7, s[20:23], s43 offen offset:0
    buffer_load_dwordx4 v[228:231], v7, s[20:23], s43 offen offset:2048
    s_add_u32 s44, s43, 4096
    buffer_load_dwordx4 v[232:235], v7, s[20:23], s44 offen offset:0
    buffer_load_dwordx4 v[236:239], v7, s[20:23], s44 offen offset:2048
    s_add_u32 s43, s43, 57344
    buffer_load_dwordx4 v[240:243], v7, s[20:23], s43 offen offset:0
    buffer_load_dwordx4 v[244:247], v7, s[20:23], s43 offen offset:2048
    s_add_u32 s44, s43, 4096
    buffer_load_dwordx4 v[248:251], v7, s[20:23], s44 offen offset:0
    buffer_load_dwordx4 v[252:255], v7, s[20:23], s44 offen offset:2048
    s_barrier
    s_mov_b32 s16, s6
    s_and_b32 s17, s7, 0xffff
    s_mov_b32 s18, 1835008
    s_mov_b32 s19, 0x00020000
    s_lshl_b32 s43, s41, 5
    v_add_u32 v8, s43, v2
    v_mul_u32_u24 v8, 896, v8
    v_lshl_add_u32 v8, v3, 3, v8
    s_lshl_b32 s43, s40, 7
    v_add_u32 v8, s43, v8
    s_mov_b32 s44, 14336
    buffer_load_dwordx2 v[32:33], v8, s[16:19], 0 offen offset:0
    buffer_load_dwordx2 v[34:35], v8, s[16:19], 0 offen offset:32
    buffer_load_dwordx2 v[36:37], v8, s[16:19], 0 offen offset:64
    buffer_load_dwordx2 v[38:39], v8, s[16:19], 0 offen offset:96
    buffer_load_dwordx2 v[40:41], v8, s[16:19], s44 offen offset:0
    buffer_load_dwordx2 v[42:43], v8, s[16:19], s44 offen offset:32
    buffer_load_dwordx2 v[44:45], v8, s[16:19], s44 offen offset:64
    buffer_load_dwordx2 v[46:47], v8, s[16:19], s44 offen offset:96
    s_add_u32 s4, s8, 27262976
    s_addc_u32 s5, s9, 0
    s_mov_b32 s28, s4
    s_and_b32 s29, s5, 0xffff
    s_mov_b32 s30, 1605632
    s_mov_b32 s31, 0x00020000
    s_lshl_b32 s43, s40, 8
    s_add_u32 s43, s43, 146432
    v_lshlrev_b32 v9, 4, v3
    v_add_u32 v9, s43, v9
    s_add_u32 s4, s8, 16777216
    s_addc_u32 s5, s9, 0
    s_mov_b32 s32, s4
    s_and_b32 s33, s5, 0xffff
    s_mov_b32 s34, 7340032
    s_mov_b32 s35, 0x00020000
    s_add_u32 s4, s8, 25165824
    s_addc_u32 s5, s9, 0
    s_mov_b32 s36, s4
    s_and_b32 s37, s5, 0xffff
    s_mov_b32 s38, 1835008
    s_mov_b32 s39, 0x00020000
    v_lshrrev_b32 v10, 2, v2
    v_cmp_eq_u32 vcc, v10, v3
    v_and_b32 v10, 1, v2
    v_lshlrev_b32 v10, 4, v10
    v_mov_b32 v11, 0x3f80
    v_lshlrev_b32 v11, v10, v11
    v_cndmask_b32 v11, 0, v11, vcc
    v_and_b32 v10, 2, v2
    v_cmp_eq_u32 vcc, 0, v10
    v_mov_b32 v80, 0
    v_mov_b32 v81, 0
    v_mov_b32 v84, 0
    v_mov_b32 v85, 0
    v_cndmask_b32 v82, 0, v11, vcc
    v_sub_u32 v83, v11, v82
    v_mov_b32 v7, 1.0
    v_mul_u32_u24 v11, 80, v2
    v_add_u32 v11, 143360, v11
    s_lshl_b32 s43, s40, 3
    v_add_u32 v10, s43, v11
    s_waitcnt vmcnt(39)
    v_mfma_f32_16x16x32_bf16 v[48:51], v[82:85], v[128:131], 0
    v_mfma_f32_16x16x32_bf16 v[52:55], v[80:83], v[128:131], 0
    s_waitcnt vmcnt(38)
    v_mfma_f32_16x16x32_bf16 v[56:59], v[82:85], v[132:135], 0
    v_mfma_f32_16x16x32_bf16 v[60:63], v[80:83], v[132:135], 0
    s_waitcnt vmcnt(37)
    v_mfma_f32_16x16x32_bf16 v[64:67], v[82:85], v[136:139], 0
    v_mfma_f32_16x16x32_bf16 v[68:71], v[80:83], v[136:139], 0
    s_waitcnt vmcnt(36)
    v_mfma_f32_16x16x32_bf16 v[72:75], v[82:85], v[140:143], 0
    v_mfma_f32_16x16x32_bf16 v[76:79], v[80:83], v[140:143], 0
    s_waitcnt vmcnt(35)
    v_mfma_f32_16x16x32_bf16 v[48:51], v[82:85], v[144:147], v[48:51]
    v_mfma_f32_16x16x32_bf16 v[52:55], v[80:83], v[144:147], v[52:55]
    s_waitcnt vmcnt(34)
    v_mfma_f32_16x16x32_bf16 v[56:59], v[82:85], v[148:151], v[56:59]
    v_mfma_f32_16x16x32_bf16 v[60:63], v[80:83], v[148:151], v[60:63]
    s_waitcnt vmcnt(33)
    v_mfma_f32_16x16x32_bf16 v[64:67], v[82:85], v[152:155], v[64:67]
    v_mfma_f32_16x16x32_bf16 v[68:71], v[80:83], v[152:155], v[68:71]
    s_waitcnt vmcnt(32)
    v_mfma_f32_16x16x32_bf16 v[72:75], v[82:85], v[156:159], v[72:75]
    v_mfma_f32_16x16x32_bf16 v[76:79], v[80:83], v[156:159], v[76:79]
    s_waitcnt vmcnt(31)
    v_mfma_f32_16x16x32_bf16 v[48:51], v[82:85], v[160:163], v[48:51]
    v_mfma_f32_16x16x32_bf16 v[52:55], v[80:83], v[160:163], v[52:55]
    s_waitcnt vmcnt(30)
    v_mfma_f32_16x16x32_bf16 v[56:59], v[82:85], v[164:167], v[56:59]
    v_mfma_f32_16x16x32_bf16 v[60:63], v[80:83], v[164:167], v[60:63]
    s_waitcnt vmcnt(29)
    v_mfma_f32_16x16x32_bf16 v[64:67], v[82:85], v[168:171], v[64:67]
    v_mfma_f32_16x16x32_bf16 v[68:71], v[80:83], v[168:171], v[68:71]
    s_waitcnt vmcnt(28)
    v_mfma_f32_16x16x32_bf16 v[72:75], v[82:85], v[172:175], v[72:75]
    v_mfma_f32_16x16x32_bf16 v[76:79], v[80:83], v[172:175], v[76:79]
    s_waitcnt vmcnt(27)
    v_mfma_f32_16x16x32_bf16 v[48:51], v[82:85], v[176:179], v[48:51]
    v_mfma_f32_16x16x32_bf16 v[52:55], v[80:83], v[176:179], v[52:55]
    s_waitcnt vmcnt(26)
    v_mfma_f32_16x16x32_bf16 v[56:59], v[82:85], v[180:183], v[56:59]
    v_mfma_f32_16x16x32_bf16 v[60:63], v[80:83], v[180:183], v[60:63]
    s_waitcnt vmcnt(25)
    v_mfma_f32_16x16x32_bf16 v[64:67], v[82:85], v[184:187], v[64:67]
    v_mfma_f32_16x16x32_bf16 v[68:71], v[80:83], v[184:187], v[68:71]
    s_waitcnt vmcnt(24)
    v_mfma_f32_16x16x32_bf16 v[72:75], v[82:85], v[188:191], v[72:75]
    v_mfma_f32_16x16x32_bf16 v[76:79], v[80:83], v[188:191], v[76:79]
    s_waitcnt vmcnt(23)
    v_mfma_f32_16x16x32_bf16 v[48:51], v[82:85], v[192:195], v[48:51]
    v_mfma_f32_16x16x32_bf16 v[52:55], v[80:83], v[192:195], v[52:55]
    s_waitcnt vmcnt(22)
    v_mfma_f32_16x16x32_bf16 v[56:59], v[82:85], v[196:199], v[56:59]
    v_mfma_f32_16x16x32_bf16 v[60:63], v[80:83], v[196:199], v[60:63]
    s_waitcnt vmcnt(21)
    v_mfma_f32_16x16x32_bf16 v[64:67], v[82:85], v[200:203], v[64:67]
    v_mfma_f32_16x16x32_bf16 v[68:71], v[80:83], v[200:203], v[68:71]
    s_waitcnt vmcnt(20)
    v_mfma_f32_16x16x32_bf16 v[72:75], v[82:85], v[204:207], v[72:75]
    v_mfma_f32_16x16x32_bf16 v[76:79], v[80:83], v[204:207], v[76:79]
    s_waitcnt vmcnt(19)
    v_mfma_f32_16x16x32_bf16 v[48:51], v[82:85], v[208:211], v[48:51]
    v_mfma_f32_16x16x32_bf16 v[52:55], v[80:83], v[208:211], v[52:55]
    s_waitcnt vmcnt(18)
    v_mfma_f32_16x16x32_bf16 v[56:59], v[82:85], v[212:215], v[56:59]
    v_mfma_f32_16x16x32_bf16 v[60:63], v[80:83], v[212:215], v[60:63]
    s_waitcnt vmcnt(17)
    v_mfma_f32_16x16x32_bf16 v[64:67], v[82:85], v[216:219], v[64:67]
    v_mfma_f32_16x16x32_bf16 v[68:71], v[80:83], v[216:219], v[68:71]
    s_waitcnt vmcnt(16)
    v_mfma_f32_16x16x32_bf16 v[72:75], v[82:85], v[220:223], v[72:75]
    v_mfma_f32_16x16x32_bf16 v[76:79], v[80:83], v[220:223], v[76:79]
    s_waitcnt vmcnt(15)
    v_mfma_f32_16x16x32_bf16 v[48:51], v[82:85], v[224:227], v[48:51]
    v_mfma_f32_16x16x32_bf16 v[52:55], v[80:83], v[224:227], v[52:55]
    s_waitcnt vmcnt(14)
    v_mfma_f32_16x16x32_bf16 v[56:59], v[82:85], v[228:231], v[56:59]
    v_mfma_f32_16x16x32_bf16 v[60:63], v[80:83], v[228:231], v[60:63]
    s_waitcnt vmcnt(13)
    v_mfma_f32_16x16x32_bf16 v[64:67], v[82:85], v[232:235], v[64:67]
    v_mfma_f32_16x16x32_bf16 v[68:71], v[80:83], v[232:235], v[68:71]
    s_waitcnt vmcnt(12)
    v_mfma_f32_16x16x32_bf16 v[72:75], v[82:85], v[236:239], v[72:75]
    v_mfma_f32_16x16x32_bf16 v[76:79], v[80:83], v[236:239], v[76:79]
    s_waitcnt vmcnt(11)
    v_mfma_f32_16x16x32_bf16 v[48:51], v[82:85], v[240:243], v[48:51]
    v_mfma_f32_16x16x32_bf16 v[52:55], v[80:83], v[240:243], v[52:55]
    s_waitcnt vmcnt(10)
    v_mfma_f32_16x16x32_bf16 v[56:59], v[82:85], v[244:247], v[56:59]
    v_mfma_f32_16x16x32_bf16 v[60:63], v[80:83], v[244:247], v[60:63]
    s_waitcnt vmcnt(9)
    v_mfma_f32_16x16x32_bf16 v[64:67], v[82:85], v[248:251], v[64:67]
    v_mfma_f32_16x16x32_bf16 v[68:71], v[80:83], v[248:251], v[68:71]
    s_waitcnt vmcnt(8)
    v_mfma_f32_16x16x32_bf16 v[72:75], v[82:85], v[252:255], v[72:75]
    v_mfma_f32_16x16x32_bf16 v[76:79], v[80:83], v[252:255], v[76:79]
    s_add_u32 s43, s48, 0
    s_add_u32 m0, s49, 0
    s_nop 0
    buffer_load_dwordx4 v6, s[28:31], s43 offen offset:0 lds
    buffer_load_dwordx4 v6, s[28:31], s43 offen offset:1024 lds
    buffer_load_dwordx4 v6, s[28:31], s43 offen offset:2048 lds
    buffer_load_dwordx4 v6, s[28:31], s43 offen offset:3072 lds
    s_add_u32 s43, s48, 14336
    s_add_u32 m0, s49, 4096
    s_nop 0
    buffer_load_dwordx4 v6, s[28:31], s43 offen offset:0 lds
    buffer_load_dwordx4 v6, s[28:31], s43 offen offset:1024 lds
    buffer_load_dwordx4 v6, s[28:31], s43 offen offset:2048 lds
    buffer_load_dwordx4 v6, s[28:31], s43 offen offset:3072 lds
    s_add_u32 s43, s48, 28672
    s_add_u32 m0, s49, 8192
    s_nop 0
    buffer_load_dwordx4 v6, s[28:31], s43 offen offset:0 lds
    buffer_load_dwordx4 v6, s[28:31], s43 offen offset:1024 lds
    buffer_load_dwordx4 v6, s[28:31], s43 offen offset:2048 lds
    buffer_load_dwordx4 v6, s[28:31], s43 offen offset:3072 lds
    s_add_u32 s43, s48, 43008
    s_add_u32 m0, s49, 12288
    s_nop 0
    buffer_load_dwordx4 v6, s[28:31], s43 offen offset:0 lds
    buffer_load_dwordx4 v6, s[28:31], s43 offen offset:1024 lds
    buffer_load_dwordx4 v6, s[28:31], s43 offen offset:2048 lds
    buffer_load_dwordx4 v6, s[28:31], s43 offen offset:3072 lds
    s_barrier
    ds_read_b128 v[16:19], v9 offset:0
    ds_read_b128 v[20:23], v9 offset:64
    ds_read_b128 v[24:27], v9 offset:128
    ds_read_b128 v[28:31], v9 offset:192
    ds_read_b128 v[88:91], v9 offset:1792
    ds_read_b128 v[92:95], v9 offset:1856
    ds_read_b128 v[96:99], v9 offset:1920
    ds_read_b128 v[100:103], v9 offset:1984
    ds_read_b128 v[104:107], v9 offset:3584
    ds_read_b128 v[108:111], v9 offset:3648
    ds_read_b128 v[112:115], v9 offset:3712
    ds_read_b128 v[116:119], v9 offset:3776
    s_nop 7
    s_waitcnt vmcnt(23)
    v_lshlrev_b32 v12, 16, v32
    v_and_b32 v13, s47, v32
    s_waitcnt lgkmcnt(11)
    v_pk_fma_f32 v[48:49], v[48:49], v[16:17], v[12:13]
    v_lshlrev_b32 v12, 16, v33
    v_and_b32 v13, s47, v33
    v_pk_fma_f32 v[50:51], v[50:51], v[18:19], v[12:13]
    s_waitcnt vmcnt(19)
    v_lshlrev_b32 v12, 16, v40
    s_add_u32 s46, s48, 4096
    buffer_load_dwordx4 v[128:131], v6, s[28:31], s46 offen offset:0
    v_and_b32 v13, s47, v40
    v_pk_fma_f32 v[52:53], v[52:53], v[16:17], v[12:13]
    v_lshlrev_b32 v12, 16, v41
    v_and_b32 v13, s47, v41
    v_pk_fma_f32 v[54:55], v[54:55], v[18:19], v[12:13]
    v_lshlrev_b32 v12, 16, v34
    v_and_b32 v13, s47, v34
    s_waitcnt lgkmcnt(10)
    v_pk_fma_f32 v[56:57], v[56:57], v[20:21], v[12:13]
    s_add_u32 s46, s48, 18432
    buffer_load_dwordx4 v[132:135], v6, s[28:31], s46 offen offset:0
    v_lshlrev_b32 v12, 16, v35
    v_and_b32 v13, s47, v35
    v_pk_fma_f32 v[58:59], v[58:59], v[22:23], v[12:13]
    s_waitcnt vmcnt(20)
    v_lshlrev_b32 v12, 16, v42
    v_and_b32 v13, s47, v42
    v_pk_fma_f32 v[60:61], v[60:61], v[20:21], v[12:13]
    v_lshlrev_b32 v12, 16, v43
    v_and_b32 v13, s47, v43
    s_add_u32 s46, s48, 32768
    buffer_load_dwordx4 v[136:139], v6, s[28:31], s46 offen offset:0
    v_pk_fma_f32 v[62:63], v[62:63], v[22:23], v[12:13]
    v_lshlrev_b32 v12, 16, v36
    v_and_b32 v13, s47, v36
    s_waitcnt lgkmcnt(9)
    v_pk_fma_f32 v[64:65], v[64:65], v[24:25], v[12:13]
    v_lshlrev_b32 v12, 16, v37
    v_and_b32 v13, s47, v37
    v_pk_fma_f32 v[66:67], v[66:67], v[26:27], v[12:13]
    s_waitcnt vmcnt(20)
    v_lshlrev_b32 v12, 16, v44
    s_add_u32 s46, s48, 47104
    buffer_load_dwordx4 v[140:143], v6, s[28:31], s46 offen offset:0
    v_and_b32 v13, s47, v44
    v_pk_fma_f32 v[68:69], v[68:69], v[24:25], v[12:13]
    v_lshlrev_b32 v12, 16, v45
    v_and_b32 v13, s47, v45
    v_pk_fma_f32 v[70:71], v[70:71], v[26:27], v[12:13]
    v_lshlrev_b32 v12, 16, v38
    v_and_b32 v13, s47, v38
    s_waitcnt lgkmcnt(8)
    v_pk_fma_f32 v[72:73], v[72:73], v[28:29], v[12:13]
    s_add_u32 s46, s48, 4096
    buffer_load_dwordx4 v[144:147], v6, s[28:31], s46 offen offset:1024
    v_lshlrev_b32 v12, 16, v39
    v_and_b32 v13, s47, v39
    v_pk_fma_f32 v[74:75], v[74:75], v[30:31], v[12:13]
    s_waitcnt vmcnt(21)
    v_lshlrev_b32 v12, 16, v46
    v_and_b32 v13, s47, v46
    v_pk_fma_f32 v[76:77], v[76:77], v[28:29], v[12:13]
    v_lshlrev_b32 v12, 16, v47
    v_and_b32 v13, s47, v47
    s_add_u32 s46, s48, 18432
    buffer_load_dwordx4 v[148:151], v6, s[28:31], s46 offen offset:1024
    v_pk_fma_f32 v[78:79], v[78:79], v[30:31], v[12:13]
    v_pk_add_f32 v[16:17], v[48:49], v[50:51]
    v_pk_mul_f32 v[20:21], v[48:49], v[48:49]
    v_pk_add_f32 v[16:17], v[16:17], v[56:57]
    v_pk_add_f32 v[16:17], v[16:17], v[58:59]
    v_pk_add_f32 v[16:17], v[16:17], v[64:65]
    v_pk_add_f32 v[16:17], v[16:17], v[66:67]
    v_pk_add_f32 v[16:17], v[16:17], v[72:73]
    s_add_u32 s46, s48, 32768
    buffer_load_dwordx4 v[152:155], v6, s[28:31], s46 offen offset:1024
    v_pk_add_f32 v[16:17], v[16:17], v[74:75]
    v_pk_fma_f32 v[20:21], v[50:51], v[50:51], v[20:21]
    v_pk_fma_f32 v[20:21], v[56:57], v[56:57], v[20:21]
    v_pk_fma_f32 v[20:21], v[58:59], v[58:59], v[20:21]
    v_pk_fma_f32 v[20:21], v[64:65], v[64:65], v[20:21]
    v_pk_fma_f32 v[20:21], v[66:67], v[66:67], v[20:21]
    v_pk_fma_f32 v[20:21], v[72:73], v[72:73], v[20:21]
    v_pk_fma_f32 v[20:21], v[74:75], v[74:75], v[20:21]
    s_add_u32 s46, s48, 47104
    buffer_load_dwordx4 v[156:159], v6, s[28:31], s46 offen offset:1024
    v_add_f32 v12, v16, v17
    v_add_f32 v13, v20, v21
    v_pk_add_f32 v[16:17], v[52:53], v[54:55]
    v_pk_mul_f32 v[20:21], v[52:53], v[52:53]
    v_pk_add_f32 v[16:17], v[16:17], v[60:61]
    v_pk_add_f32 v[16:17], v[16:17], v[62:63]
    v_pk_add_f32 v[16:17], v[16:17], v[68:69]
    v_pk_add_f32 v[16:17], v[16:17], v[70:71]
    s_add_u32 s46, s48, 4096
    buffer_load_dwordx4 v[160:163], v6, s[28:31], s46 offen offset:2048
    v_pk_add_f32 v[16:17], v[16:17], v[76:77]
    v_pk_add_f32 v[16:17], v[16:17], v[78:79]
    v_pk_fma_f32 v[20:21], v[54:55], v[54:55], v[20:21]
    v_pk_fma_f32 v[20:21], v[60:61], v[60:61], v[20:21]
    v_pk_fma_f32 v[20:21], v[62:63], v[62:63], v[20:21]
    v_pk_fma_f32 v[20:21], v[68:69], v[68:69], v[20:21]
    v_pk_fma_f32 v[20:21], v[70:71], v[70:71], v[20:21]
    v_pk_fma_f32 v[20:21], v[76:77], v[76:77], v[20:21]
    s_add_u32 s46, s48, 18432
    buffer_load_dwordx4 v[164:167], v6, s[28:31], s46 offen offset:2048
    v_pk_fma_f32 v[20:21], v[78:79], v[78:79], v[20:21]
    v_add_f32 v14, v16, v17
    v_add_f32 v15, v20, v21
    s_cmp_ge_u32 s42, 2
    s_cbranch_scc1 K5_nox1
    s_lshl_b32 s43, s41, 1
    s_add_u32 s43, s43, s42
    s_mul_i32 s43, s43, 14
    s_lshl_b32 s44, s40, 1
    s_add_u32 s43, s43, s44
    s_lshl_b32 s43, s43, 10
    s_cmp_eq_u32 s42, 0
    s_cbranch_scc0 K5_x1b
    v_cvt_pk_bf16_f32 v32, v48, v49
    v_cvt_pk_bf16_f32 v33, v50, v51
    v_cvt_pk_bf16_f32 v34, v56, v57
    v_cvt_pk_bf16_f32 v35, v58, v59
    buffer_store_dwordx4 v[32:35], v6, s[36:39], s43 offen offset:0 sc0 sc1
    v_cvt_pk_bf16_f32 v36, v64, v65
    v_cvt_pk_bf16_f32 v37, v66, v67
    v_cvt_pk_bf16_f32 v38, v72, v73
    v_cvt_pk_bf16_f32 v39, v74, v75
    buffer_store_dwordx4 v[36:39], v6, s[36:39], s43 offen offset:1024 sc0 sc1
    s_branch K5_x1done
K5_x1b:
    v_cvt_pk_bf16_f32 v32, v52, v53
    v_cvt_pk_bf16_f32 v33, v54, v55
    v_cvt_pk_bf16_f32 v34, v60, v61
    v_cvt_pk_bf16_f32 v35, v62, v63
    buffer_store_dwordx4 v[32:35], v6, s[36:39], s43 offen offset:0 sc0 sc1
    v_cvt_pk_bf16_f32 v36, v68, v69
    v_cvt_pk_bf16_f32 v37, v70, v71
    v_cvt_pk_bf16_f32 v38, v76, v77
    v_cvt_pk_bf16_f32 v39, v78, v79
    buffer_store_dwordx4 v[36:39], v6, s[36:39], s43 offen offset:1024 sc0 sc1
K5_x1done:
    s_nop 1
K5_nox1:
    s_nop 1
    v_mfma_f32_16x16x4_f32 v[16:19], v7, v12, 0
    v_mfma_f32_16x16x4_f32 v[20:23], v7, v13, 0
    v_mfma_f32_16x16x4_f32 v[24:27], v7, v14, 0
    v_mfma_f32_16x16x4_f32 v[28:31], v7, v15, 0
    s_add_u32 s46, s48, 32768
    buffer_load_dwordx4 v[168:171], v6, s[28:31], s46 offen offset:2048
    s_add_u32 s46, s48, 47104
    buffer_load_dwordx4 v[172:175], v6, s[28:31], s46 offen offset:2048
    s_add_u32 s46, s48, 4096
    buffer_load_dwordx4 v[176:179], v6, s[28:31], s46 offen offset:3072
    s_add_u32 s46, s48, 18432
    buffer_load_dwordx4 v[180:183], v6, s[28:31], s46 offen offset:3072
    s_nop 7
    v_mov_b32 v17, v20
    ds_write_b64 v10, v[16:17] offset:0
    v_mov_b32 v25, v28
    ds_write_b64 v10, v[24:25] offset:1280
    s_waitcnt lgkmcnt(0)
    s_barrier
    ds_read_b128 v[16:19], v11 offset:0
    ds_read_b128 v[20:23], v11 offset:16
    ds_read_b128 v[24:27], v11 offset:32
    ds_read_b128 v[28:31], v11 offset:48
    s_waitcnt lgkmcnt(1)
    v_pk_add_f32 v[16:17], v[16:17], v[24:25]
    v_pk_add_f32 v[18:19], v[18:19], v[26:27]
    s_add_u32 s46, s48, 32768
    buffer_load_dwordx4 v[184:187], v6, s[28:31], s46 offen offset:3072
    s_waitcnt lgkmcnt(0)
    v_pk_add_f32 v[20:21], v[20:21], v[28:29]
    v_pk_add_f32 v[22:23], v[22:23], v[30:31]
    v_pk_add_f32 v[16:17], v[16:17], v[20:21]
    v_pk_add_f32 v[18:19], v[18:19], v[22:23]
    v_pk_add_f32 v[12:13], v[16:17], v[18:19]
    ds_read_b128 v[16:19], v11 offset:1280
    s_add_u32 s46, s48, 47104
    buffer_load_dwordx4 v[188:191], v6, s[28:31], s46 offen offset:3072
    ds_read_b128 v[20:23], v11 offset:1296
    ds_read_b128 v[24:27], v11 offset:1312
    ds_read_b128 v[28:31], v11 offset:1328
    s_waitcnt lgkmcnt(1)
    v_pk_add_f32 v[16:17], v[16:17], v[24:25]
    v_pk_add_f32 v[18:19], v[18:19], v[26:27]
    s_waitcnt lgkmcnt(0)
    v_pk_add_f32 v[20:21], v[20:21], v[28:29]
    s_add_u32 s46, s48, 8192
    buffer_load_dwordx4 v[192:195], v6, s[28:31], s46 offen offset:0
    v_pk_add_f32 v[22:23], v[22:23], v[30:31]
    v_pk_add_f32 v[16:17], v[16:17], v[20:21]
    v_pk_add_f32 v[18:19], v[18:19], v[22:23]
    v_pk_add_f32 v[14:15], v[16:17], v[18:19]
    v_mul_f32 v12, 0x3b124925, v12
    v_mul_f32 v13, 0x3b124925, v13
    s_add_u32 s46, s48, 22528
    buffer_load_dwordx4 v[196:199], v6, s[28:31], s46 offen offset:0
    v_fma_f32 v13, -v12, v12, v13
    v_max_f32 v13, 0, v13
    v_add_f32 v13, 0x3727c5ac, v13
    v_rsq_f32 v13, v13
    v_mul_f32 v14, 0x3b124925, v14
    v_mul_f32 v15, 0x3b124925, v15
    s_add_u32 s46, s48, 36864
    buffer_load_dwordx4 v[200:203], v6, s[28:31], s46 offen offset:0
    v_fma_f32 v15, -v14, v14, v15
    v_max_f32 v15, 0, v15
    v_add_f32 v15, 0x3727c5ac, v15
    v_rsq_f32 v15, v15
    s_lshl_b32 s43, s40, 11
    s_add_u32 s43, s43, 114688
    s_add_u32 s46, s48, 51200
    buffer_load_dwordx4 v[204:207], v6, s[28:31], s46 offen offset:0
    v_add_u32 v11, s43, v6
    v_pk_mul_f32 v[16:17], v[104:105], v[12:13] op_sel:[0,1] op_sel_hi:[1,1]
    v_pk_fma_f32 v[18:19], v[16:17], v[12:13], v[88:89] op_sel_hi:[1,0,1] neg_lo:[1,0,0] neg_hi:[1,0,0]
    v_pk_fma_f32 v[48:49], v[48:49], v[16:17], v[18:19]
    v_cvt_pk_bf16_f32 v32, v48, v49
    v_pk_mul_f32 v[16:17], v[106:107], v[12:13] op_sel:[0,1] op_sel_hi:[1,1]
    s_add_u32 s46, s48, 8192
    buffer_load_dwordx4 v[208:211], v6, s[28:31], s46 offen offset:1024
    v_pk_fma_f32 v[18:19], v[16:17], v[12:13], v[90:91] op_sel_hi:[1,0,1] neg_lo:[1,0,0] neg_hi:[1,0,0]
    v_pk_fma_f32 v[50:51], v[50:51], v[16:17], v[18:19]
    v_cvt_pk_bf16_f32 v33, v50, v51
    v_pk_mul_f32 v[16:17], v[108:109], v[12:13] op_sel:[0,1] op_sel_hi:[1,1]
    v_pk_fma_f32 v[18:19], v[16:17], v[12:13], v[92:93] op_sel_hi:[1,0,1] neg_lo:[1,0,0] neg_hi:[1,0,0]
    v_pk_fma_f32 v[56:57], v[56:57], v[16:17], v[18:19]
    s_add_u32 s46, s48, 22528
    buffer_load_dwordx4 v[212:215], v6, s[28:31], s46 offen offset:1024
    v_cvt_pk_bf16_f32 v34, v56, v57
    v_pk_mul_f32 v[16:17], v[110:111], v[12:13] op_sel:[0,1] op_sel_hi:[1,1]
    v_pk_fma_f32 v[18:19], v[16:17], v[12:13], v[94:95] op_sel_hi:[1,0,1] neg_lo:[1,0,0] neg_hi:[1,0,0]
    v_pk_fma_f32 v[58:59], v[58:59], v[16:17], v[18:19]
    v_cvt_pk_bf16_f32 v35, v58, v59
    ds_write_b128 v11, v[32:35] offset:0
    s_add_u32 s46, s48, 36864
    buffer_load_dwordx4 v[216:219], v6, s[28:31], s46 offen offset:1024
    v_pk_mul_f32 v[16:17], v[112:113], v[12:13] op_sel:[0,1] op_sel_hi:[1,1]
    v_pk_fma_f32 v[18:19], v[16:17], v[12:13], v[96:97] op_sel_hi:[1,0,1] neg_lo:[1,0,0] neg_hi:[1,0,0]
    v_pk_fma_f32 v[64:65], v[64:65], v[16:17], v[18:19]
    v_cvt_pk_bf16_f32 v36, v64, v65
    v_pk_mul_f32 v[16:17], v[114:115], v[12:13] op_sel:[0,1] op_sel_hi:[1,1]
    v_pk_fma_f32 v[18:19], v[16:17], v[12:13], v[98:99] op_sel_hi:[1,0,1] neg_lo:[1,0,0] neg_hi:[1,0,0]
    s_add_u32 s46, s48, 51200
    buffer_load_dwordx4 v[220:223], v6, s[28:31], s46 offen offset:1024
    v_pk_fma_f32 v[66:67], v[66:67], v[16:17], v[18:19]
    v_cvt_pk_bf16_f32 v37, v66, v67
    v_pk_mul_f32 v[16:17], v[116:117], v[12:13] op_sel:[0,1] op_sel_hi:[1,1]
    v_pk_fma_f32 v[18:19], v[16:17], v[12:13], v[100:101] op_sel_hi:[1,0,1] neg_lo:[1,0,0] neg_hi:[1,0,0]
    v_pk_fma_f32 v[72:73], v[72:73], v[16:17], v[18:19]
    v_cvt_pk_bf16_f32 v38, v72, v73
    s_add_u32 s46, s48, 8192
    buffer_load_dwordx4 v[224:227], v6, s[28:31], s46 offen offset:2048
    v_pk_mul_f32 v[16:17], v[118:119], v[12:13] op_sel:[0,1] op_sel_hi:[1,1]
    v_pk_fma_f32 v[18:19], v[16:17], v[12:13], v[102:103] op_sel_hi:[1,0,1] neg_lo:[1,0,0] neg_hi:[1,0,0]
    v_pk_fma_f32 v[74:75], v[74:75], v[16:17], v[18:19]
    v_cvt_pk_bf16_f32 v39, v74, v75
    ds_write_b128 v11, v[36:39] offset:1024
    v_pk_mul_f32 v[16:17], v[104:105], v[14:15] op_sel:[0,1] op_sel_hi:[1,1]
    s_add_u32 s46, s48, 22528
    buffer_load_dwordx4 v[228:231], v6, s[28:31], s46 offen offset:2048
    v_pk_fma_f32 v[18:19], v[16:17], v[14:15], v[88:89] op_sel_hi:[1,0,1] neg_lo:[1,0,0] neg_hi:[1,0,0]
    v_pk_fma_f32 v[52:53], v[52:53], v[16:17], v[18:19]
    v_cvt_pk_bf16_f32 v40, v52, v53
    v_pk_mul_f32 v[16:17], v[106:107], v[14:15] op_sel:[0,1] op_sel_hi:[1,1]
    v_pk_fma_f32 v[18:19], v[16:17], v[14:15], v[90:91] op_sel_hi:[1,0,1] neg_lo:[1,0,0] neg_hi:[1,0,0]
    v_pk_fma_f32 v[54:55], v[54:55], v[16:17], v[18:19]
    s_add_u32 s46, s48, 36864
    buffer_load_dwordx4 v[232:235], v6, s[28:31], s46 offen offset:2048
    v_cvt_pk_bf16_f32 v41, v54, v55
    v_pk_mul_f32 v[16:17], v[108:109], v[14:15] op_sel:[0,1] op_sel_hi:[1,1]
    v_pk_fma_f32 v[18:19], v[16:17], v[14:15], v[92:93] op_sel_hi:[1,0,1] neg_lo:[1,0,0] neg_hi:[1,0,0]
    v_pk_fma_f32 v[60:61], v[60:61], v[16:17], v[18:19]
    v_cvt_pk_bf16_f32 v42, v60, v61
    v_pk_mul_f32 v[16:17], v[110:111], v[14:15] op_sel:[0,1] op_sel_hi:[1,1]
    s_add_u32 s46, s48, 51200
    buffer_load_dwordx4 v[236:239], v6, s[28:31], s46 offen offset:2048
    v_pk_fma_f32 v[18:19], v[16:17], v[14:15], v[94:95] op_sel_hi:[1,0,1] neg_lo:[1,0,0] neg_hi:[1,0,0]
    v_pk_fma_f32 v[62:63], v[62:63], v[16:17], v[18:19]
    v_cvt_pk_bf16_f32 v43, v62, v63
    ds_write_b128 v11, v[40:43] offset:14336
    v_pk_mul_f32 v[16:17], v[112:113], v[14:15] op_sel:[0,1] op_sel_hi:[1,1]
    v_pk_fma_f32 v[18:19], v[16:17], v[14:15], v[96:97] op_sel_hi:[1,0,1] neg_lo:[1,0,0] neg_hi:[1,0,0]
    s_add_u32 s46, s48, 8192
    buffer_load_dwordx4 v[240:243], v6, s[28:31], s46 offen offset:3072
    v_pk_fma_f32 v[68:69], v[68:69], v[16:17], v[18:19]
    v_cvt_pk_bf16_f32 v44, v68, v69
    v_pk_mul_f32 v[16:17], v[114:115], v[14:15] op_sel:[0,1] op_sel_hi:[1,1]
    v_pk_fma_f32 v[18:19], v[16:17], v[14:15], v[98:99] op_sel_hi:[1,0,1] neg_lo:[1,0,0] neg_hi:[1,0,0]
    v_pk_fma_f32 v[70:71], v[70:71], v[16:17], v[18:19]
    v_cvt_pk_bf16_f32 v45, v70, v71
    s_add_u32 s46, s48, 22528
    buffer_load_dwordx4 v[244:247], v6, s[28:31], s46 offen offset:3072
    v_pk_mul_f32 v[16:17], v[116:117], v[14:15] op_sel:[0,1] op_sel_hi:[1,1]
    v_pk_fma_f32 v[18:19], v[16:17], v[14:15], v[100:101] op_sel_hi:[1,0,1] neg_lo:[1,0,0] neg_hi:[1,0,0]
    v_pk_fma_f32 v[76:77], v[76:77], v[16:17], v[18:19]
    v_cvt_pk_bf16_f32 v46, v76, v77
    v_pk_mul_f32 v[16:17], v[118:119], v[14:15] op_sel:[0,1] op_sel_hi:[1,1]
    v_pk_fma_f32 v[18:19], v[16:17], v[14:15], v[102:103] op_sel_hi:[1,0,1] neg_lo:[1,0,0] neg_hi:[1,0,0]
    s_add_u32 s46, s48, 36864
    buffer_load_dwordx4 v[248:251], v6, s[28:31], s46 offen offset:3072
    v_pk_fma_f32 v[78:79], v[78:79], v[16:17], v[18:19]
    v_cvt_pk_bf16_f32 v47, v78, v79
    ds_write_b128 v11, v[44:47] offset:15360
    s_add_u32 s46, s48, 51200
    buffer_load_dwordx4 v[252:255], v6, s[28:31], s46 offen offset:3072
    v_add_u32 v11, 114688, v6
    v_add_u32 v10, s49, v6
    s_waitcnt lgkmcnt(0)
    s_barrier
    s_waitcnt vmcnt(32)
    ds_read_b128 v[16:19], v11 offset:0
    ds_read_b128 v[20:23], v11 offset:14336
    ds_read_b128 v[80:83], v10 offset:0
    ds_read_b128 v[84:87], v10 offset:4096
    ds_read_b128 v[88:91], v10 offset:8192
    ds_read_b128 v[92:95], v10 offset:12288
    ds_read_b128 v[24:27], v11 offset:1024
    ds_read_b128 v[28:31], v11 offset:15360
    ds_read_b128 v[96:99], v10 offset:1024
    ds_read_b128 v[100:103], v10 offset:5120
    ds_read_b128 v[104:107], v10 offset:9216
    ds_read_b128 v[108:111], v10 offset:13312
    s_waitcnt lgkmcnt(9)
    v_mfma_f32_16x16x32_bf16 v[48:51], v[80:83], v[16:19], 0
    v_mfma_f32_16x16x32_bf16 v[52:55], v[80:83], v[20:23], 0
    s_waitcnt lgkmcnt(8)
    v_mfma_f32_16x16x32_bf16 v[56:59], v[84:87], v[16:19], 0
    v_mfma_f32_16x16x32_bf16 v[60:63], v[84:87], v[20:23], 0
    s_waitcnt lgkmcnt(7)
    v_mfma_f32_16x16x32_bf16 v[64:67], v[88:91], v[16:19], 0
    v_mfma_f32_16x16x32_bf16 v[68:71], v[88:91], v[20:23], 0
    s_waitcnt lgkmcnt(6)
    v_mfma_f32_16x16x32_bf16 v[72:75], v[92:95], v[16:19], 0
    v_mfma_f32_16x16x32_bf16 v[76:79], v[92:95], v[20:23], 0
    ds_read_b128 v[16:19], v11 offset:2048
    ds_read_b128 v[20:23], v11 offset:16384
    ds_read_b128 v[80:83], v10 offset:2048
    ds_read_b128 v[84:87], v10 offset:6144
    ds_read_b128 v[88:91], v10 offset:10240
    ds_read_b128 v[92:95], v10 offset:14336
    s_waitcnt lgkmcnt(9)
    v_mfma_f32_16x16x32_bf16 v[48:51], v[96:99], v[24:27], v[48:51]
    v_mfma_f32_16x16x32_bf16 v[52:55], v[96:99], v[28:31], v[52:55]
    s_waitcnt lgkmcnt(8)
    v_mfma_f32_16x16x32_bf16 v[56:59], v[100:103], v[24:27], v[56:59]
    v_mfma_f32_16x16x32_bf16 v[60:63], v[100:103], v[28:31], v[60:63]
    s_waitcnt lgkmcnt(7)
    v_mfma_f32_16x16x32_bf16 v[64:67], v[104:107], v[24:27], v[64:67]
    v_mfma_f32_16x16x32_bf16 v[68:71], v[104:107], v[28:31], v[68:71]
    s_waitcnt lgkmcnt(6)
    v_mfma_f32_16x16x32_bf16 v[72:75], v[108:111], v[24:27], v[72:75]
    v_mfma_f32_16x16x32_bf16 v[76:79], v[108:111], v[28:31], v[76:79]
    ds_read_b128 v[24:27], v11 offset:3072
    ds_read_b128 v[28:31], v11 offset:17408
    ds_read_b128 v[96:99], v10 offset:3072
    ds_read_b128 v[100:103], v10 offset:7168
    ds_read_b128 v[104:107], v10 offset:11264
    ds_read_b128 v[108:111], v10 offset:15360
    s_waitcnt lgkmcnt(9)
    v_mfma_f32_16x16x32_bf16 v[48:51], v[80:83], v[16:19], v[48:51]
    v_mfma_f32_16x16x32_bf16 v[52:55], v[80:83], v[20:23], v[52:55]
    s_waitcnt lgkmcnt(8)
    v_mfma_f32_16x16x32_bf16 v[56:59], v[84:87], v[16:19], v[56:59]
    v_mfma_f32_16x16x32_bf16 v[60:63], v[84:87], v[20:23], v[60:63]
    s_waitcnt lgkmcnt(7)
    v_mfma_f32_16x16x32_bf16 v[64:67], v[88:91], v[16:19], v[64:67]
    v_mfma_f32_16x16x32_bf16 v[68:71], v[88:91], v[20:23], v[68:71]
    s_waitcnt lgkmcnt(6)
    v_mfma_f32_16x16x32_bf16 v[72:75], v[92:95], v[16:19], v[72:75]
    v_mfma_f32_16x16x32_bf16 v[76:79], v[92:95], v[20:23], v[76:79]
    ds_read_b128 v[16:19], v11 offset:4096
    ds_read_b128 v[20:23], v11 offset:18432
    s_waitcnt lgkmcnt(5)
    v_mfma_f32_16x16x32_bf16 v[48:51], v[96:99], v[24:27], v[48:51]
    v_mfma_f32_16x16x32_bf16 v[52:55], v[96:99], v[28:31], v[52:55]
    s_waitcnt lgkmcnt(4)
    v_mfma_f32_16x16x32_bf16 v[56:59], v[100:103], v[24:27], v[56:59]
    v_mfma_f32_16x16x32_bf16 v[60:63], v[100:103], v[28:31], v[60:63]
    s_waitcnt lgkmcnt(3)
    v_mfma_f32_16x16x32_bf16 v[64:67], v[104:107], v[24:27], v[64:67]
    v_mfma_f32_16x16x32_bf16 v[68:71], v[104:107], v[28:31], v[68:71]
    s_waitcnt lgkmcnt(2)
    v_mfma_f32_16x16x32_bf16 v[72:75], v[108:111], v[24:27], v[72:75]
    v_mfma_f32_16x16x32_bf16 v[76:79], v[108:111], v[28:31], v[76:79]
    ds_read_b128 v[24:27], v11 offset:5120
    ds_read_b128 v[28:31], v11 offset:19456
    s_waitcnt vmcnt(31) lgkmcnt(3)
    v_mfma_f32_16x16x32_bf16 v[48:51], v[128:131], v[16:19], v[48:51]
    s_waitcnt lgkmcnt(2)
    v_mfma_f32_16x16x32_bf16 v[52:55], v[128:131], v[20:23], v[52:55]
    s_waitcnt vmcnt(30)
    v_mfma_f32_16x16x32_bf16 v[56:59], v[132:135], v[16:19], v[56:59]
    v_mfma_f32_16x16x32_bf16 v[60:63], v[132:135], v[20:23], v[60:63]
    s_waitcnt vmcnt(29)
    v_mfma_f32_16x16x32_bf16 v[64:67], v[136:139], v[16:19], v[64:67]
    v_mfma_f32_16x16x32_bf16 v[68:71], v[136:139], v[20:23], v[68:71]
    s_waitcnt vmcnt(28)
    v_mfma_f32_16x16x32_bf16 v[72:75], v[140:143], v[16:19], v[72:75]
    v_mfma_f32_16x16x32_bf16 v[76:79], v[140:143], v[20:23], v[76:79]
    s_add_u32 s46, s48, 12288
    buffer_load_dwordx4 v[128:131], v6, s[28:31], s46 offen offset:0
    s_add_u32 s46, s48, 26624
    buffer_load_dwordx4 v[132:135], v6, s[28:31], s46 offen offset:0
    s_add_u32 s46, s48, 40960
    buffer_load_dwordx4 v[136:139], v6, s[28:31], s46 offen offset:0
    s_add_u32 s46, s48, 55296
    buffer_load_dwordx4 v[140:143], v6, s[28:31], s46 offen offset:0
    ds_read_b128 v[16:19], v11 offset:6144
    ds_read_b128 v[20:23], v11 offset:20480
    s_waitcnt vmcnt(31) lgkmcnt(3)
    v_mfma_f32_16x16x32_bf16 v[48:51], v[144:147], v[24:27], v[48:51]
    s_waitcnt lgkmcnt(2)
    v_mfma_f32_16x16x32_bf16 v[52:55], v[144:147], v[28:31], v[52:55]
    s_waitcnt vmcnt(30)
    v_mfma_f32_16x16x32_bf16 v[56:59], v[148:151], v[24:27], v[56:59]
    v_mfma_f32_16x16x32_bf16 v[60:63], v[148:151], v[28:31], v[60:63]
    s_waitcnt vmcnt(29)
    v_mfma_f32_16x16x32_bf16 v[64:67], v[152:155], v[24:27], v[64:67]
    v_mfma_f32_16x16x32_bf16 v[68:71], v[152:155], v[28:31], v[68:71]
    s_waitcnt vmcnt(28)
    v_mfma_f32_16x16x32_bf16 v[72:75], v[156:159], v[24:27], v[72:75]
    v_mfma_f32_16x16x32_bf16 v[76:79], v[156:159], v[28:31], v[76:79]
    s_add_u32 s46, s48, 12288
    buffer_load_dwordx4 v[144:147], v6, s[28:31], s46 offen offset:1024
    s_add_u32 s46, s48, 26624
    buffer_load_dwordx4 v[148:151], v6, s[28:31], s46 offen offset:1024
    s_add_u32 s46, s48, 40960
    buffer_load_dwordx4 v[152:155], v6, s[28:31], s46 offen offset:1024
    s_add_u32 s46, s48, 55296
    buffer_load_dwordx4 v[156:159], v6, s[28:31], s46 offen offset:1024
    ds_read_b128 v[24:27], v11 offset:7168
    ds_read_b128 v[28:31], v11 offset:21504
    s_waitcnt vmcnt(31) lgkmcnt(3)
    v_mfma_f32_16x16x32_bf16 v[48:51], v[160:163], v[16:19], v[48:51]
    s_waitcnt lgkmcnt(2)
    v_mfma_f32_16x16x32_bf16 v[52:55], v[160:163], v[20:23], v[52:55]
    s_waitcnt vmcnt(30)
    v_mfma_f32_16x16x32_bf16 v[56:59], v[164:167], v[16:19], v[56:59]
    v_mfma_f32_16x16x32_bf16 v[60:63], v[164:167], v[20:23], v[60:63]
    s_waitcnt vmcnt(29)
    v_mfma_f32_16x16x32_bf16 v[64:67], v[168:171], v[16:19], v[64:67]
    v_mfma_f32_16x16x32_bf16 v[68:71], v[168:171], v[20:23], v[68:71]
    s_waitcnt vmcnt(28)
    v_mfma_f32_16x16x32_bf16 v[72:75], v[172:175], v[16:19], v[72:75]
    v_mfma_f32_16x16x32_bf16 v[76:79], v[172:175], v[20:23], v[76:79]
    ds_read_b128 v[16:19], v11 offset:8192
    ds_read_b128 v[20:23], v11 offset:22528
    s_waitcnt vmcnt(27) lgkmcnt(3)
    v_mfma_f32_16x16x32_bf16 v[48:51], v[176:179], v[24:27], v[48:51]
    s_waitcnt lgkmcnt(2)
    v_mfma_f32_16x16x32_bf16 v[52:55], v[176:179], v[28:31], v[52:55]
    s_waitcnt vmcnt(26)
    v_mfma_f32_16x16x32_bf16 v[56:59], v[180:183], v[24:27], v[56:59]
    v_mfma_f32_16x16x32_bf16 v[60:63], v[180:183], v[28:31], v[60:63]
    s_waitcnt vmcnt(25)
    v_mfma_f32_16x16x32_bf16 v[64:67], v[184:187], v[24:27], v[64:67]
    v_mfma_f32_16x16x32_bf16 v[68:71], v[184:187], v[28:31], v[68:71]
    s_waitcnt vmcnt(24)
    v_mfma_f32_16x16x32_bf16 v[72:75], v[188:191], v[24:27], v[72:75]
    v_mfma_f32_16x16x32_bf16 v[76:79], v[188:191], v[28:31], v[76:79]
    ds_read_b128 v[24:27], v11 offset:9216
    ds_read_b128 v[28:31], v11 offset:23552
    s_waitcnt vmcnt(23) lgkmcnt(3)
    v_mfma_f32_16x16x32_bf16 v[48:51], v[192:195], v[16:19], v[48:51]
    s_waitcnt lgkmcnt(2)
    v_mfma_f32_16x16x32_bf16 v[52:55], v[192:195], v[20:23], v[52:55]
    s_waitcnt vmcnt(22)
    v_mfma_f32_16x16x32_bf16 v[56:59], v[196:199], v[16:19], v[56:59]
    v_mfma_f32_16x16x32_bf16 v[60:63], v[196:199], v[20:23], v[60:63]
    s_waitcnt vmcnt(21)
    v_mfma_f32_16x16x32_bf16 v[64:67], v[200:203], v[16:19], v[64:67]
    v_mfma_f32_16x16x32_bf16 v[68:71], v[200:203], v[20:23], v[68:71]
    s_waitcnt vmcnt(20)
    v_mfma_f32_16x16x32_bf16 v[72:75], v[204:207], v[16:19], v[72:75]
    v_mfma_f32_16x16x32_bf16 v[76:79], v[204:207], v[20:23], v[76:79]
    ds_read_b128 v[16:19], v11 offset:10240
    ds_read_b128 v[20:23], v11 offset:24576
    s_waitcnt vmcnt(19) lgkmcnt(3)
    v_mfma_f32_16x16x32_bf16 v[48:51], v[208:211], v[24:27], v[48:51]
    s_waitcnt lgkmcnt(2)
    v_mfma_f32_16x16x32_bf16 v[52:55], v[208:211], v[28:31], v[52:55]
    s_waitcnt vmcnt(18)
    v_mfma_f32_16x16x32_bf16 v[56:59], v[212:215], v[24:27], v[56:59]
    v_mfma_f32_16x16x32_bf16 v[60:63], v[212:215], v[28:31], v[60:63]
    s_waitcnt vmcnt(17)
    v_mfma_f32_16x16x32_bf16 v[64:67], v[216:219], v[24:27], v[64:67]
    v_mfma_f32_16x16x32_bf16 v[68:71], v[216:219], v[28:31], v[68:71]
    s_waitcnt vmcnt(16)
    v_mfma_f32_16x16x32_bf16 v[72:75], v[220:223], v[24:27], v[72:75]
    v_mfma_f32_16x16x32_bf16 v[76:79], v[220:223], v[28:31], v[76:79]
    ds_read_b128 v[24:27], v11 offset:11264
    ds_read_b128 v[28:31], v11 offset:25600
    s_waitcnt vmcnt(15) lgkmcnt(3)
    v_mfma_f32_16x16x32_bf16 v[48:51], v[224:227], v[16:19], v[48:51]
    s_waitcnt lgkmcnt(2)
    v_mfma_f32_16x16x32_bf16 v[52:55], v[224:227], v[20:23], v[52:55]
    s_waitcnt vmcnt(14)
    v_mfma_f32_16x16x32_bf16 v[56:59], v[228:231], v[16:19], v[56:59]
    v_mfma_f32_16x16x32_bf16 v[60:63], v[228:231], v[20:23], v[60:63]
    s_waitcnt vmcnt(13)
    v_mfma_f32_16x16x32_bf16 v[64:67], v[232:235], v[16:19], v[64:67]
    v_mfma_f32_16x16x32_bf16 v[68:71], v[232:235], v[20:23], v[68:71]
    s_waitcnt vmcnt(12)
    v_mfma_f32_16x16x32_bf16 v[72:75], v[236:239], v[16:19], v[72:75]
    v_mfma_f32_16x16x32_bf16 v[76:79], v[236:239], v[20:23], v[76:79]
    ds_read_b128 v[16:19], v11 offset:12288
    ds_read_b128 v[20:23], v11 offset:26624
    s_waitcnt vmcnt(11) lgkmcnt(3)
    v_mfma_f32_16x16x32_bf16 v[48:51], v[240:243], v[24:27], v[48:51]
    s_waitcnt lgkmcnt(2)
    v_mfma_f32_16x16x32_bf16 v[52:55], v[240:243], v[28:31], v[52:55]
    s_waitcnt vmcnt(10)
    v_mfma_f32_16x16x32_bf16 v[56:59], v[244:247], v[24:27], v[56:59]
    v_mfma_f32_16x16x32_bf16 v[60:63], v[244:247], v[28:31], v[60:63]
    s_waitcnt vmcnt(9)
    v_mfma_f32_16x16x32_bf16 v[64:67], v[248:251], v[24:27], v[64:67]
    v_mfma_f32_16x16x32_bf16 v[68:71], v[248:251], v[28:31], v[68:71]
    s_waitcnt vmcnt(8)
    v_mfma_f32_16x16x32_bf16 v[72:75], v[252:255], v[24:27], v[72:75]
    v_mfma_f32_16x16x32_bf16 v[76:79], v[252:255], v[28:31], v[76:79]
    ds_read_b128 v[24:27], v11 offset:13312
    ds_read_b128 v[28:31], v11 offset:27648
    s_waitcnt vmcnt(7) lgkmcnt(3)
    v_mfma_f32_16x16x32_bf16 v[48:51], v[128:131], v[16:19], v[48:51]
    s_waitcnt lgkmcnt(2)
    v_mfma_f32_16x16x32_bf16 v[52:55], v[128:131], v[20:23], v[52:55]
    s_waitcnt vmcnt(6)
    v_mfma_f32_16x16x32_bf16 v[56:59], v[132:135], v[16:19], v[56:59]
    v_mfma_f32_16x16x32_bf16 v[60:63], v[132:135], v[20:23], v[60:63]
    s_waitcnt vmcnt(5)
    v_mfma_f32_16x16x32_bf16 v[64:67], v[136:139], v[16:19], v[64:67]
    v_mfma_f32_16x16x32_bf16 v[68:71], v[136:139], v[20:23], v[68:71]
    s_waitcnt vmcnt(4)
    v_mfma_f32_16x16x32_bf16 v[72:75], v[140:143], v[16:19], v[72:75]
    v_mfma_f32_16x16x32_bf16 v[76:79], v[140:143], v[20:23], v[76:79]
    s_waitcnt vmcnt(3) lgkmcnt(1)
    v_mfma_f32_16x16x32_bf16 v[48:51], v[144:147], v[24:27], v[48:51]
    s_waitcnt lgkmcnt(0)
    v_mfma_f32_16x16x32_bf16 v[52:55], v[144:147], v[28:31], v[52:55]
    s_waitcnt vmcnt(2)
    v_mfma_f32_16x16x32_bf16 v[56:59], v[148:151], v[24:27], v[56:59]
    v_mfma_f32_16x16x32_bf16 v[60:63], v[148:151], v[28:31], v[60:63]
    s_waitcnt vmcnt(1)
    v_mfma_f32_16x16x32_bf16 v[64:67], v[152:155], v[24:27], v[64:67]
    v_mfma_f32_16x16x32_bf16 v[68:71], v[152:155], v[28:31], v[68:71]
    s_waitcnt vmcnt(0)
    v_mfma_f32_16x16x32_bf16 v[72:75], v[156:159], v[24:27], v[72:75]
    v_mfma_f32_16x16x32_bf16 v[76:79], v[156:159], v[28:31], v[76:79]
    s_nop 7
    s_mul_i32 s43, s41, 112
    s_mul_i32 s44, s42, 14
    s_add_u32 s43, s43, s44
    s_lshl_b32 s44, s40, 1
    s_add_u32 s43, s43, s44
    s_lshl_b32 s43, s43, 10
    s_add_u32 s44, s43, 57344
    v_max_f32 v48, 0, v48
    v_max_f32 v49, 0, v49
    v_max_f32 v50, 0, v50
    v_max_f32 v51, 0, v51
    v_cvt_pk_bf16_f32 v16, v48, v49
    v_cvt_pk_bf16_f32 v17, v50, v51
    v_max_f32 v56, 0, v56
    v_max_f32 v57, 0, v57
    v_max_f32 v58, 0, v58
    v_max_f32 v59, 0, v59
    v_cvt_pk_bf16_f32 v18, v56, v57
    v_cvt_pk_bf16_f32 v19, v58, v59
    buffer_store_dwordx4 v[16:19], v6, s[32:35], s43 offen offset:0 sc0 sc1
    v_max_f32 v64, 0, v64
    v_max_f32 v65, 0, v65
    v_max_f32 v66, 0, v66
    v_max_f32 v67, 0, v67
    v_cvt_pk_bf16_f32 v20, v64, v65
    v_cvt_pk_bf16_f32 v21, v66, v67
    v_max_f32 v72, 0, v72
    v_max_f32 v73, 0, v73
    v_max_f32 v74, 0, v74
    v_max_f32 v75, 0, v75
    v_cvt_pk_bf16_f32 v22, v72, v73
    v_cvt_pk_bf16_f32 v23, v74, v75
    buffer_store_dwordx4 v[20:23], v6, s[32:35], s43 offen offset:1024 sc0 sc1
    v_max_f32 v52, 0, v52
    v_max_f32 v53, 0, v53
    v_max_f32 v54, 0, v54
    v_max_f32 v55, 0, v55
    v_cvt_pk_bf16_f32 v24, v52, v53
    v_cvt_pk_bf16_f32 v25, v54, v55
    v_max_f32 v60, 0, v60
    v_max_f32 v61, 0, v61
    v_max_f32 v62, 0, v62
    v_max_f32 v63, 0, v63
    v_cvt_pk_bf16_f32 v26, v60, v61
    v_cvt_pk_bf16_f32 v27, v62, v63
    buffer_store_dwordx4 v[24:27], v6, s[32:35], s44 offen offset:0 sc0 sc1
    v_max_f32 v68, 0, v68
    v_max_f32 v69, 0, v69
    v_max_f32 v70, 0, v70
    v_max_f32 v71, 0, v71
    v_cvt_pk_bf16_f32 v28, v68, v69
    v_cvt_pk_bf16_f32 v29, v70, v71
    v_max_f32 v76, 0, v76
    v_max_f32 v77, 0, v77
    v_max_f32 v78, 0, v78
    v_max_f32 v79, 0, v79
    v_cvt_pk_bf16_f32 v30, v76, v77
    v_cvt_pk_bf16_f32 v31, v78, v79
    buffer_store_dwordx4 v[28:31], v6, s[32:35], s44 offen offset:1024 sc0 sc1
    s_branch K5_phase2
K5_helper:
    s_mov_b32 m0, 146432
    s_mov_b32 s43, 3584
    buffer_load_dwordx4 v6, s[24:27], s43 offen lds
    s_mov_b32 m0, 147456
    s_mov_b32 s43, 4608
    buffer_load_dwordx4 v6, s[24:27], s43 offen lds
    s_mov_b32 m0, 148480
    s_mov_b32 s43, 5632
    buffer_load_dwordx4 v6, s[24:27], s43 offen lds
    s_mov_b32 m0, 149504
    s_mov_b32 s43, 6656
    buffer_load_dwordx4 v6, s[24:27], s43 offen lds
    s_mov_b32 m0, 150528
    s_mov_b32 s43, 7680
    buffer_load_dwordx4 v6, s[24:27], s43 offen lds
    s_mov_b32 m0, 151552
    s_mov_b32 s43, 8704
    buffer_load_dwordx4 v6, s[24:27], s43 offen lds
    v_mov_b32 v12, 0
    v_mov_b32 v13, 0
    v_mov_b32 v14, 0
    v_mov_b32 v15, 0
    v_add_u32 v11, 143360, v6
    ds_write_b128 v11, v[12:15] offset:0
    ds_write_b128 v11, v[12:15] offset:1024
    ds_write_b128 v11, v[12:15] offset:2048
    s_add_u32 s4, s8, 16777216
    s_addc_u32 s5, s9, 0
    s_mov_b32 s32, s4
    s_and_b32 s33, s5, 0xffff
    s_mov_b32 s34, 7340032
    s_mov_b32 s35, 0x00020000
    s_add_u32 s4, s8, 25165824
    s_addc_u32 s5, s9, 0
    s_mov_b32 s36, s4
    s_and_b32 s37, s5, 0xffff
    s_mov_b32 s38, 1835008
    s_mov_b32 s39, 0x00020000
    s_barrier
    s_waitcnt vmcnt(0) lgkmcnt(0)
    s_barrier
    s_cmp_lg_u32 s40, 7
    s_cbranch_scc1 K5_nocpf
    s_getpc_b64 s[70:71]
K5_pc:
    s_sub_u32 s70, s70, K5_pc-k34_tail_kernel
    s_subb_u32 s71, s71, 0
    v_lshlrev_b32 v15, 7, v1
    v_min_u32 v15, code_end-k34_tail_kernel-4, v15
    global_load_dword v15, v15, s[70:71]
K5_nocpf:
    s_barrier
    s_barrier
K5_phase2:
    s_mul_i32 s44, s51, 37
    s_lshr_b32 s44, s44, 8
    s_mul_i32 s45, s44, 7
    s_sub_u32 s64, s51, s45
    s_and_b32 s65, s2, 7
    s_lshl_b32 s44, s44, 3
    s_add_u32 s65, s65, s44
    s_add_u32 s4, s8, 29360128
    s_addc_u32 s5, s9, 0
    s_mov_b32 s52, s4
    s_and_b32 s53, s5, 0xffff
    s_mov_b32 s54, 1605632
    s_mov_b32 s55, 0x00020000
    s_mov_b32 s56, s12
    s_and_b32 s57, s13, 0xffff
    s_mov_b32 s58, 1835008
    s_mov_b32 s59, 0x00020000
    s_mul_i32 s66, s64, 56
    s_mul_i32 s44, s40, 7
    s_add_u32 s66, s66, s44
    s_lshl_b32 s66, s66, 12
    s_mul_i32 s43, s65, 224
    s_add_u32 s43, s43, s44
    s_lshl_b32 s43, s43, 10
    v_add_u32 v7, s43, v6
    s_waitcnt vmcnt(0) lgkmcnt(0)
    s_barrier
    s_cmp_lg_u32 s40, 0
    s_cbranch_scc1 K5_nopub
    s_lshl_b32 s43, s50, 3
    s_and_b32 s44, s51, 7
    s_add_u32 s43, s43, s44
    s_lshl_b32 s43, s43, 7
    s_add_u32 s43, s43, 65536
    v_mov_b32 v12, s43
    v_mov_b32 v13, s68
    v_cmp_eq_u32 vcc, 0, v1
    s_and_saveexec_b64 s[4:5], vcc
    buffer_store_dword v13, v12, s[60:63], 0 offen sc0 sc1
    s_mov_b64 exec, s[4:5]
K5_nopub:
    s_cmp_ge_u32 s51, 28
    s_cbranch_scc1 K5_end
    s_add_u32 s46, s66, 0
    buffer_load_dwordx4 v[96:99], v6, s[52:55], s46 offen offset:0
    buffer_load_dwordx4 v[100:103], v6, s[52:55], s46 offen offset:1024
    buffer_load_dwordx4 v[104:107], v6, s[52:55], s46 offen offset:2048
    buffer_load_dwordx4 v[108:111], v6, s[52:55], s46 offen offset:3072
    s_add_u32 s46, s66, 4096
    buffer_load_dwordx4 v[128:131], v6, s[52:55], s46 offen offset:0
    buffer_load_dwordx4 v[132:135], v6, s[52:55], s46 offen offset:1024
    buffer_load_dwordx4 v[136:139], v6, s[52:55], s46 offen offset:2048
    buffer_load_dwordx4 v[140:143], v6, s[52:55], s46 offen offset:3072
    s_add_u32 s46, s66, 8192
    buffer_load_dwordx4 v[160:163], v6, s[52:55], s46 offen offset:0
    buffer_load_dwordx4 v[164:167], v6, s[52:55], s46 offen offset:1024
    buffer_load_dwordx4 v[168:171], v6, s[52:55], s46 offen offset:2048
    buffer_load_dwordx4 v[172:175], v6, s[52:55], s46 offen offset:3072
    s_add_u32 s46, s66, 12288
    buffer_load_dwordx4 v[192:195], v6, s[52:55], s46 offen offset:0
    buffer_load_dwordx4 v[196:199], v6, s[52:55], s46 offen offset:1024
    buffer_load_dwordx4 v[200:203], v6, s[52:55], s46 offen offset:2048
    buffer_load_dwordx4 v[204:207], v6, s[52:55], s46 offen offset:3072
    s_add_u32 s46, s66, 16384
    buffer_load_dwordx4 v[224:227], v6, s[52:55], s46 offen offset:0
    buffer_load_dwordx4 v[228:231], v6, s[52:55], s46 offen offset:1024
    buffer_load_dwordx4 v[232:235], v6, s[52:55], s46 offen offset:2048
    buffer_load_dwordx4 v[236:239], v6, s[52:55], s46 offen offset:3072
    s_lshl_b32 s43, s65, 6
    s_lshr_b32 s44, s40, 1
    s_lshl_b32 s44, s44, 4
    s_add_u32 s43, s43, s44
    v_add_u32 v8, s43, v2
    v_mul_u32_u24 v8, 896, v8
    v_lshl_add_u32 v8, v3, 3, v8
    s_lshl_b32 s43, s64, 7
    s_and_b32 s44, s40, 1
    s_lshl_b32 s44, s44, 6
    s_add_u32 s43, s43, s44
    v_add_u32 v8, s43, v8
    s_lshl_b32 s43, s43, 1
    s_add_u32 s43, s43, 8960
    v_lshlrev_b32 v9, 4, v3
    buffer_load_dwordx4 v[20:23], v9, s[24:27], s43 offen offset:0
    buffer_load_dwordx4 v[24:27], v9, s[24:27], s43 offen offset:64
    s_cmp_lg_u32 s40, 0
    s_cbranch_scc1 K5_polled
    v_and_b32 v12, 7, v1
    s_lshl_b32 s43, s65, 3
    v_add_u32 v12, s43, v12
    v_lshlrev_b32 v12, 7, v12
    v_add_u32 v12, 65536, v12
    s_mov_b32 s45, 0x100000
K5_poll:
    buffer_load_dword v13, v12, s[60:63], 0 offen sc0 sc1
    s_waitcnt vmcnt(0)
    v_cmp_ne_u32 vcc, s68, v13
    s_nop 1
    s_cbranch_vccz K5_polled
    s_sleep 1
    s_sub_u32 s45, s45, 1
    s_cmp_lg_u32 s45, 0
    s_cbranch_scc1 K5_poll
K5_polled:
    s_barrier
    s_mov_b32 s45, 0
    buffer_load_dwordx4 v[112:115], v7, s[32:35], s45 offen offset:0 sc0 sc1
    s_mov_b32 s45, 57344
    buffer_load_dwordx4 v[116:119], v7, s[32:35], s45 offen offset:0 sc0 sc1
    s_mov_b32 s45, 114688
    buffer_load_dwordx4 v[120:123], v7, s[32:35], s45 offen offset:0 sc0 sc1
    s_mov_b32 s45, 172032
    buffer_load_dwordx4 v[124:127], v7, s[32:35], s45 offen offset:0 sc0 sc1
    s_mov_b32 s45, 0
    buffer_load_dwordx4 v[144:147], v7, s[32:35], s45 offen offset:1024 sc0 sc1
    s_mov_b32 s45, 57344
    buffer_load_dwordx4 v[148:151], v7, s[32:35], s45 offen offset:1024 sc0 sc1
    s_mov_b32 s45, 114688
    buffer_load_dwordx4 v[152:155], v7, s[32:35], s45 offen offset:1024 sc0 sc1
    s_mov_b32 s45, 172032
    buffer_load_dwordx4 v[156:159], v7, s[32:35], s45 offen offset:1024 sc0 sc1
    s_mov_b32 s45, 0
    buffer_load_dwordx4 v[176:179], v7, s[32:35], s45 offen offset:2048 sc0 sc1
    s_mov_b32 s45, 57344
    buffer_load_dwordx4 v[180:183], v7, s[32:35], s45 offen offset:2048 sc0 sc1
    s_mov_b32 s45, 114688
    buffer_load_dwordx4 v[184:187], v7, s[32:35], s45 offen offset:2048 sc0 sc1
    s_mov_b32 s45, 172032
    buffer_load_dwordx4 v[188:191], v7, s[32:35], s45 offen offset:2048 sc0 sc1
    s_mov_b32 s45, 0
    buffer_load_dwordx4 v[208:211], v7, s[32:35], s45 offen offset:3072 sc0 sc1
    s_mov_b32 s45, 57344
    buffer_load_dwordx4 v[212:215], v7, s[32:35], s45 offen offset:3072 sc0 sc1
    s_mov_b32 s45, 114688
    buffer_load_dwordx4 v[216:219], v7, s[32:35], s45 offen offset:3072 sc0 sc1
    s_mov_b32 s45, 172032
    buffer_load_dwordx4 v[220:223], v7, s[32:35], s45 offen offset:3072 sc0 sc1
    s_mov_b32 s45, 4096
    buffer_load_dwordx4 v[240:243], v7, s[32:35], s45 offen offset:0 sc0 sc1
    s_mov_b32 s45, 61440
    buffer_load_dwordx4 v[244:247], v7, s[32:35], s45 offen offset:0 sc0 sc1
    s_mov_b32 s45, 118784
    buffer_load_dwordx4 v[248:251], v7, s[32:35], s45 offen offset:0 sc0 sc1
    s_mov_b32 s45, 176128
    buffer_load_dwordx4 v[252:255], v7, s[32:35], s45 offen offset:0 sc0 sc1
    s_lshl_b32 s45, s65, 2
    s_lshr_b32 s46, s40, 1
    s_add_u32 s45, s45, s46
    s_mul_i32 s45, s45, 14
    s_lshl_b32 s46, s64, 1
    s_add_u32 s45, s45, s46
    s_and_b32 s46, s40, 1
    s_add_u32 s45, s45, s46
    s_lshl_b32 s45, s45, 10
    buffer_load_dwordx4 v[16:19], v6, s[36:39], s45 offen sc0 sc1
    s_waitcnt vmcnt(20)
    v_mfma_f32_16x16x32_bf16 v[32:35], v[96:99], v[112:115], 0
    s_waitcnt vmcnt(19)
    v_mfma_f32_16x16x32_bf16 v[48:51], v[96:99], v[116:119], 0
    s_waitcnt vmcnt(18)
    v_mfma_f32_16x16x32_bf16 v[64:67], v[96:99], v[120:123], 0
    s_waitcnt vmcnt(17)
    v_mfma_f32_16x16x32_bf16 v[80:83], v[96:99], v[124:127], 0
    v_mfma_f32_16x16x32_bf16 v[36:39], v[100:103], v[112:115], 0
    v_mfma_f32_16x16x32_bf16 v[52:55], v[100:103], v[116:119], 0
    v_mfma_f32_16x16x32_bf16 v[68:71], v[100:103], v[120:123], 0
    v_mfma_f32_16x16x32_bf16 v[84:87], v[100:103], v[124:127], 0
    v_mfma_f32_16x16x32_bf16 v[40:43], v[104:107], v[112:115], 0
    v_mfma_f32_16x16x32_bf16 v[56:59], v[104:107], v[116:119], 0
    v_mfma_f32_16x16x32_bf16 v[72:75], v[104:107], v[120:123], 0
    v_mfma_f32_16x16x32_bf16 v[88:91], v[104:107], v[124:127], 0
    v_mfma_f32_16x16x32_bf16 v[44:47], v[108:111], v[112:115], 0
    v_mfma_f32_16x16x32_bf16 v[60:63], v[108:111], v[116:119], 0
    v_mfma_f32_16x16x32_bf16 v[76:79], v[108:111], v[120:123], 0
    v_mfma_f32_16x16x32_bf16 v[92:95], v[108:111], v[124:127], 0
    s_add_u32 s46, s66, 20480
    buffer_load_dwordx4 v[96:99], v6, s[52:55], s46 offen offset:0
    buffer_load_dwordx4 v[100:103], v6, s[52:55], s46 offen offset:1024
    buffer_load_dwordx4 v[104:107], v6, s[52:55], s46 offen offset:2048
    buffer_load_dwordx4 v[108:111], v6, s[52:55], s46 offen offset:3072
    s_mov_b32 s45, 4096
    buffer_load_dwordx4 v[112:115], v7, s[32:35], s45 offen offset:1024 sc0 sc1
    s_mov_b32 s45, 61440
    buffer_load_dwordx4 v[116:119], v7, s[32:35], s45 offen offset:1024 sc0 sc1
    s_mov_b32 s45, 118784
    buffer_load_dwordx4 v[120:123], v7, s[32:35], s45 offen offset:1024 sc0 sc1
    s_mov_b32 s45, 176128
    buffer_load_dwordx4 v[124:127], v7, s[32:35], s45 offen offset:1024 sc0 sc1
    s_waitcnt vmcnt(24)
    v_mfma_f32_16x16x32_bf16 v[32:35], v[128:131], v[144:147], v[32:35]
    s_waitcnt vmcnt(23)
    v_mfma_f32_16x16x32_bf16 v[48:51], v[128:131], v[148:151], v[48:51]
    s_waitcnt vmcnt(22)
    v_mfma_f32_16x16x32_bf16 v[64:67], v[128:131], v[152:155], v[64:67]
    s_waitcnt vmcnt(21)
    v_mfma_f32_16x16x32_bf16 v[80:83], v[128:131], v[156:159], v[80:83]
    v_mfma_f32_16x16x32_bf16 v[36:39], v[132:135], v[144:147], v[36:39]
    v_mfma_f32_16x16x32_bf16 v[52:55], v[132:135], v[148:151], v[52:55]
    v_mfma_f32_16x16x32_bf16 v[68:71], v[132:135], v[152:155], v[68:71]
    v_mfma_f32_16x16x32_bf16 v[84:87], v[132:135], v[156:159], v[84:87]
    v_mfma_f32_16x16x32_bf16 v[40:43], v[136:139], v[144:147], v[40:43]
    v_mfma_f32_16x16x32_bf16 v[56:59], v[136:139], v[148:151], v[56:59]
    v_mfma_f32_16x16x32_bf16 v[72:75], v[136:139], v[152:155], v[72:75]
    v_mfma_f32_16x16x32_bf16 v[88:91], v[136:139], v[156:159], v[88:91]
    v_mfma_f32_16x16x32_bf16 v[44:47], v[140:143], v[144:147], v[44:47]
    v_mfma_f32_16x16x32_bf16 v[60:63], v[140:143], v[148:151], v[60:63]
    v_mfma_f32_16x16x32_bf16 v[76:79], v[140:143], v[152:155], v[76:79]
    v_mfma_f32_16x16x32_bf16 v[92:95], v[140:143], v[156:159], v[92:95]
    s_add_u32 s46, s66, 24576
    buffer_load_dwordx4 v[128:131], v6, s[52:55], s46 offen offset:0
    buffer_load_dwordx4 v[132:135], v6, s[52:55], s46 offen offset:1024
    buffer_load_dwordx4 v[136:139], v6, s[52:55], s46 offen offset:2048
    buffer_load_dwordx4 v[140:143], v6, s[52:55], s46 offen offset:3072
    s_mov_b32 s45, 4096
    buffer_load_dwordx4 v[144:147], v7, s[32:35], s45 offen offset:2048 sc0 sc1
    s_mov_b32 s45, 61440
    buffer_load_dwordx4 v[148:151], v7, s[32:35], s45 offen offset:2048 sc0 sc1
    s_mov_b32 s45, 118784
    buffer_load_dwordx4 v[152:155], v7, s[32:35], s45 offen offset:2048 sc0 sc1
    s_mov_b32 s45, 176128
    buffer_load_dwordx4 v[156:159], v7, s[32:35], s45 offen offset:2048 sc0 sc1
    s_waitcnt vmcnt(28)
    v_mfma_f32_16x16x32_bf16 v[32:35], v[160:163], v[176:179], v[32:35]
    s_waitcnt vmcnt(27)
    v_mfma_f32_16x16x32_bf16 v[48:51], v[160:163], v[180:183], v[48:51]
    s_waitcnt vmcnt(26)
    v_mfma_f32_16x16x32_bf16 v[64:67], v[160:163], v[184:187], v[64:67]
    s_waitcnt vmcnt(25)
    v_mfma_f32_16x16x32_bf16 v[80:83], v[160:163], v[188:191], v[80:83]
    v_mfma_f32_16x16x32_bf16 v[36:39], v[164:167], v[176:179], v[36:39]
    v_mfma_f32_16x16x32_bf16 v[52:55], v[164:167], v[180:183], v[52:55]
    v_mfma_f32_16x16x32_bf16 v[68:71], v[164:167], v[184:187], v[68:71]
    v_mfma_f32_16x16x32_bf16 v[84:87], v[164:167], v[188:191], v[84:87]
    v_mfma_f32_16x16x32_bf16 v[40:43], v[168:171], v[176:179], v[40:43]
    v_mfma_f32_16x16x32_bf16 v[56:59], v[168:171], v[180:183], v[56:59]
    v_mfma_f32_16x16x32_bf16 v[72:75], v[168:171], v[184:187], v[72:75]
    v_mfma_f32_16x16x32_bf16 v[88:91], v[168:171], v[188:191], v[88:91]
    v_mfma_f32_16x16x32_bf16 v[44:47], v[172:175], v[176:179], v[44:47]
    v_mfma_f32_16x16x32_bf16 v[60:63], v[172:175], v[180:183], v[60:63]
    v_mfma_f32_16x16x32_bf16 v[76:79], v[172:175], v[184:187], v[76:79]
    v_mfma_f32_16x16x32_bf16 v[92:95], v[172:175], v[188:191], v[92:95]
    s_waitcnt vmcnt(24)
    v_mfma_f32_16x16x32_bf16 v[32:35], v[192:195], v[208:211], v[32:35]
    s_waitcnt vmcnt(23)
    v_mfma_f32_16x16x32_bf16 v[48:51], v[192:195], v[212:215], v[48:51]
    s_waitcnt vmcnt(22)
    v_mfma_f32_16x16x32_bf16 v[64:67], v[192:195], v[216:219], v[64:67]
    s_waitcnt vmcnt(21)
    v_mfma_f32_16x16x32_bf16 v[80:83], v[192:195], v[220:223], v[80:83]
    v_mfma_f32_16x16x32_bf16 v[36:39], v[196:199], v[208:211], v[36:39]
    v_mfma_f32_16x16x32_bf16 v[52:55], v[196:199], v[212:215], v[52:55]
    v_mfma_f32_16x16x32_bf16 v[68:71], v[196:199], v[216:219], v[68:71]
    v_mfma_f32_16x16x32_bf16 v[84:87], v[196:199], v[220:223], v[84:87]
    v_mfma_f32_16x16x32_bf16 v[40:43], v[200:203], v[208:211], v[40:43]
    v_mfma_f32_16x16x32_bf16 v[56:59], v[200:203], v[212:215], v[56:59]
    v_mfma_f32_16x16x32_bf16 v[72:75], v[200:203], v[216:219], v[72:75]
    v_mfma_f32_16x16x32_bf16 v[88:91], v[200:203], v[220:223], v[88:91]
    v_mfma_f32_16x16x32_bf16 v[44:47], v[204:207], v[208:211], v[44:47]
    v_mfma_f32_16x16x32_bf16 v[60:63], v[204:207], v[212:215], v[60:63]
    v_mfma_f32_16x16x32_bf16 v[76:79], v[204:207], v[216:219], v[76:79]
    v_mfma_f32_16x16x32_bf16 v[92:95], v[204:207], v[220:223], v[92:95]
    s_waitcnt vmcnt(20)
    v_mfma_f32_16x16x32_bf16 v[32:35], v[224:227], v[240:243], v[32:35]
    s_waitcnt vmcnt(19)
    v_mfma_f32_16x16x32_bf16 v[48:51], v[224:227], v[244:247], v[48:51]
    s_waitcnt vmcnt(18)
    v_mfma_f32_16x16x32_bf16 v[64:67], v[224:227], v[248:251], v[64:67]
    s_waitcnt vmcnt(17)
    v_mfma_f32_16x16x32_bf16 v[80:83], v[224:227], v[252:255], v[80:83]
    v_mfma_f32_16x16x32_bf16 v[36:39], v[228:231], v[240:243], v[36:39]
    v_mfma_f32_16x16x32_bf16 v[52:55], v[228:231], v[244:247], v[52:55]
    v_mfma_f32_16x16x32_bf16 v[68:71], v[228:231], v[248:251], v[68:71]
    v_mfma_f32_16x16x32_bf16 v[84:87], v[228:231], v[252:255], v[84:87]
    v_mfma_f32_16x16x32_bf16 v[40:43], v[232:235], v[240:243], v[40:43]
    v_mfma_f32_16x16x32_bf16 v[56:59], v[232:235], v[244:247], v[56:59]
    v_mfma_f32_16x16x32_bf16 v[72:75], v[232:235], v[248:251], v[72:75]
    v_mfma_f32_16x16x32_bf16 v[88:91], v[232:235], v[252:255], v[88:91]
    v_mfma_f32_16x16x32_bf16 v[44:47], v[236:239], v[240:243], v[44:47]
    v_mfma_f32_16x16x32_bf16 v[60:63], v[236:239], v[244:247], v[60:63]
    v_mfma_f32_16x16x32_bf16 v[76:79], v[236:239], v[248:251], v[76:79]
    v_mfma_f32_16x16x32_bf16 v[92:95], v[236:239], v[252:255], v[92:95]
    s_waitcnt vmcnt(11)
    v_mfma_f32_16x16x32_bf16 v[32:35], v[96:99], v[112:115], v[32:35]
    s_waitcnt vmcnt(10)
    v_mfma_f32_16x16x32_bf16 v[48:51], v[96:99], v[116:119], v[48:51]
    s_waitcnt vmcnt(9)
    v_mfma_f32_16x16x32_bf16 v[64:67], v[96:99], v[120:123], v[64:67]
    s_waitcnt vmcnt(8)
    v_mfma_f32_16x16x32_bf16 v[80:83], v[96:99], v[124:127], v[80:83]
    v_mfma_f32_16x16x32_bf16 v[36:39], v[100:103], v[112:115], v[36:39]
    v_mfma_f32_16x16x32_bf16 v[52:55], v[100:103], v[116:119], v[52:55]
    v_mfma_f32_16x16x32_bf16 v[68:71], v[100:103], v[120:123], v[68:71]
    v_mfma_f32_16x16x32_bf16 v[84:87], v[100:103], v[124:127], v[84:87]
    v_mfma_f32_16x16x32_bf16 v[40:43], v[104:107], v[112:115], v[40:43]
    v_mfma_f32_16x16x32_bf16 v[56:59], v[104:107], v[116:119], v[56:59]
    v_mfma_f32_16x16x32_bf16 v[72:75], v[104:107], v[120:123], v[72:75]
    v_mfma_f32_16x16x32_bf16 v[88:91], v[104:107], v[124:127], v[88:91]
    v_mfma_f32_16x16x32_bf16 v[44:47], v[108:111], v[112:115], v[44:47]
    v_mfma_f32_16x16x32_bf16 v[60:63], v[108:111], v[116:119], v[60:63]
    v_mfma_f32_16x16x32_bf16 v[76:79], v[108:111], v[120:123], v[76:79]
    v_mfma_f32_16x16x32_bf16 v[92:95], v[108:111], v[124:127], v[92:95]
    s_waitcnt vmcnt(3)
    v_mfma_f32_16x16x32_bf16 v[32:35], v[128:131], v[144:147], v[32:35]
    s_waitcnt vmcnt(2)
    v_mfma_f32_16x16x32_bf16 v[48:51], v[128:131], v[148:151], v[48:51]
    s_waitcnt vmcnt(1)
    v_mfma_f32_16x16x32_bf16 v[64:67], v[128:131], v[152:155], v[64:67]
    s_waitcnt vmcnt(0)
    v_mfma_f32_16x16x32_bf16 v[80:83], v[128:131], v[156:159], v[80:83]
    v_mfma_f32_16x16x32_bf16 v[36:39], v[132:135], v[144:147], v[36:39]
    v_mfma_f32_16x16x32_bf16 v[52:55], v[132:135], v[148:151], v[52:55]
    v_mfma_f32_16x16x32_bf16 v[68:71], v[132:135], v[152:155], v[68:71]
    v_mfma_f32_16x16x32_bf16 v[84:87], v[132:135], v[156:159], v[84:87]
    v_mfma_f32_16x16x32_bf16 v[40:43], v[136:139], v[144:147], v[40:43]
    v_mfma_f32_16x16x32_bf16 v[56:59], v[136:139], v[148:151], v[56:59]
    v_mfma_f32_16x16x32_bf16 v[72:75], v[136:139], v[152:155], v[72:75]
    v_mfma_f32_16x16x32_bf16 v[88:91], v[136:139], v[156:159], v[88:91]
    v_mfma_f32_16x16x32_bf16 v[44:47], v[140:143], v[144:147], v[44:47]
    v_mfma_f32_16x16x32_bf16 v[60:63], v[140:143], v[148:151], v[60:63]
    v_mfma_f32_16x16x32_bf16 v[76:79], v[140:143], v[152:155], v[76:79]
    v_mfma_f32_16x16x32_bf16 v[92:95], v[140:143], v[156:159], v[92:95]
    s_lshl_b32 s67, s40, 14
    v_add_u32 v12, s67, v6
    s_nop 7
    ds_write_b128 v12, v[32:35] offset:0
    ds_write_b128 v12, v[36:39] offset:1024
    ds_write_b128 v12, v[40:43] offset:2048
    ds_write_b128 v12, v[44:47] offset:3072
    ds_write_b128 v12, v[48:51] offset:4096
    ds_write_b128 v12, v[52:55] offset:5120
    ds_write_b128 v12, v[56:59] offset:6144
    ds_write_b128 v12, v[60:63] offset:7168
    ds_write_b128 v12, v[64:67] offset:8192
    ds_write_b128 v12, v[68:71] offset:9216
    ds_write_b128 v12, v[72:75] offset:10240
    ds_write_b128 v12, v[76:79] offset:11264
    ds_write_b128 v12, v[80:83] offset:12288
    ds_write_b128 v12, v[84:87] offset:13312
    ds_write_b128 v12, v[88:91] offset:14336
    ds_write_b128 v12, v[92:95] offset:15360
    s_lshl_b32 s43, s40, 11
    v_add_u32 v12, s43, v6
    v_add_u32 v13, 65536, v12
    s_waitcnt lgkmcnt(0)
    s_barrier
    ds_read_b128 v[32:35], v12 offset:0
    ds_read_b128 v[36:39], v12 offset:1024
    ds_read_b128 v[40:43], v12 offset:16384
    ds_read_b128 v[44:47], v12 offset:17408
    ds_read_b128 v[48:51], v12 offset:32768
    ds_read_b128 v[52:55], v12 offset:33792
    ds_read_b128 v[56:59], v12 offset:49152
    ds_read_b128 v[60:63], v12 offset:50176
    ds_read_b128 v[64:67], v13 offset:0
    ds_read_b128 v[68:71], v13 offset:1024
    ds_read_b128 v[72:75], v13 offset:16384
    ds_read_b128 v[76:79], v13 offset:17408
    ds_read_b128 v[80:83], v13 offset:32768
    ds_read_b128 v[84:87], v13 offset:33792
    ds_read_b128 v[88:91], v13 offset:49152
    ds_read_b128 v[92:95], v13 offset:50176
    s_waitcnt lgkmcnt(7)
    v_pk_add_f32 v[32:33], v[32:33], v[64:65]
    v_pk_add_f32 v[34:35], v[34:35], v[66:67]
    s_waitcnt lgkmcnt(6)
    v_pk_add_f32 v[36:37], v[36:37], v[68:69]
    v_pk_add_f32 v[38:39], v[38:39], v[70:71]
    s_waitcnt lgkmcnt(5)
    v_pk_add_f32 v[40:41], v[40:41], v[72:73]
    v_pk_add_f32 v[42:43], v[42:43], v[74:75]
    s_waitcnt lgkmcnt(4)
    v_pk_add_f32 v[44:45], v[44:45], v[76:77]
    v_pk_add_f32 v[46:47], v[46:47], v[78:79]
    s_waitcnt lgkmcnt(3)
    v_pk_add_f32 v[48:49], v[48:49], v[80:81]
    v_pk_add_f32 v[50:51], v[50:51], v[82:83]
    s_waitcnt lgkmcnt(2)
    v_pk_add_f32 v[52:53], v[52:53], v[84:85]
    v_pk_add_f32 v[54:55], v[54:55], v[86:87]
    s_waitcnt lgkmcnt(1)
    v_pk_add_f32 v[56:57], v[56:57], v[88:89]
    v_pk_add_f32 v[58:59], v[58:59], v[90:91]
    s_waitcnt lgkmcnt(0)
    v_pk_add_f32 v[60:61], v[60:61], v[92:93]
    v_pk_add_f32 v[62:63], v[62:63], v[94:95]
    v_pk_add_f32 v[32:33], v[32:33], v[48:49]
    v_pk_add_f32 v[34:35], v[34:35], v[50:51]
    v_pk_add_f32 v[36:37], v[36:37], v[52:53]
    v_pk_add_f32 v[38:39], v[38:39], v[54:55]
    v_pk_add_f32 v[40:41], v[40:41], v[56:57]
    v_pk_add_f32 v[42:43], v[42:43], v[58:59]
    v_pk_add_f32 v[44:45], v[44:45], v[60:61]
    v_pk_add_f32 v[46:47], v[46:47], v[62:63]
    v_pk_add_f32 v[32:33], v[32:33], v[40:41]
    v_pk_add_f32 v[34:35], v[34:35], v[42:43]
    v_pk_add_f32 v[36:37], v[36:37], v[44:45]
    v_pk_add_f32 v[38:39], v[38:39], v[46:47]
    v_lshlrev_b32 v12, 16, v16
    v_and_b32 v13, s47, v16
    v_pk_fma_f32 v[32:33], v[32:33], v[20:21], v[12:13]
    v_cvt_pk_bf16_f32 v16, v32, v33
    v_lshlrev_b32 v12, 16, v17
    v_and_b32 v13, s47, v17
    v_pk_fma_f32 v[34:35], v[34:35], v[22:23], v[12:13]
    v_cvt_pk_bf16_f32 v17, v34, v35
    buffer_store_dwordx2 v[16:17], v8, s[56:59], 0 offen offset:0 sc0 sc1
    v_lshlrev_b32 v12, 16, v18
    v_and_b32 v13, s47, v18
    v_pk_fma_f32 v[36:37], v[36:37], v[24:25], v[12:13]
    v_cvt_pk_bf16_f32 v18, v36, v37
    v_lshlrev_b32 v12, 16, v19
    v_and_b32 v13, s47, v19
    v_pk_fma_f32 v[38:39], v[38:39], v[26:27], v[12:13]
    v_cvt_pk_bf16_f32 v19, v38, v39
    buffer_store_dwordx2 v[18:19], v8, s[56:59], 0 offen offset:32 sc0 sc1
K5_end:
    s_endpgm
.section .rodata,"a"
.p2align 6
.amdhsa_kernel k34_tail_kernel
  .amdhsa_next_free_vgpr 256
  .amdhsa_next_free_sgpr 96
  .amdhsa_accum_offset 256
  .amdhsa_group_segment_fixed_size 0
  .amdhsa_kernarg_size 104
  .amdhsa_user_sgpr_count 2
  .amdhsa_user_sgpr_kernarg_segment_ptr 1
  .amdhsa_system_sgpr_workgroup_id_x 1
.end_amdhsa_kernel
.text
code_end:
    s_endpgm
```
